```python
import torch

def _softmax(x, axis=-1):
    return torch.softmax(x, dim=axis)
def _gelu(x):
    return torch.nn.functional.gelu(x, approximate="tanh")
def _silu(x):
    return torch.nn.functional.silu(x)
def _sigmoid(x):
    return torch.sigmoid(x)
def _layernorm(x, axis=-1, eps=1e-5):
    m = x.mean(dim=axis, keepdim=True)
    v = x.var(dim=axis, keepdim=True, unbiased=False)
    return (x - m) / torch.sqrt(v + eps)
def _scatter_add(tgt, idx, src, axis=0):
    return tgt.clone().index_add_(axis, idx, src)
def _segment_sum(src, seg, n):
    out = torch.zeros((n,) + src.shape[1:], dtype=src.dtype)
    return out.index_add_(0, seg, src)
def _pad(x, pw):
    flat = tuple(v for pair in reversed(pw) for v in pair)
    return torch.nn.functional.pad(x, flat)

kernel_name = 'parallel_sum__sliding_block__dense_activation_relu__prompt'

def setup_inputs():

    _w = (lambda a: (lambda t: t.to(torch.bfloat16) if t.is_floating_point() else t)(torch.as_tensor(a)))
    def _A_setup():
        B, S, D = 1, 2048, 1024
        return {
            "x": _w((lambda *s: torch.randn(*s, dtype=torch.bfloat16) * 0.05)(B, S, D)),
            "wqkv": _w((lambda *s: torch.randn(*s, dtype=torch.bfloat16) * 0.05)(D, 3 * D)),
            "wo": _w((lambda *s: torch.randn(*s, dtype=torch.bfloat16) * 0.05)(D, D)),
        }
    _A_in = _A_setup()

    def _B_setup():
        B, S, D, Dff = 1, 2048, 1024, 3584
        return {
            "x": _w((lambda *s: torch.randn(*s, dtype=torch.bfloat16) * 0.05)(B, S, D)),
            "w1": _w((lambda *s: torch.randn(*s, dtype=torch.bfloat16) * 0.05)(D, Dff)),
            "w2": _w((lambda *s: torch.randn(*s, dtype=torch.bfloat16) * 0.05)(Dff, D)),
        }
    _B_in = _B_setup()

    return {
        "A_x": _A_in["x"],
        "A_wqkv": _A_in["wqkv"],
        "A_wo": _A_in["wo"],
        "B_x": _B_in["x"],
        "B_w1": _B_in["w1"],
        "B_w2": _B_in["w2"],
    }

def reference(A_x, A_wqkv, A_wo, B_x, B_w1, B_w2):
    def _A_ref(x, wqkv, wo):
        B, S, D = x.shape
        H = 32; Dh = D // H; W = 256
        qkv = (lambda x, *d: x.permute(*d))((x @ wqkv).reshape(B, S, 3, H, Dh), 2, 0, 3, 1, 4)
        q, k, v = qkv[0], qkv[1], qkv[2]
        scores = torch.einsum("bhqd,bhkd->bhqk", q, k) * (Dh ** -0.5)
        idx = torch.arange(S)
        mask = (idx[:, None] - idx[None, :] >= 0) & (idx[:, None] - idx[None, :] < W)
        scores = torch.where(mask[None, None], scores, -1e9)
        p = _softmax(scores, axis=-1)
        o = torch.einsum("bhqk,bhkd->bhqd", p, v)
        return (lambda x, *d: x.permute(*d))(o, 0, 2, 1, 3).reshape(B, S, D) @ wo

    def _B_ref(x, w1, w2):
        h = torch.einsum("bsd,df->bsf", x, w1)
        zero = torch.zeros_like(h)
        h = torch.maximum(h, zero)
        return torch.einsum("bsf,fd->bsd", h, w2)

    x = A_x
    xn = _layernorm(x, axis=-1)
    return x + _A_ref(xn, A_wqkv, A_wo) + _B_ref(xn, B_w1, B_w2)
```

```asm
; @launch grid=(256,1,1) block=(256,1,1) lds=163840
.amdgcn_target "amdgcn-amd-amdhsa--gfx950"
.text
.globl parallel_sum__sliding_block__dense_activation_relu__prompt_kernel
.p2align 8
.type parallel_sum__sliding_block__dense_activation_relu__prompt_kernel,@function
parallel_sum__sliding_block__dense_activation_relu__prompt_kernel:
s_cmp_ge_u32 s2, 256
s_cbranch_scc1 Lend
s_load_dwordx16 s[64:79], s[0:1], 0
s_load_dwordx2 s[80:81], s[0:1], 64
v_and_b32 v234, 63, v0
v_lshrrev_b32 v1, 6, v0
s_nop 0
v_readfirstlane_b32 s3, v1
v_lshlrev_b32 v233, 4, v234
v_and_b32 v252, 31, v234
v_lshlrev_b32 v235, 7, v252
v_lshlrev_b32 v236, 9, v252
s_getpc_b64 s[28:29]
s_and_b32 s29, s29, 0xffff
s_mov_b32 s30, 60884
s_mov_b32 s31, 0x20000
s_lshr_b32 s42, s2, 3
s_lshl_b32 s43, s42, 2
s_add_u32 s43, s43, s3
s_mul_i32 s43, s43, 640
s_mov_b64 exec, 0x1f
buffer_load_dword v2, v235, s[28:31], s43 offen
s_mov_b64 exec, -1
s_and_b32 s32, s42, 3
s_lshr_b32 s33, s42, 2
s_and_b32 s43, s2, 1
s_lshl_b32 s43, s43, 2
s_add_u32 s32, s32, s43
s_and_b32 s43, s2, 6
s_lshl_b32 s43, s43, 2
s_add_u32 s33, s33, s43
s_lshr_b32 s38, s33, 3
s_and_b32 s40, s38, 1
s_and_b32 s39, s33, 7
s_lshl_b32 s42, s32, 5
s_add_u32 s42, s42, s33
s_lshl_b32 s42, s42, 2
s_add_u32 s42, s42, s3
s_lshl_b32 s34, s42, 7
s_add_u32 s34, s34, 48234496
s_lshl_b32 s43, s42, 12
v_mov_b32 v245, 0
v_lshlrev_b32 v237, 26, v234
v_min_u32 v237, 67108864, v237
s_lshl_b32 s44, s2, 2
s_add_u32 s44, s44, s3
s_mul_i32 s60, s44, 1536
s_mul_i32 s61, s44, 1792
s_mov_b32 s47, s42
s_add_u32 s44, s32, s33
s_and_b32 s44, s44, 3
s_mov_b32 s58, 0x75463102
s_mov_b32 s59, 0xfdceb98a
s_cmp_eq_u32 s44, 1
s_cselect_b32 s58, 0x65742130, s58
s_cselect_b32 s59, 0xedfca9b8, s59
s_cmp_eq_u32 s44, 2
s_cselect_b32 s58, 0x68532410, s58
s_cselect_b32 s59, 0xfedbac97, s59
s_cmp_eq_u32 s44, 3
s_cselect_b32 s58, 0x96435201, s58
s_cselect_b32 s59, 0xfecbda87, s59
v_lshrrev_b32 v5, 3, v234
v_and_b32 v6, 7, v234
v_xor_b32 v6, v6, v5
v_lshlrev_b32 v251, 11, v5
v_lshl_add_u32 v251, v6, 4, v251
s_lshl_b32 s44, s32, 2
s_add_u32 s44, s44, s3
s_lshl_b32 s54, s44, 17
s_lshl_b32 s57, s44, 12
s_add_u32 s57, s57, 48234496
s_lshl_b32 s62, s44, 10
s_add_u32 s62, s62, 49152000
s_lshl_b32 s63, s47, 5
s_add_u32 s63, s63, 49152000
s_mov_b32 s42, 49217536
s_mov_b32 s6, 4194304
s_mov_b32 s7, 0x20000
s_mov_b32 s18, 49283072
s_mov_b32 s19, 0x20000
s_mov_b32 s10, 6291456
s_mov_b32 s11, 0x20000
s_mov_b32 s14, 7340032
s_mov_b32 s15, 0x20000
s_mov_b32 s22, 7340032
s_mov_b32 s23, 0x20000
s_mov_b32 s26, 2097152
s_mov_b32 s27, 0x20000
s_waitcnt lgkmcnt(0)
s_mov_b64 s[4:5], s[64:65]
buffer_load_dwordx4 v[8:11], v233, s[4:7], s43 offen offset:0
buffer_load_dwordx4 v[12:15], v233, s[4:7], s43 offen offset:1024
buffer_load_dwordx4 v[16:19], v233, s[4:7], s43 offen offset:2048
buffer_load_dwordx4 v[20:23], v233, s[4:7], s43 offen offset:3072
s_mov_b64 s[16:17], s[80:81]
buffer_load_dwordx2 v[238:239], v245, s[16:19], s42 offen sc1
v_lshlrev_b32 v4, 17, v234
s_mov_b64 exec, 0x7f
buffer_load_dword v3, v4, s[16:19], s34 offen
s_mov_b64 exec, -1
s_mov_b64 s[8:9], s[66:67]
s_mov_b64 s[12:13], s[72:73]
s_mov_b64 s[20:21], s[74:75]
s_mov_b64 s[24:25], s[68:69]
s_mov_b64 s[28:29], s[76:77]
s_mov_b32 s30, 4194304
s_mov_b32 s31, 0x20000
buffer_load_dword v2, v237, s[16:19], s63 offen
v_lshrrev_b32 v100, 2, v234
s_lshl_b32 s44, s3, 4
v_add_u32 v100, s44, v100
v_mul_u32_u24 v100, 6144, v100
v_lshrrev_b32 v101, 5, v234
v_lshlrev_b32 v101, 1, v101
v_and_b32 v102, 3, v234
v_xor_b32 v101, v101, v102
v_lshl_add_u32 v100, v101, 4, v100
s_lshl_b32 s45, s33, 6
v_add_u32 v226, s45, v100
v_add_u32 v227, 1024, v226
v_add_u32 v228, 2048, v226
v_lshrrev_b32 v100, 4, v234
v_add_u32 v101, s44, v100
v_mul_u32_u24 v101, 7168, v101
s_mul_i32 s45, s33, 224
s_and_b32 s46, s33, 1
s_lshl_b32 s48, s46, 5
s_sub_u32 s45, s45, s48
v_add_u32 v101, s45, v101
v_and_b32 v102, 1, v234
v_lshl_add_u32 v101, v102, 4, v101
v_bfe_u32 v102, v234, 1, 3
v_xor_b32 v102, v102, v100
v_lshl_add_u32 v229, v102, 5, v101
v_lshl_add_u32 v230, v102, 5, v101
v_add_u32 v230, 27648, v230
v_xor_b32 v102, 4, v102
v_lshl_add_u32 v231, v102, 5, v101
v_add_u32 v231, 55296, v231
v_lshl_add_u32 v232, v102, 5, v101
v_add_u32 v232, 82944, v232
s_mul_i32 s56, s3, 7168
s_add_u32 s56, s56, 4096
s_add_u32 m0, s56, 3072
s_bfe_u32 s55, s58, 0x40000
s_mul_i32 s50, s55, 393216
s_mul_i32 s51, s55, 458752
buffer_load_dwordx4 v229, s[12:15], s51 offen offset:0 lds
buffer_load_dwordx4 v230, s[12:15], s51 offen offset:1024 lds
buffer_load_dwordx4 v231, s[12:15], s51 offen offset:2048 lds
buffer_load_dwordx4 v232, s[12:15], s51 offen offset:3072 lds
s_add_u32 m0, s56, 0
s_nop 0
buffer_load_dwordx4 v226, s[8:11], s50 offen offset:0 lds
buffer_load_dwordx4 v227, s[8:11], s50 offen offset:1024 lds
buffer_load_dwordx4 v228, s[8:11], s50 offen offset:2048 lds
v_and_b32 v40, 7, v234
s_lshl_b32 s44, s3, 1
s_add_u32 s45, s44, 0
v_xor_b32 v41, s45, v40
v_lshlrev_b32 v41, 4, v41
v_lshl_add_u32 v41, v234, 7, v41
v_add_u32 v41, 131072, v41
s_add_u32 s45, s44, 1
v_xor_b32 v42, s45, v40
v_lshlrev_b32 v42, 4, v42
v_lshl_add_u32 v42, v234, 7, v42
v_add_u32 v42, 131072, v42
v_lshrrev_b32 v43, 3, v234
v_xor_b32 v44, v43, v40
v_lshlrev_b32 v44, 4, v44
v_lshl_add_u32 v44, v43, 7, v44
s_lshl_b32 s44, s3, 12
s_add_u32 s44, s44, 131072
v_add_u32 v44, s44, v44
v_lshlrev_b32 v45, 8, v43
v_lshl_add_u32 v45, v40, 4, v45
s_lshl_b32 s44, s32, 2
s_lshr_b32 s45, s33, 3
s_add_u32 s44, s44, s45
s_lshl_b32 s44, s44, 17
s_bfe_u32 s45, s33, 0x20001
s_lshl_b32 s45, s45, 11
s_add_u32 s44, s44, s45
s_lshl_b32 s45, s46, 7
s_add_u32 s44, s44, s45
s_lshl_b32 s45, s3, 15
s_add_u32 s42, s44, s45
v_mov_b32 v30, 0x3f803f80
v_mov_b32 v24, 0
v_mov_b32 v25, 0
v_lshrrev_b32 v100, 5, v234
v_mul_u32_u24 v100, 7168, v100
v_and_b32 v101, 3, v234
v_lshl_add_u32 v100, v101, 3, v100
v_add_u32 v100, 4096, v100
v_bfe_u32 v101, v234, 4, 1
v_bfe_u32 v102, v234, 2, 2
v_lshl_add_u32 v103, v101, 3, v102
v_lshl_add_u32 v104, v103, 6, v100
v_lshl_add_u32 v208, v101, 5, v104
v_xor_b32 v105, 1, v101
v_lshl_add_u32 v209, v105, 5, v104
v_lshl_add_u32 v104, v103, 8, v100
v_add_u32 v104, 3072, v104
v_lshl_add_u32 v105, v101, 2, v102
s_lshl_b32 s43, s46, 1
s_add_u32 s48, s43, 0
v_xor_b32 v106, s48, v105
v_lshl_add_u32 v210, v106, 5, v104
s_add_u32 s48, s43, 1
v_xor_b32 v106, s48, v105
v_lshl_add_u32 v211, v106, 5, v104
s_add_u32 s48, s43, 2
v_xor_b32 v106, s48, v105
v_lshl_add_u32 v212, v106, 5, v104
s_add_u32 s48, s43, 3
v_xor_b32 v106, s48, v105
v_lshl_add_u32 v213, v106, 5, v104
s_add_u32 s48, s43, 4
v_xor_b32 v106, s48, v105
v_lshl_add_u32 v214, v106, 5, v104
s_add_u32 s48, s43, 5
v_xor_b32 v106, s48, v105
v_lshl_add_u32 v215, v106, 5, v104
s_mul_i32 s48, s46, 5
s_sub_u32 s48, 6, s48
v_xor_b32 v106, s48, v105
v_lshl_add_u32 v216, v106, 5, v104
v_add_u32 v217, 57344, v208
v_add_u32 v218, 57344, v209
v_add_u32 v219, 57344, v210
v_add_u32 v220, 57344, v211
v_add_u32 v221, 57344, v212
v_add_u32 v222, 57344, v213
v_add_u32 v223, 57344, v214
v_add_u32 v224, 57344, v215
v_add_u32 v225, 57344, v216
v_and_b32 v46, 15, v234
v_lshrrev_b32 v47, 4, v234
v_xor_b32 v47, v47, v40
v_lshlrev_b32 v47, 4, v47
v_lshl_add_u32 v46, v46, 7, v47
s_lshl_b32 s45, s3, 13
s_add_u32 s45, s45, 61440
v_add_u32 v46, s45, v46
v_xor_b32 v47, 64, v46
s_add_u32 s48, s32, s33
s_add_u32 s48, s48, 0
s_and_b32 s48, s48, 3
v_lshlrev_b32 v255, 7, v234
v_accvgpr_write_b32 a232, v30
v_accvgpr_write_b32 a233, v30
v_accvgpr_write_b32 a234, v30
v_accvgpr_write_b32 a235, v30
s_mov_b64 exec, 0
s_cmp_eq_u32 s3, 0
s_cbranch_scc1 Lpad0
s_cmp_eq_u32 s3, 1
s_cbranch_scc1 Lpad1
s_cmp_eq_u32 s3, 2
s_cbranch_scc1 Lpad2
s_branch Lpad3
Lwarm_done:
s_mov_b64 exec, -1
s_waitcnt vmcnt(10)
v_dot2c_f32_bf16 v24, v8, v30
v_dot2c_f32_bf16 v25, v16, v30
v_dot2c_f32_bf16 v24, v9, v30
v_dot2c_f32_bf16 v25, v17, v30
v_dot2c_f32_bf16 v24, v10, v30
v_dot2c_f32_bf16 v25, v18, v30
v_dot2c_f32_bf16 v24, v11, v30
v_dot2c_f32_bf16 v25, v19, v30
v_dot2c_f32_bf16 v24, v12, v30
v_dot2c_f32_bf16 v25, v20, v30
v_dot2c_f32_bf16 v24, v13, v30
v_dot2c_f32_bf16 v25, v21, v30
v_dot2c_f32_bf16 v24, v14, v30
v_dot2c_f32_bf16 v25, v22, v30
v_dot2c_f32_bf16 v24, v15, v30
v_dot2c_f32_bf16 v25, v23, v30
v_lshlrev_b32 v64, 16, v8
v_and_b32 v65, 0xffff0000, v8
v_lshlrev_b32 v66, 16, v9
v_and_b32 v67, 0xffff0000, v9
v_lshlrev_b32 v68, 16, v10
v_add_f32_dpp v24, v24, v24 quad_perm:[1,0,3,2] row_mask:0xf bank_mask:0xf
v_add_f32_dpp v25, v25, v25 quad_perm:[1,0,3,2] row_mask:0xf bank_mask:0xf
v_and_b32 v69, 0xffff0000, v10
v_lshlrev_b32 v70, 16, v11
v_and_b32 v71, 0xffff0000, v11
v_lshlrev_b32 v72, 16, v12
v_and_b32 v73, 0xffff0000, v12
v_add_f32_dpp v24, v24, v24 quad_perm:[2,3,0,1] row_mask:0xf bank_mask:0xf
v_add_f32_dpp v25, v25, v25 quad_perm:[2,3,0,1] row_mask:0xf bank_mask:0xf
v_lshlrev_b32 v74, 16, v13
v_and_b32 v75, 0xffff0000, v13
v_lshlrev_b32 v76, 16, v14
v_and_b32 v77, 0xffff0000, v14
v_lshlrev_b32 v78, 16, v15
v_add_f32_dpp v24, v24, v24 row_half_mirror row_mask:0xf bank_mask:0xf
v_add_f32_dpp v25, v25, v25 row_half_mirror row_mask:0xf bank_mask:0xf
v_and_b32 v79, 0xffff0000, v15
v_lshlrev_b32 v80, 16, v16
v_and_b32 v81, 0xffff0000, v16
v_lshlrev_b32 v82, 16, v17
v_and_b32 v83, 0xffff0000, v17
v_add_f32_dpp v24, v24, v24 row_mirror row_mask:0xf bank_mask:0xf
v_add_f32_dpp v25, v25, v25 row_mirror row_mask:0xf bank_mask:0xf
v_lshlrev_b32 v84, 16, v18
v_and_b32 v85, 0xffff0000, v18
v_lshlrev_b32 v86, 16, v19
v_and_b32 v87, 0xffff0000, v19
v_lshlrev_b32 v88, 16, v20
v_mov_b32 v28, v24
v_mov_b32 v29, v25
v_and_b32 v89, 0xffff0000, v20
v_lshlrev_b32 v90, 16, v21
v_and_b32 v91, 0xffff0000, v21
v_lshlrev_b32 v92, 16, v22
v_and_b32 v93, 0xffff0000, v22
v_permlane16_swap_b32 v24, v28
v_permlane16_swap_b32 v25, v29
v_add_f32 v24, v24, v28
v_add_f32 v25, v25, v29
v_lshlrev_b32 v94, 16, v23
v_and_b32 v95, 0xffff0000, v23
s_bfe_u32 s52, s58, 0x40000
s_lshl_b32 s52, s52, 7
s_add_u32 s52, s52, s54
s_lshl_b32 s53, s3, 13
s_add_u32 s53, s53, 61440
s_add_u32 m0, s53, 0
s_nop 0
buffer_load_dwordx4 v251, s[4:7], s52 offen offset:0 lds
v_mov_b32 v28, v24
v_mov_b32 v29, v25
s_nop 0
v_permlane32_swap_b32 v24, v28
v_permlane32_swap_b32 v25, v29
v_add_f32 v24, v24, v28
v_add_f32 v25, v25, v29
v_mul_f32 v24, 0x3a800000, v24
v_mul_f32 v25, 0x3a800000, v25
v_cvt_pk_bf16_f32 v32, 0, v24
v_cvt_pk_bf16_f32 v34, 0, v25
v_pk_add_f32 v[64:65], v[64:65], v[32:33] op_sel_hi:[1,0] neg_lo:[0,1] neg_hi:[0,1]
v_pk_add_f32 v[80:81], v[80:81], v[34:35] op_sel_hi:[1,0] neg_lo:[0,1] neg_hi:[0,1]
v_pk_add_f32 v[66:67], v[66:67], v[32:33] op_sel_hi:[1,0] neg_lo:[0,1] neg_hi:[0,1]
v_pk_add_f32 v[82:83], v[82:83], v[34:35] op_sel_hi:[1,0] neg_lo:[0,1] neg_hi:[0,1]
v_pk_add_f32 v[68:69], v[68:69], v[32:33] op_sel_hi:[1,0] neg_lo:[0,1] neg_hi:[0,1]
v_pk_add_f32 v[84:85], v[84:85], v[34:35] op_sel_hi:[1,0] neg_lo:[0,1] neg_hi:[0,1]
v_pk_add_f32 v[70:71], v[70:71], v[32:33] op_sel_hi:[1,0] neg_lo:[0,1] neg_hi:[0,1]
v_pk_add_f32 v[86:87], v[86:87], v[34:35] op_sel_hi:[1,0] neg_lo:[0,1] neg_hi:[0,1]
v_pk_add_f32 v[72:73], v[72:73], v[32:33] op_sel_hi:[1,0] neg_lo:[0,1] neg_hi:[0,1]
v_pk_add_f32 v[88:89], v[88:89], v[34:35] op_sel_hi:[1,0] neg_lo:[0,1] neg_hi:[0,1]
v_pk_add_f32 v[74:75], v[74:75], v[32:33] op_sel_hi:[1,0] neg_lo:[0,1] neg_hi:[0,1]
v_pk_add_f32 v[90:91], v[90:91], v[34:35] op_sel_hi:[1,0] neg_lo:[0,1] neg_hi:[0,1]
v_pk_add_f32 v[76:77], v[76:77], v[32:33] op_sel_hi:[1,0] neg_lo:[0,1] neg_hi:[0,1]
v_pk_add_f32 v[92:93], v[92:93], v[34:35] op_sel_hi:[1,0] neg_lo:[0,1] neg_hi:[0,1]
v_pk_add_f32 v[78:79], v[78:79], v[32:33] op_sel_hi:[1,0] neg_lo:[0,1] neg_hi:[0,1]
v_pk_add_f32 v[94:95], v[94:95], v[34:35] op_sel_hi:[1,0] neg_lo:[0,1] neg_hi:[0,1]
v_pk_mul_f32 v[36:37], v[64:65], v[64:65]
v_pk_mul_f32 v[38:39], v[80:81], v[80:81]
v_pk_fma_f32 v[36:37], v[66:67], v[66:67], v[36:37]
v_pk_fma_f32 v[38:39], v[82:83], v[82:83], v[38:39]
v_pk_fma_f32 v[36:37], v[68:69], v[68:69], v[36:37]
v_pk_fma_f32 v[38:39], v[84:85], v[84:85], v[38:39]
v_pk_fma_f32 v[36:37], v[70:71], v[70:71], v[36:37]
v_pk_fma_f32 v[38:39], v[86:87], v[86:87], v[38:39]
v_pk_fma_f32 v[36:37], v[72:73], v[72:73], v[36:37]
v_pk_fma_f32 v[38:39], v[88:89], v[88:89], v[38:39]
v_pk_fma_f32 v[36:37], v[74:75], v[74:75], v[36:37]
v_pk_fma_f32 v[38:39], v[90:91], v[90:91], v[38:39]
v_pk_fma_f32 v[36:37], v[76:77], v[76:77], v[36:37]
v_pk_fma_f32 v[38:39], v[92:93], v[92:93], v[38:39]
v_pk_fma_f32 v[36:37], v[78:79], v[78:79], v[36:37]
v_pk_fma_f32 v[38:39], v[94:95], v[94:95], v[38:39]
v_add_f32 v26, v36, v37
v_add_f32 v27, v38, v39
s_waitcnt vmcnt(10)
v_add_co_u32 v238, vcc, 0x9e3779b9, v238
v_add_f32_dpp v26, v26, v26 quad_perm:[1,0,3,2] row_mask:0xf bank_mask:0xf
v_add_f32_dpp v27, v27, v27 quad_perm:[1,0,3,2] row_mask:0xf bank_mask:0xf
v_mov_b32 v31, 0x7f4a7c15
v_cmp_eq_u32 s[44:45], 1, v234
v_add_f32_dpp v26, v26, v26 quad_perm:[2,3,0,1] row_mask:0xf bank_mask:0xf
v_add_f32_dpp v27, v27, v27 quad_perm:[2,3,0,1] row_mask:0xf bank_mask:0xf
v_addc_co_u32 v239, vcc, v239, v31, vcc
v_mov_b32 v5, v238
v_add_f32_dpp v26, v26, v26 row_half_mirror row_mask:0xf bank_mask:0xf
v_add_f32_dpp v27, v27, v27 row_half_mirror row_mask:0xf bank_mask:0xf
v_cndmask_b32_e64 v4, v32, v34, s[44:45]
v_mov_b32 v7, v239
v_add_f32_dpp v26, v26, v26 row_mirror row_mask:0xf bank_mask:0xf
v_add_f32_dpp v27, v27, v27 row_mirror row_mask:0xf bank_mask:0xf
v_mov_b32 v31, 0x3a800000
v_sub_f32 v24, v24, v32
v_mov_b32 v28, v26
v_mov_b32 v29, v27
v_sub_f32 v25, v25, v34
v_mul_f32 v24, v24, v24
v_permlane16_swap_b32 v26, v28
v_permlane16_swap_b32 v27, v29
v_add_f32 v26, v26, v28
v_add_f32 v27, v27, v29
v_mul_f32 v25, v25, v25
v_mov_b32 v28, v26
v_mov_b32 v29, v27
s_nop 0
v_permlane32_swap_b32 v26, v28
v_permlane32_swap_b32 v27, v29
v_add_f32 v26, v26, v28
v_add_f32 v27, v27, v29
v_fma_f32 v26, v26, v31, -v24
v_fma_f32 v27, v27, v31, -v25
v_max_f32 v26, 0, v26
v_max_f32 v27, 0, v27
v_cvt_pk_bf16_f32 v26, 0, v26
v_cvt_pk_bf16_f32 v27, 0, v27
v_add_f32 v26, 0x3727c5ac, v26
v_add_f32 v27, 0x3727c5ac, v27
v_cvt_pk_bf16_f32 v26, 0, v26
v_cvt_pk_bf16_f32 v27, 0, v27
v_sqrt_f32 v26, v26
v_sqrt_f32 v27, v27
v_cvt_pk_bf16_f32 v26, 0, v26
v_cvt_pk_bf16_f32 v27, 0, v27
v_rcp_f32 v32, v26
v_rcp_f32 v34, v27
s_nop 0
v_cndmask_b32_e64 v6, v32, v34, s[44:45]
v_mul_f32_e64 v4, -v4, v6
s_mov_b64 exec, 0x3
buffer_store_dwordx4 v[4:7], v233, s[16:19], s63 offen sc1
s_mov_b64 exec, -1
v_pk_mul_f32 v[64:65], v[64:65], v[32:33] op_sel_hi:[1,0]
v_pk_mul_f32 v[66:67], v[66:67], v[32:33] op_sel_hi:[1,0]
v_pk_mul_f32 v[68:69], v[68:69], v[32:33] op_sel_hi:[1,0]
v_pk_mul_f32 v[70:71], v[70:71], v[32:33] op_sel_hi:[1,0]
v_cvt_pk_bf16_f32 v8, v64, v65
v_cvt_pk_bf16_f32 v9, v66, v67
v_cvt_pk_bf16_f32 v10, v68, v69
v_cvt_pk_bf16_f32 v11, v70, v71
ds_write_b128 v41, v[8:11] offset:0
s_add_u32 s52, s52, 15360
buffer_load_dwordx4 v251, s[4:7], s52 offen offset:1024 lds
s_add_u32 s52, s52, 15360
buffer_load_dwordx4 v251, s[4:7], s52 offen offset:2048 lds
v_pk_mul_f32 v[72:73], v[72:73], v[32:33] op_sel_hi:[1,0]
v_pk_mul_f32 v[74:75], v[74:75], v[32:33] op_sel_hi:[1,0]
v_pk_mul_f32 v[76:77], v[76:77], v[32:33] op_sel_hi:[1,0]
v_pk_mul_f32 v[78:79], v[78:79], v[32:33] op_sel_hi:[1,0]
v_cvt_pk_bf16_f32 v12, v72, v73
v_cvt_pk_bf16_f32 v13, v74, v75
v_cvt_pk_bf16_f32 v14, v76, v77
v_cvt_pk_bf16_f32 v15, v78, v79
ds_write_b128 v41, v[12:15] offset:8192
s_add_u32 s52, s52, 15360
buffer_load_dwordx4 v251, s[4:7], s52 offen offset:3072 lds
s_add_u32 s52, s52, 19456
s_add_u32 m0, s53, 4096
s_nop 0
buffer_load_dwordx4 v251, s[4:7], s52 offen offset:0 lds
v_pk_mul_f32 v[80:81], v[80:81], v[34:35] op_sel_hi:[1,0]
v_pk_mul_f32 v[82:83], v[82:83], v[34:35] op_sel_hi:[1,0]
v_pk_mul_f32 v[84:85], v[84:85], v[34:35] op_sel_hi:[1,0]
v_pk_mul_f32 v[86:87], v[86:87], v[34:35] op_sel_hi:[1,0]
v_cvt_pk_bf16_f32 v16, v80, v81
v_cvt_pk_bf16_f32 v17, v82, v83
v_cvt_pk_bf16_f32 v18, v84, v85
v_cvt_pk_bf16_f32 v19, v86, v87
ds_write_b128 v42, v[16:19] offset:0
s_add_u32 s52, s52, 15360
buffer_load_dwordx4 v251, s[4:7], s52 offen offset:1024 lds
s_add_u32 s52, s52, 15360
buffer_load_dwordx4 v251, s[4:7], s52 offen offset:2048 lds
v_pk_mul_f32 v[88:89], v[88:89], v[34:35] op_sel_hi:[1,0]
v_pk_mul_f32 v[90:91], v[90:91], v[34:35] op_sel_hi:[1,0]
v_pk_mul_f32 v[92:93], v[92:93], v[34:35] op_sel_hi:[1,0]
v_pk_mul_f32 v[94:95], v[94:95], v[34:35] op_sel_hi:[1,0]
v_cvt_pk_bf16_f32 v20, v88, v89
v_cvt_pk_bf16_f32 v21, v90, v91
v_cvt_pk_bf16_f32 v22, v92, v93
v_cvt_pk_bf16_f32 v23, v94, v95
ds_write_b128 v42, v[20:23] offset:8192
s_add_u32 s52, s52, 15360
buffer_load_dwordx4 v251, s[4:7], s52 offen offset:3072 lds
s_waitcnt lgkmcnt(0)
s_barrier
ds_read_b128 v[48:51], v44 offset:0
ds_read_b128 v[52:55], v44 offset:1024
ds_read_b128 v[56:59], v44 offset:2048
ds_read_b128 v[60:63], v44 offset:3072
v_readfirstlane_b32 s36, v238
v_readfirstlane_b32 s37, v239
s_waitcnt lgkmcnt(3)
buffer_store_dwordx4 v[48:51], v45, s[16:19], s42 offen sc1
s_add_u32 s42, s42, 8192
s_waitcnt lgkmcnt(2)
buffer_store_dwordx4 v[52:55], v45, s[16:19], s42 offen sc1
s_add_u32 s42, s42, 8192
s_waitcnt lgkmcnt(1)
buffer_store_dwordx4 v[56:59], v45, s[16:19], s42 offen sc1
s_add_u32 s42, s42, 8192
s_waitcnt lgkmcnt(0)
buffer_store_dwordx4 v[60:63], v45, s[16:19], s42 offen sc1
s_add_u32 s42, s42, 8192
s_waitcnt vmcnt(4)
ds_read_b128 v[64:67], v46 offset:0
ds_read_b128 v[68:71], v47 offset:0
ds_read_b128 v[72:75], v46 offset:2048
ds_read_b128 v[76:79], v47 offset:2048
ds_read_b128 v[80:83], v46 offset:4096
ds_read_b128 v[84:87], v47 offset:4096
ds_read_b128 v[88:91], v46 offset:6144
ds_read_b128 v[92:95], v47 offset:6144
s_waitcnt lgkmcnt(6)
v_lshlrev_b32 v96, 16, v64
v_and_b32 v97, 0xffff0000, v64
v_lshlrev_b32 v98, 16, v65
v_and_b32 v99, 0xffff0000, v65
v_lshlrev_b32 v100, 16, v66
v_and_b32 v101, 0xffff0000, v66
v_lshlrev_b32 v102, 16, v67
v_and_b32 v103, 0xffff0000, v67
v_lshlrev_b32 v104, 16, v68
v_and_b32 v105, 0xffff0000, v68
v_lshlrev_b32 v106, 16, v69
v_and_b32 v107, 0xffff0000, v69
v_lshlrev_b32 v108, 16, v70
v_and_b32 v109, 0xffff0000, v70
v_lshlrev_b32 v110, 16, v71
v_and_b32 v111, 0xffff0000, v71
s_waitcnt lgkmcnt(4)
v_lshlrev_b32 v112, 16, v72
v_and_b32 v113, 0xffff0000, v72
v_lshlrev_b32 v114, 16, v73
v_and_b32 v115, 0xffff0000, v73
v_lshlrev_b32 v116, 16, v74
v_and_b32 v117, 0xffff0000, v74
v_lshlrev_b32 v118, 16, v75
v_and_b32 v119, 0xffff0000, v75
v_lshlrev_b32 v120, 16, v76
v_and_b32 v121, 0xffff0000, v76
v_lshlrev_b32 v122, 16, v77
v_and_b32 v123, 0xffff0000, v77
v_lshlrev_b32 v124, 16, v78
v_and_b32 v125, 0xffff0000, v78
v_lshlrev_b32 v126, 16, v79
v_and_b32 v127, 0xffff0000, v79
s_waitcnt lgkmcnt(2)
v_lshlrev_b32 v128, 16, v80
v_and_b32 v129, 0xffff0000, v80
v_lshlrev_b32 v130, 16, v81
v_and_b32 v131, 0xffff0000, v81
v_lshlrev_b32 v132, 16, v82
v_and_b32 v133, 0xffff0000, v82
v_lshlrev_b32 v134, 16, v83
v_and_b32 v135, 0xffff0000, v83
v_lshlrev_b32 v136, 16, v84
v_and_b32 v137, 0xffff0000, v84
v_lshlrev_b32 v138, 16, v85
v_and_b32 v139, 0xffff0000, v85
v_lshlrev_b32 v140, 16, v86
v_and_b32 v141, 0xffff0000, v86
v_lshlrev_b32 v142, 16, v87
v_and_b32 v143, 0xffff0000, v87
s_waitcnt lgkmcnt(0)
v_lshlrev_b32 v144, 16, v88
v_and_b32 v145, 0xffff0000, v88
v_lshlrev_b32 v146, 16, v89
v_and_b32 v147, 0xffff0000, v89
v_lshlrev_b32 v148, 16, v90
v_and_b32 v149, 0xffff0000, v90
v_lshlrev_b32 v150, 16, v91
v_and_b32 v151, 0xffff0000, v91
v_lshlrev_b32 v152, 16, v92
v_and_b32 v153, 0xffff0000, v92
v_lshlrev_b32 v154, 16, v93
v_and_b32 v155, 0xffff0000, v93
v_lshlrev_b32 v156, 16, v94
v_and_b32 v157, 0xffff0000, v94
v_lshlrev_b32 v158, 16, v95
v_and_b32 v159, 0xffff0000, v95
buffer_load_dwordx4 v[160:163], v233, s[16:19], s62 offen sc1
s_barrier
ds_read_b64_tr_b16 a[128:129], v208 offset:0
ds_read_b64_tr_b16 a[130:131], v208 offset:256
ds_read_b64_tr_b16 a[132:133], v208 offset:14336
ds_read_b64_tr_b16 a[134:135], v208 offset:14592
ds_read_b64_tr_b16 a[136:137], v209 offset:0
ds_read_b64_tr_b16 a[138:139], v209 offset:256
ds_read_b64_tr_b16 a[140:141], v209 offset:14336
ds_read_b64_tr_b16 a[142:143], v209 offset:14592
ds_read_b64_tr_b16 a[144:145], v208 offset:1024
ds_read_b64_tr_b16 a[146:147], v208 offset:1280
ds_read_b64_tr_b16 a[148:149], v208 offset:15360
ds_read_b64_tr_b16 a[150:151], v208 offset:15616
ds_read_b64_tr_b16 a[152:153], v209 offset:1024
ds_read_b64_tr_b16 a[154:155], v209 offset:1280
ds_read_b64_tr_b16 a[156:157], v209 offset:15360
ds_read_b64_tr_b16 a[158:159], v209 offset:15616
ds_read_b64_tr_b16 a[160:161], v208 offset:2048
ds_read_b64_tr_b16 a[162:163], v208 offset:2304
ds_read_b64_tr_b16 a[164:165], v208 offset:16384
ds_read_b64_tr_b16 a[166:167], v208 offset:16640
ds_read_b64_tr_b16 a[168:169], v209 offset:2048
ds_read_b64_tr_b16 a[170:171], v209 offset:2304
ds_read_b64_tr_b16 a[172:173], v209 offset:16384
ds_read_b64_tr_b16 a[174:175], v209 offset:16640
ds_read_b64_tr_b16 a[176:177], v210 offset:0
ds_read_b64_tr_b16 a[178:179], v210 offset:1024
ds_read_b64_tr_b16 a[180:181], v210 offset:14336
ds_read_b64_tr_b16 a[182:183], v210 offset:15360
s_waitcnt vmcnt(0)
buffer_store_dwordx2 v[238:239], v237, s[16:19], s34 offen sc1
s_mov_b32 s49, 262144
v_cmp_ne_u32 vcc, s36, v161
v_cmp_ne_u32 s[44:45], s37, v163
s_nop 0
s_or_b64 vcc, vcc, s[44:45]
s_cbranch_vccz Lgr_ok
Lgr_sp:
buffer_load_dwordx4 v[160:163], v233, s[16:19], s62 offen sc1
s_sub_u32 s49, s49, 1
s_waitcnt vmcnt(0)
v_cmp_ne_u32 vcc, s36, v161
v_cmp_ne_u32 s[44:45], s37, v163
s_nop 0
s_or_b64 vcc, vcc, s[44:45]
s_cmp_eq_u32 s49, 0
s_cbranch_scc1 Lgr_ok
s_cbranch_vccnz Lgr_sp
Lgr_ok:
s_add_u32 m0, s56, 28672
s_bfe_u32 s55, s58, 0x40004
s_mul_i32 s50, s55, 393216
s_mul_i32 s51, s55, 458752
buffer_load_dwordx4 v226, s[8:11], s50 offen offset:0 lds
buffer_load_dwordx4 v227, s[8:11], s50 offen offset:1024 lds
buffer_load_dwordx4 v228, s[8:11], s50 offen offset:2048 lds
s_add_u32 m0, s56, 31744
s_nop 0
buffer_load_dwordx4 v229, s[12:15], s51 offen offset:0 lds
buffer_load_dwordx4 v230, s[12:15], s51 offen offset:1024 lds
buffer_load_dwordx4 v231, s[12:15], s51 offen offset:2048 lds
buffer_load_dwordx4 v232, s[12:15], s51 offen offset:3072 lds
v_mov_b32 v168, v160
v_mov_b32 v170, v160
v_mov_b32 v169, v162
v_mov_b32 v171, v162
v_permlane16_swap_b32 v168, v170
s_nop 0
v_permlane16_swap_b32 v169, v171
v_mov_b32 v172, v168
v_mov_b32 v173, v169
v_mov_b32 v174, v170
v_mov_b32 v175, v171
v_permlane32_swap_b32 v168, v172
v_permlane32_swap_b32 v169, v173
v_permlane32_swap_b32 v170, v174
v_permlane32_swap_b32 v171, v175
v_pk_fma_f32 v[96:97], v[96:97], v[168:169], v[168:169] op_sel:[0,1,0] op_sel_hi:[1,1,0]
v_pk_fma_f32 v[98:99], v[98:99], v[168:169], v[168:169] op_sel:[0,1,0] op_sel_hi:[1,1,0]
v_pk_fma_f32 v[100:101], v[100:101], v[168:169], v[168:169] op_sel:[0,1,0] op_sel_hi:[1,1,0]
v_pk_fma_f32 v[102:103], v[102:103], v[168:169], v[168:169] op_sel:[0,1,0] op_sel_hi:[1,1,0]
v_pk_fma_f32 v[104:105], v[104:105], v[168:169], v[168:169] op_sel:[0,1,0] op_sel_hi:[1,1,0]
v_pk_fma_f32 v[106:107], v[106:107], v[168:169], v[168:169] op_sel:[0,1,0] op_sel_hi:[1,1,0]
v_pk_fma_f32 v[108:109], v[108:109], v[168:169], v[168:169] op_sel:[0,1,0] op_sel_hi:[1,1,0]
v_pk_fma_f32 v[110:111], v[110:111], v[168:169], v[168:169] op_sel:[0,1,0] op_sel_hi:[1,1,0]
v_cvt_pk_bf16_f32 v64, v96, v97
v_cvt_pk_bf16_f32 v65, v98, v99
v_cvt_pk_bf16_f32 v66, v100, v101
v_cvt_pk_bf16_f32 v67, v102, v103
v_cvt_pk_bf16_f32 v68, v104, v105
v_cvt_pk_bf16_f32 v69, v106, v107
v_cvt_pk_bf16_f32 v70, v108, v109
v_cvt_pk_bf16_f32 v71, v110, v111
v_accvgpr_write_b32 a0, v64
v_accvgpr_write_b32 a1, v65
v_accvgpr_write_b32 a2, v66
v_accvgpr_write_b32 a3, v67
v_accvgpr_write_b32 a16, v68
v_accvgpr_write_b32 a17, v69
v_accvgpr_write_b32 a18, v70
v_accvgpr_write_b32 a19, v71
v_pk_fma_f32 v[112:113], v[112:113], v[170:171], v[170:171] op_sel:[0,1,0] op_sel_hi:[1,1,0]
v_pk_fma_f32 v[114:115], v[114:115], v[170:171], v[170:171] op_sel:[0,1,0] op_sel_hi:[1,1,0]
v_pk_fma_f32 v[116:117], v[116:117], v[170:171], v[170:171] op_sel:[0,1,0] op_sel_hi:[1,1,0]
v_pk_fma_f32 v[118:119], v[118:119], v[170:171], v[170:171] op_sel:[0,1,0] op_sel_hi:[1,1,0]
v_pk_fma_f32 v[120:121], v[120:121], v[170:171], v[170:171] op_sel:[0,1,0] op_sel_hi:[1,1,0]
v_pk_fma_f32 v[122:123], v[122:123], v[170:171], v[170:171] op_sel:[0,1,0] op_sel_hi:[1,1,0]
v_pk_fma_f32 v[124:125], v[124:125], v[170:171], v[170:171] op_sel:[0,1,0] op_sel_hi:[1,1,0]
v_pk_fma_f32 v[126:127], v[126:127], v[170:171], v[170:171] op_sel:[0,1,0] op_sel_hi:[1,1,0]
v_cvt_pk_bf16_f32 v72, v112, v113
v_cvt_pk_bf16_f32 v73, v114, v115
v_cvt_pk_bf16_f32 v74, v116, v117
v_cvt_pk_bf16_f32 v75, v118, v119
v_cvt_pk_bf16_f32 v76, v120, v121
v_cvt_pk_bf16_f32 v77, v122, v123
v_cvt_pk_bf16_f32 v78, v124, v125
v_cvt_pk_bf16_f32 v79, v126, v127
v_accvgpr_write_b32 a4, v72
v_accvgpr_write_b32 a5, v73
v_accvgpr_write_b32 a6, v74
v_accvgpr_write_b32 a7, v75
v_accvgpr_write_b32 a20, v76
v_accvgpr_write_b32 a21, v77
v_accvgpr_write_b32 a22, v78
v_accvgpr_write_b32 a23, v79
v_pk_fma_f32 v[128:129], v[128:129], v[172:173], v[172:173] op_sel:[0,1,0] op_sel_hi:[1,1,0]
v_pk_fma_f32 v[130:131], v[130:131], v[172:173], v[172:173] op_sel:[0,1,0] op_sel_hi:[1,1,0]
v_pk_fma_f32 v[132:133], v[132:133], v[172:173], v[172:173] op_sel:[0,1,0] op_sel_hi:[1,1,0]
v_pk_fma_f32 v[134:135], v[134:135], v[172:173], v[172:173] op_sel:[0,1,0] op_sel_hi:[1,1,0]
v_pk_fma_f32 v[136:137], v[136:137], v[172:173], v[172:173] op_sel:[0,1,0] op_sel_hi:[1,1,0]
v_pk_fma_f32 v[138:139], v[138:139], v[172:173], v[172:173] op_sel:[0,1,0] op_sel_hi:[1,1,0]
v_pk_fma_f32 v[140:141], v[140:141], v[172:173], v[172:173] op_sel:[0,1,0] op_sel_hi:[1,1,0]
v_pk_fma_f32 v[142:143], v[142:143], v[172:173], v[172:173] op_sel:[0,1,0] op_sel_hi:[1,1,0]
v_cvt_pk_bf16_f32 v80, v128, v129
v_cvt_pk_bf16_f32 v81, v130, v131
v_cvt_pk_bf16_f32 v82, v132, v133
v_cvt_pk_bf16_f32 v83, v134, v135
v_cvt_pk_bf16_f32 v84, v136, v137
v_cvt_pk_bf16_f32 v85, v138, v139
v_cvt_pk_bf16_f32 v86, v140, v141
v_cvt_pk_bf16_f32 v87, v142, v143
v_accvgpr_write_b32 a8, v80
v_accvgpr_write_b32 a9, v81
v_accvgpr_write_b32 a10, v82
v_accvgpr_write_b32 a11, v83
v_accvgpr_write_b32 a24, v84
v_accvgpr_write_b32 a25, v85
v_accvgpr_write_b32 a26, v86
v_accvgpr_write_b32 a27, v87
v_pk_fma_f32 v[144:145], v[144:145], v[174:175], v[174:175] op_sel:[0,1,0] op_sel_hi:[1,1,0]
v_pk_fma_f32 v[146:147], v[146:147], v[174:175], v[174:175] op_sel:[0,1,0] op_sel_hi:[1,1,0]
v_pk_fma_f32 v[148:149], v[148:149], v[174:175], v[174:175] op_sel:[0,1,0] op_sel_hi:[1,1,0]
v_pk_fma_f32 v[150:151], v[150:151], v[174:175], v[174:175] op_sel:[0,1,0] op_sel_hi:[1,1,0]
v_pk_fma_f32 v[152:153], v[152:153], v[174:175], v[174:175] op_sel:[0,1,0] op_sel_hi:[1,1,0]
v_pk_fma_f32 v[154:155], v[154:155], v[174:175], v[174:175] op_sel:[0,1,0] op_sel_hi:[1,1,0]
v_pk_fma_f32 v[156:157], v[156:157], v[174:175], v[174:175] op_sel:[0,1,0] op_sel_hi:[1,1,0]
v_pk_fma_f32 v[158:159], v[158:159], v[174:175], v[174:175] op_sel:[0,1,0] op_sel_hi:[1,1,0]
v_cvt_pk_bf16_f32 v88, v144, v145
v_cvt_pk_bf16_f32 v89, v146, v147
v_cvt_pk_bf16_f32 v90, v148, v149
v_cvt_pk_bf16_f32 v91, v150, v151
v_cvt_pk_bf16_f32 v92, v152, v153
v_cvt_pk_bf16_f32 v93, v154, v155
v_cvt_pk_bf16_f32 v94, v156, v157
v_cvt_pk_bf16_f32 v95, v158, v159
v_accvgpr_write_b32 a12, v88
v_accvgpr_write_b32 a13, v89
v_accvgpr_write_b32 a14, v90
v_accvgpr_write_b32 a15, v91
v_accvgpr_write_b32 a28, v92
v_accvgpr_write_b32 a29, v93
v_accvgpr_write_b32 a30, v94
v_accvgpr_write_b32 a31, v95
s_branch Lmain
.p2align 12
Lmain:
Lpad0:
s_cbranch_execz Lpad4
s_waitcnt lgkmcnt(0)
v_mfma_f32_16x16x32_bf16 v[0:3], a[128:131], a[0:3], 0
s_add_u32 m0, s56, 57344
ds_read_b64_tr_b16 a[184:185], v211 offset:0
v_mfma_f32_16x16x32_bf16 v[0:3], a[132:135], a[16:19], v[0:3]
s_bfe_u32 s55, s58, 0x40008
ds_read_b64_tr_b16 a[186:187], v211 offset:1024
v_mfma_f32_16x16x32_bf16 v[4:7], a[128:131], a[4:7], 0
s_mul_i32 s50, s55, 393216
v_mfma_f32_16x16x32_bf16 v[4:7], a[132:135], a[20:23], v[4:7]
s_mul_i32 s51, s55, 458752
buffer_load_dwordx4 v226, s[8:11], s50 offen offset:0 lds
v_mfma_f32_16x16x32_bf16 v[8:11], a[128:131], a[8:11], 0
s_add_u32 m0, s56, 60416
s_nop 0
buffer_load_dwordx4 v229, s[12:15], s51 offen offset:0 lds
v_mfma_f32_16x16x32_bf16 v[8:11], a[132:135], a[24:27], v[8:11]
s_lshl_b32 s42, s32, 3
buffer_load_dwordx4 v230, s[12:15], s51 offen offset:1024 lds
v_mfma_f32_16x16x32_bf16 v[12:15], a[128:131], a[12:15], 0
s_add_u32 m0, s56, 57344
ds_read_b64_tr_b16 a[188:189], v211 offset:14336
ds_read_b64_tr_b16 a[190:191], v211 offset:15360
v_mfma_f32_16x16x32_bf16 v[12:15], a[132:135], a[28:31], v[12:15]
s_lshr_b32 s45, s33, 2
ds_read_b64_tr_b16 a[192:193], v212 offset:0
v_mfma_f32_16x16x32_bf16 v[16:19], a[136:139], a[0:3], 0
s_add_u32 s42, s42, s45
buffer_load_dwordx4 v227, s[8:11], s50 offen offset:1024 lds
v_mfma_f32_16x16x32_bf16 v[16:19], a[140:143], a[16:19], v[16:19]
s_add_u32 m0, s56, 60416
ds_read_b64_tr_b16 a[194:195], v212 offset:1024
v_mfma_f32_16x16x32_bf16 v[20:23], a[136:139], a[4:7], 0
s_lshl_b32 s42, s42, 2
v_mfma_f32_16x16x32_bf16 v[20:23], a[140:143], a[20:23], v[20:23]
buffer_load_dwordx4 v231, s[12:15], s51 offen offset:2048 lds
v_mfma_f32_16x16x32_bf16 v[24:27], a[136:139], a[8:11], 0
s_add_u32 m0, s56, 57344
ds_read_b64_tr_b16 a[196:197], v212 offset:14336
v_mfma_f32_16x16x32_bf16 v[24:27], a[140:143], a[24:27], v[24:27]
ds_read_b64_tr_b16 a[198:199], v212 offset:15360
v_mfma_f32_16x16x32_bf16 v[28:31], a[136:139], a[12:15], 0
s_add_u32 s42, s42, s3
buffer_load_dwordx4 v228, s[8:11], s50 offen offset:2048 lds
v_mfma_f32_16x16x32_bf16 v[28:31], a[140:143], a[28:31], v[28:31]
s_add_u32 m0, s56, 60416
ds_read_b64_tr_b16 a[200:201], v213 offset:0
v_mfma_f32_16x16x32_bf16 v[32:35], a[144:147], a[0:3], 0
v_mfma_f32_16x16x32_bf16 v[32:35], a[148:151], a[16:19], v[32:35]
buffer_load_dwordx4 v232, s[12:15], s51 offen offset:3072 lds
v_mfma_f32_16x16x32_bf16 v[36:39], a[144:147], a[4:7], 0
s_lshl_b32 s45, s48, 8
ds_read_b64_tr_b16 a[202:203], v213 offset:1024
v_mfma_f32_16x16x32_bf16 v[36:39], a[148:151], a[20:23], v[36:39]
ds_read_b64_tr_b16 a[204:205], v213 offset:14336
v_mfma_f32_16x16x32_bf16 v[40:43], a[144:147], a[8:11], 0
v_mfma_f32_16x16x32_bf16 v[40:43], a[148:151], a[24:27], v[40:43]
s_add_u32 s42, s42, s45
ds_read_b64_tr_b16 a[206:207], v213 offset:15360
v_mfma_f32_16x16x32_bf16 v[44:47], a[144:147], a[12:15], 0
v_mfma_f32_16x16x32_bf16 v[44:47], a[148:151], a[28:31], v[44:47]
ds_read_b64_tr_b16 a[208:209], v214 offset:0
v_mfma_f32_16x16x32_bf16 v[48:51], a[152:155], a[0:3], 0
ds_read_b64_tr_b16 a[210:211], v214 offset:1024
v_mfma_f32_16x16x32_bf16 v[48:51], a[156:159], a[16:19], v[48:51]
s_mul_i32 s60, s42, 3072
v_mfma_f32_16x16x32_bf16 v[52:55], a[152:155], a[4:7], 0
ds_read_b64_tr_b16 a[212:213], v214 offset:14336
v_mfma_f32_16x16x32_bf16 v[52:55], a[156:159], a[20:23], v[52:55]
v_mfma_f32_16x16x32_bf16 v[56:59], a[152:155], a[8:11], 0
s_add_u32 s60, s60, 3145728
ds_read_b64_tr_b16 a[214:215], v214 offset:15360
v_mfma_f32_16x16x32_bf16 v[56:59], a[156:159], a[24:27], v[56:59]
v_mfma_f32_16x16x32_bf16 v[60:63], a[152:155], a[12:15], 0
ds_read_b64_tr_b16 a[216:217], v215 offset:0
v_mfma_f32_16x16x32_bf16 v[60:63], a[156:159], a[28:31], v[60:63]
v_mfma_f32_16x16x32_bf16 v[64:67], a[0:3], a[160:163], 0
s_mul_i32 s61, s42, 3584
ds_read_b64_tr_b16 a[218:219], v215 offset:1024
v_mfma_f32_16x16x32_bf16 v[64:67], a[16:19], a[164:167], v[64:67]
v_mfma_f32_16x16x32_bf16 v[68:71], a[4:7], a[160:163], 0
ds_read_b64_tr_b16 a[220:221], v215 offset:14336
v_mfma_f32_16x16x32_bf16 v[68:71], a[20:23], a[164:167], v[68:71]
v_mfma_f32_16x16x32_bf16 v[72:75], a[8:11], a[160:163], 0
s_add_u32 s61, s61, 3670016
ds_read_b64_tr_b16 a[222:223], v215 offset:15360
v_mfma_f32_16x16x32_bf16 v[72:75], a[24:27], a[164:167], v[72:75]
v_mfma_f32_16x16x32_bf16 v[76:79], a[12:15], a[160:163], 0
ds_read_b64_tr_b16 a[224:225], v216 offset:0
v_mfma_f32_16x16x32_bf16 v[76:79], a[28:31], a[164:167], v[76:79]
s_lshl_b32 s75, s47, 14
v_mfma_f32_16x16x32_bf16 v[80:83], a[0:3], a[168:171], 0
ds_read_b64_tr_b16 a[226:227], v216 offset:1024
v_mfma_f32_16x16x32_bf16 v[80:83], a[16:19], a[172:175], v[80:83]
v_mfma_f32_16x16x32_bf16 v[84:87], a[4:7], a[168:171], 0
ds_read_b64_tr_b16 a[228:229], v216 offset:14336
buffer_load_dwordx2 v[246:247], v235, s[16:19], s57 offen sc1
v_mfma_f32_16x16x32_bf16 v[84:87], a[20:23], a[172:175], v[84:87]
s_add_u32 s74, s75, 31457280
v_mfma_f32_16x16x32_bf16 v[88:91], a[8:11], a[168:171], 0
ds_read_b64_tr_b16 a[230:231], v216 offset:15360
v_mfma_f32_16x16x32_bf16 v[88:91], a[24:27], a[172:175], v[88:91]
v_mfma_f32_16x16x32_bf16 v[92:95], a[12:15], a[168:171], 0
s_mul_i32 s46, s42, 7168
v_mfma_f32_16x16x32_bf16 v[92:95], a[28:31], a[172:175], v[92:95]
v_mfma_f32_16x16x32_bf16 v[96:99], a[176:179], a[0:3], 0
v_mfma_f32_16x16x32_bf16 v[96:99], a[180:183], a[16:19], v[96:99]
v_mfma_f32_16x16x32_bf16 v[100:103], a[176:179], a[4:7], 0
s_lshl_b32 s47, s42, 11
v_mfma_f32_16x16x32_bf16 v[100:103], a[180:183], a[20:23], v[100:103]
v_mfma_f32_16x16x32_bf16 v[104:107], a[176:179], a[8:11], 0
v_mfma_f32_16x16x32_bf16 v[104:107], a[180:183], a[24:27], v[104:107]
v_mfma_f32_16x16x32_bf16 v[108:111], a[176:179], a[12:15], 0
v_mfma_f32_16x16x32_bf16 v[108:111], a[180:183], a[28:31], v[108:111]
s_waitcnt vmcnt(8) lgkmcnt(0)
s_barrier
v_mfma_f32_16x16x32_bf16 v[112:115], a[184:187], a[0:3], 0
ds_read_b64_tr_b16 a[128:129], v208 offset:28672
v_mfma_f32_16x16x32_bf16 v[112:115], a[188:191], a[16:19], v[112:115]
ds_read_b64_tr_b16 a[130:131], v208 offset:28928
v_mfma_f32_16x16x32_bf16 v[116:119], a[184:187], a[4:7], 0
ds_read_b64_tr_b16 a[132:133], v208 offset:43008
v_mfma_f32_16x16x32_bf16 v[116:119], a[188:191], a[20:23], v[116:119]
v_mfma_f32_16x16x32_bf16 v[120:123], a[184:187], a[8:11], 0
ds_read_b64_tr_b16 a[134:135], v208 offset:43264
v_mfma_f32_16x16x32_bf16 v[120:123], a[188:191], a[24:27], v[120:123]
ds_read_b64_tr_b16 a[136:137], v209 offset:28672
v_mfma_f32_16x16x32_bf16 v[124:127], a[184:187], a[12:15], 0
ds_read_b64_tr_b16 a[138:139], v209 offset:28928
v_mfma_f32_16x16x32_bf16 v[124:127], a[188:191], a[28:31], v[124:127]
s_waitcnt vmcnt(0)
v_cmp_ne_u64 vcc, s[36:37], v[246:247]
s_mov_b32 s49, 262144
s_cbranch_vccnz Lsp2
Lok1:
s_bfe_u32 s52, s58, 0x40004
s_lshl_b32 s52, s52, 13
s_add_u32 s52, s52, s54
s_add_u32 s53, s52, 4096
buffer_load_dwordx4 a[32:35], v233, s[16:19], s52 offen offset:0 sc1
buffer_load_dwordx4 a[48:51], v233, s[16:19], s52 offen offset:1024 sc1
buffer_load_dwordx4 a[36:39], v233, s[16:19], s52 offen offset:2048 sc1
buffer_load_dwordx4 a[52:55], v233, s[16:19], s52 offen offset:3072 sc1
v_mfma_f32_16x16x32_bf16 v[128:131], a[192:195], a[0:3], 0
buffer_load_dwordx4 a[40:43], v233, s[16:19], s53 offen offset:0 sc1
v_mfma_f32_16x16x32_bf16 v[128:131], a[196:199], a[16:19], v[128:131]
buffer_load_dwordx4 a[56:59], v233, s[16:19], s53 offen offset:1024 sc1
v_mfma_f32_16x16x32_bf16 v[132:135], a[192:195], a[4:7], 0
buffer_load_dwordx4 a[44:47], v233, s[16:19], s53 offen offset:2048 sc1
v_mfma_f32_16x16x32_bf16 v[132:135], a[196:199], a[20:23], v[132:135]
buffer_load_dwordx4 a[60:63], v233, s[16:19], s53 offen offset:3072 sc1
v_mfma_f32_16x16x32_bf16 v[136:139], a[192:195], a[8:11], 0
ds_read_b64_tr_b16 a[140:141], v209 offset:43008
ds_read_b64_tr_b16 a[142:143], v209 offset:43264
v_mfma_f32_16x16x32_bf16 v[136:139], a[196:199], a[24:27], v[136:139]
ds_read_b64_tr_b16 a[144:145], v208 offset:29696
ds_read_b64_tr_b16 a[146:147], v208 offset:29952
v_mfma_f32_16x16x32_bf16 v[140:143], a[192:195], a[12:15], 0
ds_read_b64_tr_b16 a[148:149], v208 offset:44032
ds_read_b64_tr_b16 a[150:151], v208 offset:44288
v_mfma_f32_16x16x32_bf16 v[140:143], a[196:199], a[28:31], v[140:143]
v_mfma_f32_16x16x32_bf16 v[144:147], a[200:203], a[0:3], 0
ds_read_b64_tr_b16 a[152:153], v209 offset:29696
v_mfma_f32_16x16x32_bf16 v[144:147], a[204:207], a[16:19], v[144:147]
ds_read_b64_tr_b16 a[154:155], v209 offset:29952
v_mfma_f32_16x16x32_bf16 v[148:151], a[200:203], a[4:7], 0
v_mfma_f32_16x16x32_bf16 v[148:151], a[204:207], a[20:23], v[148:151]
ds_read_b64_tr_b16 a[156:157], v209 offset:44032
v_mfma_f32_16x16x32_bf16 v[152:155], a[200:203], a[8:11], 0
ds_read_b64_tr_b16 a[158:159], v209 offset:44288
v_mfma_f32_16x16x32_bf16 v[152:155], a[204:207], a[24:27], v[152:155]
ds_read_b64_tr_b16 a[160:161], v208 offset:30720
v_mfma_f32_16x16x32_bf16 v[156:159], a[200:203], a[12:15], 0
v_mfma_f32_16x16x32_bf16 v[156:159], a[204:207], a[28:31], v[156:159]
ds_read_b64_tr_b16 a[162:163], v208 offset:30976
v_mfma_f32_16x16x32_bf16 v[160:163], a[208:211], a[0:3], 0
ds_read_b64_tr_b16 a[164:165], v208 offset:45056
v_mfma_f32_16x16x32_bf16 v[160:163], a[212:215], a[16:19], v[160:163]
ds_read_b64_tr_b16 a[166:167], v208 offset:45312
v_mfma_f32_16x16x32_bf16 v[164:167], a[208:211], a[4:7], 0
v_mfma_f32_16x16x32_bf16 v[164:167], a[212:215], a[20:23], v[164:167]
ds_read_b64_tr_b16 a[168:169], v209 offset:30720
v_mfma_f32_16x16x32_bf16 v[168:171], a[208:211], a[8:11], 0
ds_read_b64_tr_b16 a[170:171], v209 offset:30976
v_mfma_f32_16x16x32_bf16 v[168:171], a[212:215], a[24:27], v[168:171]
ds_read_b64_tr_b16 a[172:173], v209 offset:45056
v_mfma_f32_16x16x32_bf16 v[172:175], a[208:211], a[12:15], 0
v_mfma_f32_16x16x32_bf16 v[172:175], a[212:215], a[28:31], v[172:175]
ds_read_b64_tr_b16 a[174:175], v209 offset:45312
v_mfma_f32_16x16x32_bf16 v[176:179], a[216:219], a[0:3], 0
ds_read_b64_tr_b16 a[176:177], v210 offset:28672
v_mfma_f32_16x16x32_bf16 v[176:179], a[220:223], a[16:19], v[176:179]
ds_read_b64_tr_b16 a[178:179], v210 offset:29696
v_mfma_f32_16x16x32_bf16 v[180:183], a[216:219], a[4:7], 0
v_mfma_f32_16x16x32_bf16 v[180:183], a[220:223], a[20:23], v[180:183]
ds_read_b64_tr_b16 a[180:181], v210 offset:43008
v_mfma_f32_16x16x32_bf16 v[184:187], a[216:219], a[8:11], 0
ds_read_b64_tr_b16 a[182:183], v210 offset:44032
v_mfma_f32_16x16x32_bf16 v[184:187], a[220:223], a[24:27], v[184:187]
v_mfma_f32_16x16x32_bf16 v[188:191], a[216:219], a[12:15], 0
v_mfma_f32_16x16x32_bf16 v[188:191], a[220:223], a[28:31], v[188:191]
v_mfma_f32_16x16x32_bf16 v[192:195], a[224:227], a[0:3], 0
v_mfma_f32_16x16x32_bf16 v[192:195], a[228:231], a[16:19], v[192:195]
v_mfma_f32_16x16x32_bf16 v[196:199], a[224:227], a[4:7], 0
v_mfma_f32_16x16x32_bf16 v[196:199], a[228:231], a[20:23], v[196:199]
v_mfma_f32_16x16x32_bf16 v[200:203], a[224:227], a[8:11], 0
v_mfma_f32_16x16x32_bf16 v[200:203], a[228:231], a[24:27], v[200:203]
v_mfma_f32_16x16x32_bf16 v[204:207], a[224:227], a[12:15], 0
v_mfma_f32_16x16x32_bf16 v[204:207], a[228:231], a[28:31], v[204:207]
s_waitcnt vmcnt(0) lgkmcnt(0)
v_mfma_f32_16x16x32_bf16 v[0:3], a[128:131], a[32:35], v[0:3]
s_bfe_u32 s52, s58, 0x40008
ds_read_b64_tr_b16 a[184:185], v211 offset:28672
v_mfma_f32_16x16x32_bf16 v[0:3], a[132:135], a[48:51], v[0:3]
s_lshl_b32 s52, s52, 13
ds_read_b64_tr_b16 a[186:187], v211 offset:29696
v_mfma_f32_16x16x32_bf16 v[4:7], a[132:135], a[52:55], v[4:7]
s_add_u32 s52, s52, s54
v_mfma_f32_16x16x32_bf16 v[4:7], a[128:131], a[36:39], v[4:7]
s_add_u32 s53, s52, 4096
buffer_load_dwordx4 a[64:67], v233, s[16:19], s52 offen offset:0 sc1
v_mfma_f32_16x16x32_bf16 v[8:11], a[128:131], a[40:43], v[8:11]
ds_read_b64_tr_b16 a[188:189], v211 offset:43008
v_mfma_f32_16x16x32_bf16 v[8:11], a[132:135], a[56:59], v[8:11]
ds_read_b64_tr_b16 a[190:191], v211 offset:44032
v_mfma_f32_16x16x32_bf16 v[12:15], a[132:135], a[60:63], v[12:15]
buffer_load_dwordx4 a[80:83], v233, s[16:19], s52 offen offset:1024 sc1
v_mfma_f32_16x16x32_bf16 v[12:15], a[128:131], a[44:47], v[12:15]
ds_read_b64_tr_b16 a[192:193], v212 offset:28672
v_mfma_f32_16x16x32_bf16 v[16:19], a[136:139], a[32:35], v[16:19]
v_mfma_f32_16x16x32_bf16 v[16:19], a[140:143], a[48:51], v[16:19]
ds_read_b64_tr_b16 a[194:195], v212 offset:29696
v_mfma_f32_16x16x32_bf16 v[20:23], a[140:143], a[52:55], v[20:23]
v_mfma_f32_16x16x32_bf16 v[20:23], a[136:139], a[36:39], v[20:23]
ds_read_b64_tr_b16 a[196:197], v212 offset:43008
v_mfma_f32_16x16x32_bf16 v[24:27], a[136:139], a[40:43], v[24:27]
buffer_load_dwordx4 a[68:71], v233, s[16:19], s52 offen offset:2048 sc1
v_mfma_f32_16x16x32_bf16 v[24:27], a[140:143], a[56:59], v[24:27]
ds_read_b64_tr_b16 a[198:199], v212 offset:44032
v_mfma_f32_16x16x32_bf16 v[28:31], a[140:143], a[60:63], v[28:31]
v_mfma_f32_16x16x32_bf16 v[28:31], a[136:139], a[44:47], v[28:31]
ds_read_b64_tr_b16 a[200:201], v213 offset:28672
v_mfma_f32_16x16x32_bf16 v[32:35], a[144:147], a[32:35], v[32:35]
v_mfma_f32_16x16x32_bf16 v[32:35], a[148:151], a[48:51], v[32:35]
ds_read_b64_tr_b16 a[202:203], v213 offset:29696
v_mfma_f32_16x16x32_bf16 v[36:39], a[148:151], a[52:55], v[36:39]
buffer_load_dwordx4 a[84:87], v233, s[16:19], s52 offen offset:3072 sc1
v_mfma_f32_16x16x32_bf16 v[36:39], a[144:147], a[36:39], v[36:39]
ds_read_b64_tr_b16 a[204:205], v213 offset:43008
v_mfma_f32_16x16x32_bf16 v[40:43], a[144:147], a[40:43], v[40:43]
v_mfma_f32_16x16x32_bf16 v[40:43], a[148:151], a[56:59], v[40:43]
ds_read_b64_tr_b16 a[206:207], v213 offset:44032
v_mfma_f32_16x16x32_bf16 v[44:47], a[148:151], a[60:63], v[44:47]
v_mfma_f32_16x16x32_bf16 v[44:47], a[144:147], a[44:47], v[44:47]
ds_read_b64_tr_b16 a[208:209], v214 offset:28672
v_mfma_f32_16x16x32_bf16 v[48:51], a[152:155], a[32:35], v[48:51]
buffer_load_dwordx4 a[72:75], v233, s[16:19], s53 offen offset:0 sc1
v_mfma_f32_16x16x32_bf16 v[48:51], a[156:159], a[48:51], v[48:51]
ds_read_b64_tr_b16 a[210:211], v214 offset:29696
v_mfma_f32_16x16x32_bf16 v[52:55], a[156:159], a[52:55], v[52:55]
ds_read_b64_tr_b16 a[212:213], v214 offset:43008
v_mfma_f32_16x16x32_bf16 v[52:55], a[152:155], a[36:39], v[52:55]
v_mfma_f32_16x16x32_bf16 v[56:59], a[152:155], a[40:43], v[56:59]
ds_read_b64_tr_b16 a[214:215], v214 offset:44032
v_mfma_f32_16x16x32_bf16 v[56:59], a[156:159], a[56:59], v[56:59]
v_mfma_f32_16x16x32_bf16 v[60:63], a[156:159], a[60:63], v[60:63]
buffer_load_dwordx4 a[88:91], v233, s[16:19], s53 offen offset:1024 sc1
v_mfma_f32_16x16x32_bf16 v[60:63], a[152:155], a[44:47], v[60:63]
ds_read_b64_tr_b16 a[216:217], v215 offset:28672
v_mfma_f32_16x16x32_bf16 v[64:67], a[32:35], a[160:163], v[64:67]
ds_read_b64_tr_b16 a[218:219], v215 offset:29696
v_mfma_f32_16x16x32_bf16 v[64:67], a[48:51], a[164:167], v[64:67]
v_mfma_f32_16x16x32_bf16 v[68:71], a[52:55], a[164:167], v[68:71]
ds_read_b64_tr_b16 a[220:221], v215 offset:43008
v_mfma_f32_16x16x32_bf16 v[68:71], a[36:39], a[160:163], v[68:71]
v_mfma_f32_16x16x32_bf16 v[72:75], a[40:43], a[160:163], v[72:75]
buffer_load_dwordx4 a[76:79], v233, s[16:19], s53 offen offset:2048 sc1
v_mfma_f32_16x16x32_bf16 v[72:75], a[56:59], a[164:167], v[72:75]
ds_read_b64_tr_b16 a[222:223], v215 offset:44032
v_mfma_f32_16x16x32_bf16 v[76:79], a[60:63], a[164:167], v[76:79]
ds_read_b64_tr_b16 a[224:225], v216 offset:28672
v_mfma_f32_16x16x32_bf16 v[76:79], a[44:47], a[160:163], v[76:79]
v_mfma_f32_16x16x32_bf16 v[80:83], a[32:35], a[168:171], v[80:83]
ds_read_b64_tr_b16 a[226:227], v216 offset:29696
v_mfma_f32_16x16x32_bf16 v[80:83], a[48:51], a[172:175], v[80:83]
v_mfma_f32_16x16x32_bf16 v[84:87], a[52:55], a[172:175], v[84:87]
buffer_load_dwordx4 a[92:95], v233, s[16:19], s53 offen offset:3072 sc1
v_mfma_f32_16x16x32_bf16 v[84:87], a[36:39], a[168:171], v[84:87]
s_add_u32 m0, s56, 86016
ds_read_b64_tr_b16 a[228:229], v216 offset:43008
v_mfma_f32_16x16x32_bf16 v[88:91], a[40:43], a[168:171], v[88:91]
s_bfe_u32 s55, s58, 0x4000c
ds_read_b64_tr_b16 a[230:231], v216 offset:44032
v_mfma_f32_16x16x32_bf16 v[88:91], a[56:59], a[172:175], v[88:91]
s_mul_i32 s50, s55, 393216
v_mfma_f32_16x16x32_bf16 v[92:95], a[60:63], a[172:175], v[92:95]
s_mul_i32 s51, s55, 458752
v_mfma_f32_16x16x32_bf16 v[92:95], a[44:47], a[168:171], v[92:95]
v_mfma_f32_16x16x32_bf16 v[96:99], a[176:179], a[32:35], v[96:99]
buffer_load_dwordx4 v226, s[8:11], s50 offen offset:0 lds
v_mfma_f32_16x16x32_bf16 v[96:99], a[180:183], a[48:51], v[96:99]
v_mfma_f32_16x16x32_bf16 v[100:103], a[180:183], a[52:55], v[100:103]
v_mfma_f32_16x16x32_bf16 v[100:103], a[176:179], a[36:39], v[100:103]
v_mfma_f32_16x16x32_bf16 v[104:107], a[176:179], a[40:43], v[104:107]
v_mfma_f32_16x16x32_bf16 v[104:107], a[180:183], a[56:59], v[104:107]
v_mfma_f32_16x16x32_bf16 v[108:111], a[180:183], a[60:63], v[108:111]
v_mfma_f32_16x16x32_bf16 v[108:111], a[176:179], a[44:47], v[108:111]
s_waitcnt lgkmcnt(0)
s_barrier
v_mfma_f32_16x16x32_bf16 v[112:115], a[184:187], a[32:35], v[112:115]
s_bfe_u32 s52, s58, 0x4000c
ds_read_b64_tr_b16 a[128:129], v217 offset:0
v_mfma_f32_16x16x32_bf16 v[112:115], a[188:191], a[48:51], v[112:115]
s_lshl_b32 s52, s52, 13
ds_read_b64_tr_b16 a[130:131], v217 offset:256
v_mfma_f32_16x16x32_bf16 v[116:119], a[188:191], a[52:55], v[116:119]
s_add_u32 s52, s52, s54
ds_read_b64_tr_b16 a[132:133], v217 offset:14336
v_mfma_f32_16x16x32_bf16 v[116:119], a[184:187], a[36:39], v[116:119]
s_add_u32 s53, s52, 4096
buffer_load_dwordx4 a[96:99], v233, s[16:19], s52 offen offset:0 sc1
v_mfma_f32_16x16x32_bf16 v[120:123], a[184:187], a[40:43], v[120:123]
s_add_u32 m0, s56, 89088
ds_read_b64_tr_b16 a[134:135], v217 offset:14592
v_mfma_f32_16x16x32_bf16 v[120:123], a[188:191], a[56:59], v[120:123]
buffer_load_dwordx4 v229, s[12:15], s51 offen offset:0 lds
v_mfma_f32_16x16x32_bf16 v[124:127], a[188:191], a[60:63], v[124:127]
ds_read_b64_tr_b16 a[136:137], v218 offset:0
ds_read_b64_tr_b16 a[138:139], v218 offset:256
v_mfma_f32_16x16x32_bf16 v[124:127], a[184:187], a[44:47], v[124:127]
v_mfma_f32_16x16x32_bf16 v[128:131], a[192:195], a[32:35], v[128:131]
ds_read_b64_tr_b16 a[140:141], v218 offset:14336
v_mfma_f32_16x16x32_bf16 v[128:131], a[196:199], a[48:51], v[128:131]
ds_read_b64_tr_b16 a[142:143], v218 offset:14592
v_mfma_f32_16x16x32_bf16 v[132:135], a[196:199], a[52:55], v[132:135]
buffer_load_dwordx4 a[112:115], v233, s[16:19], s52 offen offset:1024 sc1
v_mfma_f32_16x16x32_bf16 v[132:135], a[192:195], a[36:39], v[132:135]
ds_read_b64_tr_b16 a[144:145], v217 offset:1024
v_mfma_f32_16x16x32_bf16 v[136:139], a[192:195], a[40:43], v[136:139]
ds_read_b64_tr_b16 a[146:147], v217 offset:1280
v_mfma_f32_16x16x32_bf16 v[136:139], a[196:199], a[56:59], v[136:139]
ds_read_b64_tr_b16 a[148:149], v217 offset:15360
v_mfma_f32_16x16x32_bf16 v[140:143], a[196:199], a[60:63], v[140:143]
ds_read_b64_tr_b16 a[150:151], v217 offset:15616
v_mfma_f32_16x16x32_bf16 v[140:143], a[192:195], a[44:47], v[140:143]
buffer_load_dwordx4 v230, s[12:15], s51 offen offset:1024 lds
v_mfma_f32_16x16x32_bf16 v[144:147], a[200:203], a[32:35], v[144:147]
ds_read_b64_tr_b16 a[152:153], v218 offset:1024
v_mfma_f32_16x16x32_bf16 v[144:147], a[204:207], a[48:51], v[144:147]
ds_read_b64_tr_b16 a[154:155], v218 offset:1280
v_mfma_f32_16x16x32_bf16 v[148:151], a[204:207], a[52:55], v[148:151]
v_mfma_f32_16x16x32_bf16 v[148:151], a[200:203], a[36:39], v[148:151]
ds_read_b64_tr_b16 a[156:157], v218 offset:15360
v_mfma_f32_16x16x32_bf16 v[152:155], a[200:203], a[40:43], v[152:155]
buffer_load_dwordx4 a[100:103], v233, s[16:19], s52 offen offset:2048 sc1
v_mfma_f32_16x16x32_bf16 v[152:155], a[204:207], a[56:59], v[152:155]
s_add_u32 m0, s56, 86016
ds_read_b64_tr_b16 a[158:159], v218 offset:15616
ds_read_b64_tr_b16 a[160:161], v217 offset:2048
v_mfma_f32_16x16x32_bf16 v[156:159], a[204:207], a[60:63], v[156:159]
v_mfma_f32_16x16x32_bf16 v[156:159], a[200:203], a[44:47], v[156:159]
ds_read_b64_tr_b16 a[162:163], v217 offset:2304
v_mfma_f32_16x16x32_bf16 v[160:163], a[208:211], a[32:35], v[160:163]
ds_read_b64_tr_b16 a[164:165], v217 offset:16384
v_mfma_f32_16x16x32_bf16 v[160:163], a[212:215], a[48:51], v[160:163]
buffer_load_dwordx4 v227, s[8:11], s50 offen offset:1024 lds
v_mfma_f32_16x16x32_bf16 v[164:167], a[212:215], a[52:55], v[164:167]
ds_read_b64_tr_b16 a[166:167], v217 offset:16640
v_mfma_f32_16x16x32_bf16 v[164:167], a[208:211], a[36:39], v[164:167]
ds_read_b64_tr_b16 a[168:169], v218 offset:2048
v_mfma_f32_16x16x32_bf16 v[168:171], a[208:211], a[40:43], v[168:171]
ds_read_b64_tr_b16 a[170:171], v218 offset:2304
v_mfma_f32_16x16x32_bf16 v[168:171], a[212:215], a[56:59], v[168:171]
ds_read_b64_tr_b16 a[172:173], v218 offset:16384
v_mfma_f32_16x16x32_bf16 v[172:175], a[212:215], a[60:63], v[172:175]
buffer_load_dwordx4 a[116:119], v233, s[16:19], s52 offen offset:3072 sc1
v_mfma_f32_16x16x32_bf16 v[172:175], a[208:211], a[44:47], v[172:175]
s_add_u32 m0, s56, 89088
ds_read_b64_tr_b16 a[174:175], v218 offset:16640
v_mfma_f32_16x16x32_bf16 v[176:179], a[216:219], a[32:35], v[176:179]
ds_read_b64_tr_b16 a[176:177], v219 offset:0
v_mfma_f32_16x16x32_bf16 v[176:179], a[220:223], a[48:51], v[176:179]
ds_read_b64_tr_b16 a[178:179], v219 offset:1024
v_mfma_f32_16x16x32_bf16 v[180:183], a[220:223], a[52:55], v[180:183]
v_mfma_f32_16x16x32_bf16 v[180:183], a[216:219], a[36:39], v[180:183]
buffer_load_dwordx4 v231, s[12:15], s51 offen offset:2048 lds
v_mfma_f32_16x16x32_bf16 v[184:187], a[216:219], a[40:43], v[184:187]
ds_read_b64_tr_b16 a[180:181], v219 offset:14336
ds_read_b64_tr_b16 a[182:183], v219 offset:15360
v_mfma_f32_16x16x32_bf16 v[184:187], a[220:223], a[56:59], v[184:187]
v_mfma_f32_16x16x32_bf16 v[188:191], a[220:223], a[60:63], v[188:191]
v_mfma_f32_16x16x32_bf16 v[188:191], a[216:219], a[44:47], v[188:191]
v_mfma_f32_16x16x32_bf16 v[192:195], a[224:227], a[32:35], v[192:195]
buffer_load_dwordx4 a[104:107], v233, s[16:19], s53 offen offset:0 sc1
v_mfma_f32_16x16x32_bf16 v[192:195], a[228:231], a[48:51], v[192:195]
v_mfma_f32_16x16x32_bf16 v[196:199], a[228:231], a[52:55], v[196:199]
v_mfma_f32_16x16x32_bf16 v[196:199], a[224:227], a[36:39], v[196:199]
v_mfma_f32_16x16x32_bf16 v[200:203], a[224:227], a[40:43], v[200:203]
v_mfma_f32_16x16x32_bf16 v[200:203], a[228:231], a[56:59], v[200:203]
v_mfma_f32_16x16x32_bf16 v[204:207], a[228:231], a[60:63], v[204:207]
v_mfma_f32_16x16x32_bf16 v[204:207], a[224:227], a[44:47], v[204:207]
s_waitcnt vmcnt(10) lgkmcnt(0)
v_mfma_f32_16x16x32_bf16 v[0:3], a[128:131], a[64:67], v[0:3]
s_add_u32 m0, s56, 86016
s_nop 0
buffer_load_dwordx4 v228, s[8:11], s50 offen offset:2048 lds
v_mfma_f32_16x16x32_bf16 v[0:3], a[132:135], a[80:83], v[0:3]
ds_read_b64_tr_b16 a[184:185], v220 offset:0
ds_read_b64_tr_b16 a[186:187], v220 offset:1024
v_mfma_f32_16x16x32_bf16 v[4:7], a[132:135], a[84:87], v[4:7]
v_mfma_f32_16x16x32_bf16 v[4:7], a[128:131], a[68:71], v[4:7]
ds_read_b64_tr_b16 a[188:189], v220 offset:14336
v_mfma_f32_16x16x32_bf16 v[8:11], a[128:131], a[72:75], v[8:11]
v_mfma_f32_16x16x32_bf16 v[8:11], a[132:135], a[88:91], v[8:11]
ds_read_b64_tr_b16 a[190:191], v220 offset:15360
v_mfma_f32_16x16x32_bf16 v[12:15], a[132:135], a[92:95], v[12:15]
buffer_load_dwordx4 a[120:123], v233, s[16:19], s53 offen offset:1024 sc1
v_mfma_f32_16x16x32_bf16 v[12:15], a[128:131], a[76:79], v[12:15]
s_add_u32 m0, s56, 89088
ds_read_b64_tr_b16 a[192:193], v221 offset:0
v_mfma_f32_16x16x32_bf16 v[16:19], a[136:139], a[64:67], v[16:19]
v_mfma_f32_16x16x32_bf16 v[16:19], a[140:143], a[80:83], v[16:19]
ds_read_b64_tr_b16 a[194:195], v221 offset:1024
v_mfma_f32_16x16x32_bf16 v[20:23], a[140:143], a[84:87], v[20:23]
v_mfma_f32_16x16x32_bf16 v[20:23], a[136:139], a[68:71], v[20:23]
ds_read_b64_tr_b16 a[196:197], v221 offset:14336
v_mfma_f32_16x16x32_bf16 v[24:27], a[136:139], a[72:75], v[24:27]
buffer_load_dwordx4 v232, s[12:15], s51 offen offset:3072 lds
v_mfma_f32_16x16x32_bf16 v[24:27], a[140:143], a[88:91], v[24:27]
ds_read_b64_tr_b16 a[198:199], v221 offset:15360
v_mfma_f32_16x16x32_bf16 v[28:31], a[140:143], a[92:95], v[28:31]
v_mfma_f32_16x16x32_bf16 v[28:31], a[136:139], a[76:79], v[28:31]
ds_read_b64_tr_b16 a[200:201], v222 offset:0
v_mfma_f32_16x16x32_bf16 v[32:35], a[144:147], a[64:67], v[32:35]
v_mfma_f32_16x16x32_bf16 v[32:35], a[148:151], a[80:83], v[32:35]
ds_read_b64_tr_b16 a[202:203], v222 offset:1024
v_mfma_f32_16x16x32_bf16 v[36:39], a[148:151], a[84:87], v[36:39]
buffer_load_dwordx4 a[108:111], v233, s[16:19], s53 offen offset:2048 sc1
v_mfma_f32_16x16x32_bf16 v[36:39], a[144:147], a[68:71], v[36:39]
ds_read_b64_tr_b16 a[204:205], v222 offset:14336
v_mfma_f32_16x16x32_bf16 v[40:43], a[144:147], a[72:75], v[40:43]
v_mfma_f32_16x16x32_bf16 v[40:43], a[148:151], a[88:91], v[40:43]
ds_read_b64_tr_b16 a[206:207], v222 offset:15360
v_mfma_f32_16x16x32_bf16 v[44:47], a[148:151], a[92:95], v[44:47]
v_mfma_f32_16x16x32_bf16 v[44:47], a[144:147], a[76:79], v[44:47]
ds_read_b64_tr_b16 a[208:209], v223 offset:0
v_mfma_f32_16x16x32_bf16 v[48:51], a[152:155], a[64:67], v[48:51]
buffer_load_dwordx4 a[124:127], v233, s[16:19], s53 offen offset:3072 sc1
v_mfma_f32_16x16x32_bf16 v[48:51], a[156:159], a[80:83], v[48:51]
s_add_u32 m0, s56, 0
ds_read_b64_tr_b16 a[210:211], v223 offset:1024
v_mfma_f32_16x16x32_bf16 v[52:55], a[156:159], a[84:87], v[52:55]
s_bfe_u32 s55, s58, 0x40010
ds_read_b64_tr_b16 a[212:213], v223 offset:14336
v_mfma_f32_16x16x32_bf16 v[52:55], a[152:155], a[68:71], v[52:55]
s_mul_i32 s50, s55, 393216
v_mfma_f32_16x16x32_bf16 v[56:59], a[152:155], a[72:75], v[56:59]
s_mul_i32 s51, s55, 458752
ds_read_b64_tr_b16 a[214:215], v223 offset:15360
v_mfma_f32_16x16x32_bf16 v[56:59], a[156:159], a[88:91], v[56:59]
v_mfma_f32_16x16x32_bf16 v[60:63], a[156:159], a[92:95], v[60:63]
buffer_load_dwordx4 v226, s[8:11], s50 offen offset:0 lds
v_mfma_f32_16x16x32_bf16 v[60:63], a[152:155], a[76:79], v[60:63]
s_bfe_u32 s52, s58, 0x40010
ds_read_b64_tr_b16 a[216:217], v224 offset:0
v_mfma_f32_16x16x32_bf16 v[64:67], a[64:67], a[160:163], v[64:67]
s_lshl_b32 s52, s52, 13
ds_read_b64_tr_b16 a[218:219], v224 offset:1024
v_mfma_f32_16x16x32_bf16 v[64:67], a[80:83], a[164:167], v[64:67]
s_add_u32 s52, s52, s54
v_mfma_f32_16x16x32_bf16 v[68:71], a[84:87], a[164:167], v[68:71]
s_add_u32 s53, s52, 4096
ds_read_b64_tr_b16 a[220:221], v224 offset:14336
v_mfma_f32_16x16x32_bf16 v[68:71], a[68:71], a[160:163], v[68:71]
v_mfma_f32_16x16x32_bf16 v[72:75], a[72:75], a[160:163], v[72:75]
buffer_load_dwordx4 a[0:3], v233, s[16:19], s52 offen offset:0 sc1
v_mfma_f32_16x16x32_bf16 v[72:75], a[88:91], a[164:167], v[72:75]
s_add_u32 m0, s56, 3072
ds_read_b64_tr_b16 a[222:223], v224 offset:15360
v_mfma_f32_16x16x32_bf16 v[76:79], a[92:95], a[164:167], v[76:79]
ds_read_b64_tr_b16 a[224:225], v225 offset:0
v_mfma_f32_16x16x32_bf16 v[76:79], a[76:79], a[160:163], v[76:79]
v_mfma_f32_16x16x32_bf16 v[80:83], a[64:67], a[168:171], v[80:83]
ds_read_b64_tr_b16 a[226:227], v225 offset:1024
v_mfma_f32_16x16x32_bf16 v[80:83], a[80:83], a[172:175], v[80:83]
v_mfma_f32_16x16x32_bf16 v[84:87], a[84:87], a[172:175], v[84:87]
buffer_load_dwordx4 v229, s[12:15], s51 offen offset:0 lds
v_mfma_f32_16x16x32_bf16 v[84:87], a[68:71], a[168:171], v[84:87]
ds_read_b64_tr_b16 a[228:229], v225 offset:14336
v_mfma_f32_16x16x32_bf16 v[88:91], a[72:75], a[168:171], v[88:91]
ds_read_b64_tr_b16 a[230:231], v225 offset:15360
v_mfma_f32_16x16x32_bf16 v[88:91], a[88:91], a[172:175], v[88:91]
v_mfma_f32_16x16x32_bf16 v[92:95], a[92:95], a[172:175], v[92:95]
v_mfma_f32_16x16x32_bf16 v[92:95], a[76:79], a[168:171], v[92:95]
v_mfma_f32_16x16x32_bf16 v[96:99], a[176:179], a[64:67], v[96:99]
buffer_load_dwordx4 a[16:19], v233, s[16:19], s52 offen offset:1024 sc1
v_mfma_f32_16x16x32_bf16 v[96:99], a[180:183], a[80:83], v[96:99]
v_mfma_f32_16x16x32_bf16 v[100:103], a[180:183], a[84:87], v[100:103]
v_mfma_f32_16x16x32_bf16 v[100:103], a[176:179], a[68:71], v[100:103]
v_mfma_f32_16x16x32_bf16 v[104:107], a[176:179], a[72:75], v[104:107]
v_mfma_f32_16x16x32_bf16 v[104:107], a[180:183], a[88:91], v[104:107]
v_mfma_f32_16x16x32_bf16 v[108:111], a[180:183], a[92:95], v[108:111]
v_mfma_f32_16x16x32_bf16 v[108:111], a[176:179], a[76:79], v[108:111]
s_waitcnt vmcnt(6) lgkmcnt(0)
s_barrier
v_mfma_f32_16x16x32_bf16 v[112:115], a[184:187], a[64:67], v[112:115]
buffer_load_dwordx4 v230, s[12:15], s51 offen offset:1024 lds
v_mfma_f32_16x16x32_bf16 v[112:115], a[188:191], a[80:83], v[112:115]
ds_read_b64_tr_b16 a[128:129], v217 offset:28672
ds_read_b64_tr_b16 a[130:131], v217 offset:28928
v_mfma_f32_16x16x32_bf16 v[116:119], a[188:191], a[84:87], v[116:119]
ds_read_b64_tr_b16 a[132:133], v217 offset:43008
v_mfma_f32_16x16x32_bf16 v[116:119], a[184:187], a[68:71], v[116:119]
v_mfma_f32_16x16x32_bf16 v[120:123], a[184:187], a[72:75], v[120:123]
ds_read_b64_tr_b16 a[134:135], v217 offset:43264
v_mfma_f32_16x16x32_bf16 v[120:123], a[188:191], a[88:91], v[120:123]
buffer_load_dwordx4 a[4:7], v233, s[16:19], s52 offen offset:2048 sc1
v_mfma_f32_16x16x32_bf16 v[124:127], a[188:191], a[92:95], v[124:127]
s_add_u32 m0, s56, 0
ds_read_b64_tr_b16 a[136:137], v218 offset:28672
ds_read_b64_tr_b16 a[138:139], v218 offset:28928
v_mfma_f32_16x16x32_bf16 v[124:127], a[184:187], a[76:79], v[124:127]
v_mfma_f32_16x16x32_bf16 v[128:131], a[192:195], a[64:67], v[128:131]
ds_read_b64_tr_b16 a[140:141], v218 offset:43008
v_mfma_f32_16x16x32_bf16 v[128:131], a[196:199], a[80:83], v[128:131]
ds_read_b64_tr_b16 a[142:143], v218 offset:43264
v_mfma_f32_16x16x32_bf16 v[132:135], a[196:199], a[84:87], v[132:135]
buffer_load_dwordx4 v227, s[8:11], s50 offen offset:1024 lds
v_mfma_f32_16x16x32_bf16 v[132:135], a[192:195], a[68:71], v[132:135]
Lpad1:
s_cbranch_execz Lpad5
ds_read_b64_tr_b16 a[144:145], v217 offset:29696
v_mfma_f32_16x16x32_bf16 v[136:139], a[192:195], a[72:75], v[136:139]
ds_read_b64_tr_b16 a[146:147], v217 offset:29952
v_mfma_f32_16x16x32_bf16 v[136:139], a[196:199], a[88:91], v[136:139]
ds_read_b64_tr_b16 a[148:149], v217 offset:44032
v_mfma_f32_16x16x32_bf16 v[140:143], a[196:199], a[92:95], v[140:143]
ds_read_b64_tr_b16 a[150:151], v217 offset:44288
v_mfma_f32_16x16x32_bf16 v[140:143], a[192:195], a[76:79], v[140:143]
buffer_load_dwordx4 a[20:23], v233, s[16:19], s52 offen offset:3072 sc1
v_mfma_f32_16x16x32_bf16 v[144:147], a[200:203], a[64:67], v[144:147]
s_add_u32 m0, s56, 3072
ds_read_b64_tr_b16 a[152:153], v218 offset:29696
v_mfma_f32_16x16x32_bf16 v[144:147], a[204:207], a[80:83], v[144:147]
ds_read_b64_tr_b16 a[154:155], v218 offset:29952
v_mfma_f32_16x16x32_bf16 v[148:151], a[204:207], a[84:87], v[148:151]
v_mfma_f32_16x16x32_bf16 v[148:151], a[200:203], a[68:71], v[148:151]
ds_read_b64_tr_b16 a[156:157], v218 offset:44032
v_mfma_f32_16x16x32_bf16 v[152:155], a[200:203], a[72:75], v[152:155]
buffer_load_dwordx4 v231, s[12:15], s51 offen offset:2048 lds
v_mfma_f32_16x16x32_bf16 v[152:155], a[204:207], a[88:91], v[152:155]
ds_read_b64_tr_b16 a[158:159], v218 offset:44288
ds_read_b64_tr_b16 a[160:161], v217 offset:30720
v_mfma_f32_16x16x32_bf16 v[156:159], a[204:207], a[92:95], v[156:159]
v_mfma_f32_16x16x32_bf16 v[156:159], a[200:203], a[76:79], v[156:159]
ds_read_b64_tr_b16 a[162:163], v217 offset:30976
v_mfma_f32_16x16x32_bf16 v[160:163], a[208:211], a[64:67], v[160:163]
ds_read_b64_tr_b16 a[164:165], v217 offset:45056
v_mfma_f32_16x16x32_bf16 v[160:163], a[212:215], a[80:83], v[160:163]
buffer_load_dwordx4 a[8:11], v233, s[16:19], s53 offen offset:0 sc1
v_mfma_f32_16x16x32_bf16 v[164:167], a[212:215], a[84:87], v[164:167]
s_add_u32 m0, s56, 0
ds_read_b64_tr_b16 a[166:167], v217 offset:45312
v_mfma_f32_16x16x32_bf16 v[164:167], a[208:211], a[68:71], v[164:167]
ds_read_b64_tr_b16 a[168:169], v218 offset:30720
v_mfma_f32_16x16x32_bf16 v[168:171], a[208:211], a[72:75], v[168:171]
ds_read_b64_tr_b16 a[170:171], v218 offset:30976
v_mfma_f32_16x16x32_bf16 v[168:171], a[212:215], a[88:91], v[168:171]
ds_read_b64_tr_b16 a[172:173], v218 offset:45056
v_mfma_f32_16x16x32_bf16 v[172:175], a[212:215], a[92:95], v[172:175]
buffer_load_dwordx4 v228, s[8:11], s50 offen offset:2048 lds
v_mfma_f32_16x16x32_bf16 v[172:175], a[208:211], a[76:79], v[172:175]
ds_read_b64_tr_b16 a[174:175], v218 offset:45312
v_mfma_f32_16x16x32_bf16 v[176:179], a[216:219], a[64:67], v[176:179]
ds_read_b64_tr_b16 a[176:177], v219 offset:28672
v_mfma_f32_16x16x32_bf16 v[176:179], a[220:223], a[80:83], v[176:179]
ds_read_b64_tr_b16 a[178:179], v219 offset:29696
v_mfma_f32_16x16x32_bf16 v[180:183], a[220:223], a[84:87], v[180:183]
v_mfma_f32_16x16x32_bf16 v[180:183], a[216:219], a[68:71], v[180:183]
buffer_load_dwordx4 a[24:27], v233, s[16:19], s53 offen offset:1024 sc1
v_mfma_f32_16x16x32_bf16 v[184:187], a[216:219], a[72:75], v[184:187]
s_add_u32 m0, s56, 3072
ds_read_b64_tr_b16 a[180:181], v219 offset:43008
ds_read_b64_tr_b16 a[182:183], v219 offset:44032
v_mfma_f32_16x16x32_bf16 v[184:187], a[220:223], a[88:91], v[184:187]
v_mfma_f32_16x16x32_bf16 v[188:191], a[220:223], a[92:95], v[188:191]
v_mfma_f32_16x16x32_bf16 v[188:191], a[216:219], a[76:79], v[188:191]
v_mfma_f32_16x16x32_bf16 v[192:195], a[224:227], a[64:67], v[192:195]
buffer_load_dwordx4 v232, s[12:15], s51 offen offset:3072 lds
v_mfma_f32_16x16x32_bf16 v[192:195], a[228:231], a[80:83], v[192:195]
v_mfma_f32_16x16x32_bf16 v[196:199], a[228:231], a[84:87], v[196:199]
v_mfma_f32_16x16x32_bf16 v[196:199], a[224:227], a[68:71], v[196:199]
v_mfma_f32_16x16x32_bf16 v[200:203], a[224:227], a[72:75], v[200:203]
v_mfma_f32_16x16x32_bf16 v[200:203], a[228:231], a[88:91], v[200:203]
v_mfma_f32_16x16x32_bf16 v[204:207], a[228:231], a[92:95], v[204:207]
v_mfma_f32_16x16x32_bf16 v[204:207], a[224:227], a[76:79], v[204:207]
s_waitcnt vmcnt(13) lgkmcnt(0)
v_mfma_f32_16x16x32_bf16 v[0:3], a[128:131], a[96:99], v[0:3]
buffer_load_dwordx4 a[12:15], v233, s[16:19], s53 offen offset:2048 sc1
v_mfma_f32_16x16x32_bf16 v[0:3], a[132:135], a[112:115], v[0:3]
ds_read_b64_tr_b16 a[184:185], v220 offset:28672
ds_read_b64_tr_b16 a[186:187], v220 offset:29696
v_mfma_f32_16x16x32_bf16 v[4:7], a[132:135], a[116:119], v[4:7]
v_mfma_f32_16x16x32_bf16 v[4:7], a[128:131], a[100:103], v[4:7]
ds_read_b64_tr_b16 a[188:189], v220 offset:43008
v_mfma_f32_16x16x32_bf16 v[8:11], a[128:131], a[104:107], v[8:11]
buffer_load_dwordx4 a[28:31], v233, s[16:19], s53 offen offset:3072 sc1
v_mfma_f32_16x16x32_bf16 v[8:11], a[132:135], a[120:123], v[8:11]
s_cmp_eq_u32 s48, 0
s_cselect_b32 s44, s60, 67108864
ds_read_b64_tr_b16 a[190:191], v220 offset:44032
v_mfma_f32_16x16x32_bf16 v[12:15], a[132:135], a[124:127], v[12:15]
v_mfma_f32_16x16x32_bf16 v[12:15], a[128:131], a[108:111], v[12:15]
ds_read_b64_tr_b16 a[192:193], v221 offset:28672
v_mfma_f32_16x16x32_bf16 v[16:19], a[136:139], a[96:99], v[16:19]
v_mfma_f32_16x16x32_bf16 v[16:19], a[140:143], a[112:115], v[16:19]
s_mov_b64 exec, 0xffffff
buffer_load_dword v246, v255, s[8:11], s44 offen
s_mov_b64 exec, -1
v_mfma_f32_16x16x32_bf16 v[20:23], a[140:143], a[116:119], v[20:23]
s_cmp_eq_u32 s48, 0
s_cselect_b32 s44, s61, 67108864
ds_read_b64_tr_b16 a[194:195], v221 offset:29696
v_mfma_f32_16x16x32_bf16 v[20:23], a[136:139], a[100:103], v[20:23]
ds_read_b64_tr_b16 a[196:197], v221 offset:43008
v_mfma_f32_16x16x32_bf16 v[24:27], a[136:139], a[104:107], v[24:27]
v_mfma_f32_16x16x32_bf16 v[24:27], a[140:143], a[120:123], v[24:27]
ds_read_b64_tr_b16 a[198:199], v221 offset:44032
v_mfma_f32_16x16x32_bf16 v[28:31], a[140:143], a[124:127], v[28:31]
s_mov_b64 exec, 0xfffffff
buffer_load_dword v246, v255, s[12:15], s44 offen
s_mov_b64 exec, -1
v_mfma_f32_16x16x32_bf16 v[28:31], a[136:139], a[108:111], v[28:31]
s_add_u32 m0, s56, 28672
ds_read_b64_tr_b16 a[200:201], v222 offset:28672
v_mfma_f32_16x16x32_bf16 v[32:35], a[144:147], a[96:99], v[32:35]
s_bfe_u32 s55, s58, 0x40014
v_mfma_f32_16x16x32_bf16 v[32:35], a[148:151], a[112:115], v[32:35]
s_mul_i32 s50, s55, 393216
ds_read_b64_tr_b16 a[202:203], v222 offset:29696
v_mfma_f32_16x16x32_bf16 v[36:39], a[148:151], a[116:119], v[36:39]
s_mul_i32 s51, s55, 458752
v_mfma_f32_16x16x32_bf16 v[36:39], a[144:147], a[100:103], v[36:39]
buffer_load_dwordx4 v226, s[8:11], s50 offen offset:0 lds
v_mfma_f32_16x16x32_bf16 v[40:43], a[144:147], a[104:107], v[40:43]
s_bfe_u32 s52, s58, 0x40014
ds_read_b64_tr_b16 a[204:205], v222 offset:43008
v_mfma_f32_16x16x32_bf16 v[40:43], a[148:151], a[120:123], v[40:43]
s_lshl_b32 s52, s52, 13
ds_read_b64_tr_b16 a[206:207], v222 offset:44032
v_mfma_f32_16x16x32_bf16 v[44:47], a[148:151], a[124:127], v[44:47]
s_add_u32 s52, s52, s54
v_mfma_f32_16x16x32_bf16 v[44:47], a[144:147], a[108:111], v[44:47]
s_add_u32 s53, s52, 4096
ds_read_b64_tr_b16 a[208:209], v223 offset:28672
v_mfma_f32_16x16x32_bf16 v[48:51], a[152:155], a[96:99], v[48:51]
buffer_load_dwordx4 a[32:35], v233, s[16:19], s52 offen offset:0 sc1
v_mfma_f32_16x16x32_bf16 v[48:51], a[156:159], a[112:115], v[48:51]
s_add_u32 m0, s56, 31744
ds_read_b64_tr_b16 a[210:211], v223 offset:29696
v_mfma_f32_16x16x32_bf16 v[52:55], a[156:159], a[116:119], v[52:55]
ds_read_b64_tr_b16 a[212:213], v223 offset:43008
v_mfma_f32_16x16x32_bf16 v[52:55], a[152:155], a[100:103], v[52:55]
v_mfma_f32_16x16x32_bf16 v[56:59], a[152:155], a[104:107], v[56:59]
ds_read_b64_tr_b16 a[214:215], v223 offset:44032
v_mfma_f32_16x16x32_bf16 v[56:59], a[156:159], a[120:123], v[56:59]
buffer_load_dwordx4 v229, s[12:15], s51 offen offset:0 lds
v_mfma_f32_16x16x32_bf16 v[60:63], a[156:159], a[124:127], v[60:63]
ds_read_b64_tr_b16 a[216:217], v224 offset:28672
v_mfma_f32_16x16x32_bf16 v[60:63], a[152:155], a[108:111], v[60:63]
v_mfma_f32_16x16x32_bf16 v[64:67], a[96:99], a[160:163], v[64:67]
ds_read_b64_tr_b16 a[218:219], v224 offset:29696
v_mfma_f32_16x16x32_bf16 v[64:67], a[112:115], a[164:167], v[64:67]
v_mfma_f32_16x16x32_bf16 v[68:71], a[116:119], a[164:167], v[68:71]
buffer_load_dwordx4 a[48:51], v233, s[16:19], s52 offen offset:1024 sc1
v_mfma_f32_16x16x32_bf16 v[68:71], a[100:103], a[160:163], v[68:71]
ds_read_b64_tr_b16 a[220:221], v224 offset:43008
v_mfma_f32_16x16x32_bf16 v[72:75], a[104:107], a[160:163], v[72:75]
ds_read_b64_tr_b16 a[222:223], v224 offset:44032
v_mfma_f32_16x16x32_bf16 v[72:75], a[120:123], a[164:167], v[72:75]
v_mfma_f32_16x16x32_bf16 v[76:79], a[124:127], a[164:167], v[76:79]
ds_read_b64_tr_b16 a[224:225], v225 offset:28672
v_mfma_f32_16x16x32_bf16 v[76:79], a[108:111], a[160:163], v[76:79]
buffer_load_dwordx4 v230, s[12:15], s51 offen offset:1024 lds
v_mfma_f32_16x16x32_bf16 v[80:83], a[96:99], a[168:171], v[80:83]
ds_read_b64_tr_b16 a[226:227], v225 offset:29696
v_mfma_f32_16x16x32_bf16 v[80:83], a[112:115], a[172:175], v[80:83]
v_mfma_f32_16x16x32_bf16 v[84:87], a[116:119], a[172:175], v[84:87]
ds_read_b64_tr_b16 a[228:229], v225 offset:43008
v_mfma_f32_16x16x32_bf16 v[84:87], a[100:103], a[168:171], v[84:87]
v_mfma_f32_16x16x32_bf16 v[88:91], a[104:107], a[168:171], v[88:91]
buffer_load_dwordx4 a[36:39], v233, s[16:19], s52 offen offset:2048 sc1
v_mfma_f32_16x16x32_bf16 v[88:91], a[120:123], a[172:175], v[88:91]
s_add_u32 m0, s56, 28672
ds_read_b64_tr_b16 a[230:231], v225 offset:44032
v_mfma_f32_16x16x32_bf16 v[92:95], a[124:127], a[172:175], v[92:95]
v_mfma_f32_16x16x32_bf16 v[92:95], a[108:111], a[168:171], v[92:95]
v_mfma_f32_16x16x32_bf16 v[96:99], a[176:179], a[96:99], v[96:99]
v_mfma_f32_16x16x32_bf16 v[96:99], a[180:183], a[112:115], v[96:99]
buffer_load_dwordx4 v227, s[8:11], s50 offen offset:1024 lds
v_mfma_f32_16x16x32_bf16 v[100:103], a[180:183], a[116:119], v[100:103]
v_mfma_f32_16x16x32_bf16 v[100:103], a[176:179], a[100:103], v[100:103]
v_mfma_f32_16x16x32_bf16 v[104:107], a[176:179], a[104:107], v[104:107]
v_mfma_f32_16x16x32_bf16 v[104:107], a[180:183], a[120:123], v[104:107]
v_mfma_f32_16x16x32_bf16 v[108:111], a[180:183], a[124:127], v[108:111]
v_mfma_f32_16x16x32_bf16 v[108:111], a[176:179], a[108:111], v[108:111]
s_waitcnt vmcnt(11) lgkmcnt(0)
s_barrier
v_mfma_f32_16x16x32_bf16 v[112:115], a[184:187], a[96:99], v[112:115]
buffer_load_dwordx4 a[52:55], v233, s[16:19], s52 offen offset:3072 sc1
v_mfma_f32_16x16x32_bf16 v[112:115], a[188:191], a[112:115], v[112:115]
s_add_u32 m0, s56, 31744
ds_read_b64_tr_b16 a[128:129], v208 offset:0
ds_read_b64_tr_b16 a[130:131], v208 offset:256
v_mfma_f32_16x16x32_bf16 v[116:119], a[188:191], a[116:119], v[116:119]
ds_read_b64_tr_b16 a[132:133], v208 offset:14336
v_mfma_f32_16x16x32_bf16 v[116:119], a[184:187], a[100:103], v[116:119]
v_mfma_f32_16x16x32_bf16 v[120:123], a[184:187], a[104:107], v[120:123]
buffer_load_dwordx4 v231, s[12:15], s51 offen offset:2048 lds
v_mfma_f32_16x16x32_bf16 v[120:123], a[188:191], a[120:123], v[120:123]
ds_read_b64_tr_b16 a[134:135], v208 offset:14592
ds_read_b64_tr_b16 a[136:137], v209 offset:0
v_mfma_f32_16x16x32_bf16 v[124:127], a[188:191], a[124:127], v[124:127]
ds_read_b64_tr_b16 a[138:139], v209 offset:256
v_mfma_f32_16x16x32_bf16 v[124:127], a[184:187], a[108:111], v[124:127]
v_mfma_f32_16x16x32_bf16 v[128:131], a[192:195], a[96:99], v[128:131]
buffer_load_dwordx4 a[40:43], v233, s[16:19], s53 offen offset:0 sc1
v_mfma_f32_16x16x32_bf16 v[128:131], a[196:199], a[112:115], v[128:131]
s_add_u32 m0, s56, 28672
ds_read_b64_tr_b16 a[140:141], v209 offset:14336
ds_read_b64_tr_b16 a[142:143], v209 offset:14592
v_mfma_f32_16x16x32_bf16 v[132:135], a[196:199], a[116:119], v[132:135]
ds_read_b64_tr_b16 a[144:145], v208 offset:1024
v_mfma_f32_16x16x32_bf16 v[132:135], a[192:195], a[100:103], v[132:135]
v_mfma_f32_16x16x32_bf16 v[136:139], a[192:195], a[104:107], v[136:139]
buffer_load_dwordx4 v228, s[8:11], s50 offen offset:2048 lds
v_mfma_f32_16x16x32_bf16 v[136:139], a[196:199], a[120:123], v[136:139]
ds_read_b64_tr_b16 a[146:147], v208 offset:1280
ds_read_b64_tr_b16 a[148:149], v208 offset:15360
v_mfma_f32_16x16x32_bf16 v[140:143], a[196:199], a[124:127], v[140:143]
ds_read_b64_tr_b16 a[150:151], v208 offset:15616
v_mfma_f32_16x16x32_bf16 v[140:143], a[192:195], a[108:111], v[140:143]
v_mfma_f32_16x16x32_bf16 v[144:147], a[200:203], a[96:99], v[144:147]
buffer_load_dwordx4 a[56:59], v233, s[16:19], s53 offen offset:1024 sc1
v_mfma_f32_16x16x32_bf16 v[144:147], a[204:207], a[112:115], v[144:147]
s_add_u32 m0, s56, 31744
ds_read_b64_tr_b16 a[152:153], v209 offset:1024
ds_read_b64_tr_b16 a[154:155], v209 offset:1280
v_mfma_f32_16x16x32_bf16 v[148:151], a[204:207], a[116:119], v[148:151]
v_mfma_f32_16x16x32_bf16 v[148:151], a[200:203], a[100:103], v[148:151]
ds_read_b64_tr_b16 a[156:157], v209 offset:15360
v_mfma_f32_16x16x32_bf16 v[152:155], a[200:203], a[104:107], v[152:155]
buffer_load_dwordx4 v232, s[12:15], s51 offen offset:3072 lds
v_mfma_f32_16x16x32_bf16 v[152:155], a[204:207], a[120:123], v[152:155]
ds_read_b64_tr_b16 a[158:159], v209 offset:15616
ds_read_b64_tr_b16 a[160:161], v208 offset:2048
v_mfma_f32_16x16x32_bf16 v[156:159], a[204:207], a[124:127], v[156:159]
v_mfma_f32_16x16x32_bf16 v[156:159], a[200:203], a[108:111], v[156:159]
ds_read_b64_tr_b16 a[162:163], v208 offset:2304
v_mfma_f32_16x16x32_bf16 v[160:163], a[208:211], a[96:99], v[160:163]
ds_read_b64_tr_b16 a[164:165], v208 offset:16384
v_mfma_f32_16x16x32_bf16 v[160:163], a[212:215], a[112:115], v[160:163]
buffer_load_dwordx4 a[44:47], v233, s[16:19], s53 offen offset:2048 sc1
v_mfma_f32_16x16x32_bf16 v[164:167], a[212:215], a[116:119], v[164:167]
ds_read_b64_tr_b16 a[166:167], v208 offset:16640
v_mfma_f32_16x16x32_bf16 v[164:167], a[208:211], a[100:103], v[164:167]
ds_read_b64_tr_b16 a[168:169], v209 offset:2048
v_mfma_f32_16x16x32_bf16 v[168:171], a[208:211], a[104:107], v[168:171]
ds_read_b64_tr_b16 a[170:171], v209 offset:2304
v_mfma_f32_16x16x32_bf16 v[168:171], a[212:215], a[120:123], v[168:171]
buffer_load_dwordx4 a[60:63], v233, s[16:19], s53 offen offset:3072 sc1
v_mfma_f32_16x16x32_bf16 v[172:175], a[212:215], a[124:127], v[172:175]
s_cmp_eq_u32 s48, 1
s_cselect_b32 s44, s60, 67108864
ds_read_b64_tr_b16 a[172:173], v209 offset:16384
v_mfma_f32_16x16x32_bf16 v[172:175], a[208:211], a[108:111], v[172:175]
ds_read_b64_tr_b16 a[174:175], v209 offset:16640
v_mfma_f32_16x16x32_bf16 v[176:179], a[216:219], a[96:99], v[176:179]
ds_read_b64_tr_b16 a[176:177], v210 offset:0
v_mfma_f32_16x16x32_bf16 v[176:179], a[220:223], a[112:115], v[176:179]
s_mov_b64 exec, 0xffffff
buffer_load_dword v246, v255, s[8:11], s44 offen
s_mov_b64 exec, -1
v_mfma_f32_16x16x32_bf16 v[180:183], a[220:223], a[116:119], v[180:183]
s_cmp_eq_u32 s48, 1
s_cselect_b32 s44, s61, 67108864
ds_read_b64_tr_b16 a[178:179], v210 offset:1024
v_mfma_f32_16x16x32_bf16 v[180:183], a[216:219], a[100:103], v[180:183]
ds_read_b64_tr_b16 a[180:181], v210 offset:14336
v_mfma_f32_16x16x32_bf16 v[184:187], a[216:219], a[104:107], v[184:187]
ds_read_b64_tr_b16 a[182:183], v210 offset:15360
v_mfma_f32_16x16x32_bf16 v[184:187], a[220:223], a[120:123], v[184:187]
s_mov_b64 exec, 0xfffffff
buffer_load_dword v246, v255, s[12:15], s44 offen
s_mov_b64 exec, -1
v_mfma_f32_16x16x32_bf16 v[188:191], a[220:223], a[124:127], v[188:191]
s_add_u32 m0, s56, 57344
v_mfma_f32_16x16x32_bf16 v[188:191], a[216:219], a[108:111], v[188:191]
s_bfe_u32 s55, s58, 0x40018
v_mfma_f32_16x16x32_bf16 v[192:195], a[224:227], a[96:99], v[192:195]
s_mul_i32 s50, s55, 393216
v_mfma_f32_16x16x32_bf16 v[192:195], a[228:231], a[112:115], v[192:195]
s_mul_i32 s51, s55, 458752
buffer_load_dwordx4 v226, s[8:11], s50 offen offset:0 lds
v_mfma_f32_16x16x32_bf16 v[196:199], a[228:231], a[116:119], v[196:199]
v_mfma_f32_16x16x32_bf16 v[196:199], a[224:227], a[100:103], v[196:199]
v_mfma_f32_16x16x32_bf16 v[200:203], a[224:227], a[104:107], v[200:203]
v_mfma_f32_16x16x32_bf16 v[200:203], a[228:231], a[120:123], v[200:203]
v_mfma_f32_16x16x32_bf16 v[204:207], a[228:231], a[124:127], v[204:207]
v_mfma_f32_16x16x32_bf16 v[204:207], a[224:227], a[108:111], v[204:207]
s_waitcnt vmcnt(20) lgkmcnt(0)
v_mfma_f32_16x16x32_bf16 v[0:3], a[128:131], a[0:3], v[0:3]
s_bfe_u32 s52, s58, 0x40018
ds_read_b64_tr_b16 a[184:185], v211 offset:0
v_mfma_f32_16x16x32_bf16 v[0:3], a[132:135], a[16:19], v[0:3]
s_lshl_b32 s52, s52, 13
ds_read_b64_tr_b16 a[186:187], v211 offset:1024
v_mfma_f32_16x16x32_bf16 v[4:7], a[132:135], a[20:23], v[4:7]
s_add_u32 s52, s52, s54
v_mfma_f32_16x16x32_bf16 v[4:7], a[128:131], a[4:7], v[4:7]
s_add_u32 s53, s52, 4096
buffer_load_dwordx4 a[64:67], v233, s[16:19], s52 offen offset:0 sc1
v_mfma_f32_16x16x32_bf16 v[8:11], a[128:131], a[8:11], v[8:11]
s_add_u32 m0, s56, 60416
ds_read_b64_tr_b16 a[188:189], v211 offset:14336
v_mfma_f32_16x16x32_bf16 v[8:11], a[132:135], a[24:27], v[8:11]
s_lshr_b32 s42, s54, 5
ds_read_b64_tr_b16 a[190:191], v211 offset:15360
v_mfma_f32_16x16x32_bf16 v[12:15], a[132:135], a[28:31], v[12:15]
s_lshl_b32 s45, s33, 17
buffer_load_dwordx4 v229, s[12:15], s51 offen offset:0 lds
v_mfma_f32_16x16x32_bf16 v[12:15], a[128:131], a[12:15], v[12:15]
s_add_u32 s42, s42, s45
ds_read_b64_tr_b16 a[192:193], v212 offset:0
v_mfma_f32_16x16x32_bf16 v[16:19], a[136:139], a[0:3], v[16:19]
s_add_u32 s62, s42, 23068672
v_mfma_f32_16x16x32_bf16 v[16:19], a[140:143], a[16:19], v[16:19]
s_add_u32 s63, s42, 27262976
ds_read_b64_tr_b16 a[194:195], v212 offset:1024
v_mfma_f32_16x16x32_bf16 v[20:23], a[140:143], a[20:23], v[20:23]
s_sub_u32 s67, s34, 16384
v_mfma_f32_16x16x32_bf16 v[20:23], a[136:139], a[4:7], v[20:23]
s_lshl_b32 s45, s3, 1
ds_read_b64_tr_b16 a[196:197], v212 offset:14336
v_mfma_f32_16x16x32_bf16 v[24:27], a[136:139], a[8:11], v[24:27]
s_sub_u32 s45, 8, s45
buffer_load_dwordx4 a[80:83], v233, s[16:19], s52 offen offset:1024 sc1
v_mfma_f32_16x16x32_bf16 v[24:27], a[140:143], a[24:27], v[24:27]
s_cmp_eq_u32 s32, 0
s_cselect_b32 s67, s34, s67
ds_read_b64_tr_b16 a[198:199], v212 offset:15360
v_mfma_f32_16x16x32_bf16 v[28:31], a[140:143], a[28:31], v[28:31]
s_cmp_eq_u32 s32, 0
s_cselect_b32 s35, s45, 99
v_mfma_f32_16x16x32_bf16 v[28:31], a[136:139], a[12:15], v[28:31]
s_cmp_eq_u32 s32, 0
s_cselect_b32 s45, 67108864, 0
ds_read_b64_tr_b16 a[200:201], v213 offset:0
v_mfma_f32_16x16x32_bf16 v[32:35], a[144:147], a[0:3], v[32:35]
s_sub_u32 s45, s45, 16384
v_mfma_f32_16x16x32_bf16 v[32:35], a[148:151], a[16:19], v[32:35]
s_add_u32 s68, s62, s45
ds_read_b64_tr_b16 a[202:203], v213 offset:1024
v_mfma_f32_16x16x32_bf16 v[36:39], a[148:151], a[20:23], v[36:39]
s_add_u32 s69, s63, s45
buffer_load_dwordx4 v230, s[12:15], s51 offen offset:1024 lds
v_mfma_f32_16x16x32_bf16 v[36:39], a[144:147], a[4:7], v[36:39]
s_cmp_eq_u32 s32, 7
s_cselect_b32 s45, 67108864, 0
ds_read_b64_tr_b16 a[204:205], v213 offset:14336
v_mfma_f32_16x16x32_bf16 v[40:43], a[144:147], a[8:11], v[40:43]
s_add_u32 s62, s62, s45
v_mfma_f32_16x16x32_bf16 v[40:43], a[148:151], a[24:27], v[40:43]
s_add_u32 s63, s63, s45
ds_read_b64_tr_b16 a[206:207], v213 offset:15360
v_mfma_f32_16x16x32_bf16 v[44:47], a[148:151], a[28:31], v[44:47]
s_lshl_b32 s45, s3, 12
v_mfma_f32_16x16x32_bf16 v[44:47], a[144:147], a[12:15], v[44:47]
s_add_u32 s45, s45, 16384
ds_read_b64_tr_b16 a[208:209], v214 offset:0
v_add_u32 v249, s45, v233
v_mfma_f32_16x16x32_bf16 v[48:51], a[152:155], a[0:3], v[48:51]
buffer_load_dwordx4 a[68:71], v233, s[16:19], s52 offen offset:2048 sc1
v_mfma_f32_16x16x32_bf16 v[48:51], a[156:159], a[16:19], v[48:51]
s_add_u32 m0, s56, 57344
ds_read_b64_tr_b16 a[210:211], v214 offset:1024
v_mfma_f32_16x16x32_bf16 v[52:55], a[156:159], a[20:23], v[52:55]
ds_read_b64_tr_b16 a[212:213], v214 offset:14336
v_mfma_f32_16x16x32_bf16 v[52:55], a[152:155], a[4:7], v[52:55]
v_mfma_f32_16x16x32_bf16 v[56:59], a[152:155], a[8:11], v[56:59]
ds_read_b64_tr_b16 a[214:215], v214 offset:15360
v_mfma_f32_16x16x32_bf16 v[56:59], a[156:159], a[24:27], v[56:59]
v_mfma_f32_16x16x32_bf16 v[60:63], a[156:159], a[28:31], v[60:63]
buffer_load_dwordx4 v227, s[8:11], s50 offen offset:1024 lds
v_mfma_f32_16x16x32_bf16 v[60:63], a[152:155], a[12:15], v[60:63]
ds_read_b64_tr_b16 a[216:217], v215 offset:0
v_mfma_f32_16x16x32_bf16 v[64:67], a[0:3], a[160:163], v[64:67]
ds_read_b64_tr_b16 a[218:219], v215 offset:1024
v_mfma_f32_16x16x32_bf16 v[64:67], a[16:19], a[164:167], v[64:67]
v_mfma_f32_16x16x32_bf16 v[68:71], a[20:23], a[164:167], v[68:71]
ds_read_b64_tr_b16 a[220:221], v215 offset:14336
v_mfma_f32_16x16x32_bf16 v[68:71], a[4:7], a[160:163], v[68:71]
v_mfma_f32_16x16x32_bf16 v[72:75], a[8:11], a[160:163], v[72:75]
buffer_load_dwordx4 a[84:87], v233, s[16:19], s52 offen offset:3072 sc1
v_mfma_f32_16x16x32_bf16 v[72:75], a[24:27], a[164:167], v[72:75]
s_add_u32 m0, s56, 60416
ds_read_b64_tr_b16 a[222:223], v215 offset:15360
v_mfma_f32_16x16x32_bf16 v[76:79], a[28:31], a[164:167], v[76:79]
ds_read_b64_tr_b16 a[224:225], v216 offset:0
v_mfma_f32_16x16x32_bf16 v[76:79], a[12:15], a[160:163], v[76:79]
v_mfma_f32_16x16x32_bf16 v[80:83], a[0:3], a[168:171], v[80:83]
ds_read_b64_tr_b16 a[226:227], v216 offset:1024
v_mfma_f32_16x16x32_bf16 v[80:83], a[16:19], a[172:175], v[80:83]
v_mfma_f32_16x16x32_bf16 v[84:87], a[20:23], a[172:175], v[84:87]
buffer_load_dwordx4 v231, s[12:15], s51 offen offset:2048 lds
v_mfma_f32_16x16x32_bf16 v[84:87], a[4:7], a[168:171], v[84:87]
ds_read_b64_tr_b16 a[228:229], v216 offset:14336
v_mfma_f32_16x16x32_bf16 v[88:91], a[8:11], a[168:171], v[88:91]
ds_read_b64_tr_b16 a[230:231], v216 offset:15360
v_mfma_f32_16x16x32_bf16 v[88:91], a[24:27], a[172:175], v[88:91]
v_mfma_f32_16x16x32_bf16 v[92:95], a[28:31], a[172:175], v[92:95]
v_mfma_f32_16x16x32_bf16 v[92:95], a[12:15], a[168:171], v[92:95]
v_mfma_f32_16x16x32_bf16 v[96:99], a[176:179], a[0:3], v[96:99]
buffer_load_dwordx4 a[72:75], v233, s[16:19], s53 offen offset:0 sc1
v_mfma_f32_16x16x32_bf16 v[96:99], a[180:183], a[16:19], v[96:99]
v_mfma_f32_16x16x32_bf16 v[100:103], a[180:183], a[20:23], v[100:103]
v_mfma_f32_16x16x32_bf16 v[100:103], a[176:179], a[4:7], v[100:103]
v_mfma_f32_16x16x32_bf16 v[104:107], a[176:179], a[8:11], v[104:107]
v_mfma_f32_16x16x32_bf16 v[104:107], a[180:183], a[24:27], v[104:107]
v_mfma_f32_16x16x32_bf16 v[108:111], a[180:183], a[28:31], v[108:111]
v_mfma_f32_16x16x32_bf16 v[108:111], a[176:179], a[12:15], v[108:111]
s_waitcnt vmcnt(14) lgkmcnt(0)
s_barrier
v_mfma_f32_16x16x32_bf16 v[112:115], a[184:187], a[0:3], v[112:115]
s_add_u32 m0, s56, 57344
s_nop 0
buffer_load_dwordx4 v228, s[8:11], s50 offen offset:2048 lds
v_mfma_f32_16x16x32_bf16 v[112:115], a[188:191], a[16:19], v[112:115]
ds_read_b64_tr_b16 a[128:129], v208 offset:28672
ds_read_b64_tr_b16 a[130:131], v208 offset:28928
v_mfma_f32_16x16x32_bf16 v[116:119], a[188:191], a[20:23], v[116:119]
ds_read_b64_tr_b16 a[132:133], v208 offset:43008
v_add_u32 v248, 131072, v249
v_mfma_f32_16x16x32_bf16 v[116:119], a[184:187], a[4:7], v[116:119]
s_lshr_b32 s42, s54, 17
v_mfma_f32_16x16x32_bf16 v[120:123], a[184:187], a[8:11], v[120:123]
s_mul_i32 s42, s42, 589824
buffer_load_dwordx4 a[88:91], v233, s[16:19], s53 offen offset:1024 sc1
v_mfma_f32_16x16x32_bf16 v[120:123], a[188:191], a[24:27], v[120:123]
s_add_u32 m0, s56, 60416
ds_read_b64_tr_b16 a[134:135], v208 offset:43264
ds_read_b64_tr_b16 a[136:137], v209 offset:28672
v_mfma_f32_16x16x32_bf16 v[124:127], a[188:191], a[28:31], v[124:127]
s_add_u32 s42, s42, 4194304
ds_read_b64_tr_b16 a[138:139], v209 offset:28928
v_mfma_f32_16x16x32_bf16 v[124:127], a[184:187], a[12:15], v[124:127]
s_lshr_b32 s45, s33, 1
v_mfma_f32_16x16x32_bf16 v[128:131], a[192:195], a[0:3], v[128:131]
s_mul_i32 s45, s45, 7
buffer_load_dwordx4 v232, s[12:15], s51 offen offset:3072 lds
v_mfma_f32_16x16x32_bf16 v[128:131], a[196:199], a[16:19], v[128:131]
s_and_b32 s43, s33, 1
ds_read_b64_tr_b16 a[140:141], v209 offset:43008
ds_read_b64_tr_b16 a[142:143], v209 offset:43264
v_mfma_f32_16x16x32_bf16 v[132:135], a[196:199], a[20:23], v[132:135]
s_lshl_b32 s43, s43, 2
ds_read_b64_tr_b16 a[144:145], v208 offset:29696
v_mfma_f32_16x16x32_bf16 v[132:135], a[192:195], a[4:7], v[132:135]
s_add_u32 s43, s43, s45
v_mfma_f32_16x16x32_bf16 v[136:139], a[192:195], a[8:11], v[136:139]
s_lshl_b32 s43, s43, 12
buffer_load_dwordx4 a[76:79], v233, s[16:19], s53 offen offset:2048 sc1
v_mfma_f32_16x16x32_bf16 v[136:139], a[196:199], a[24:27], v[136:139]
s_add_u32 s64, s42, s43
ds_read_b64_tr_b16 a[146:147], v208 offset:29952
ds_read_b64_tr_b16 a[148:149], v208 offset:44032
v_mfma_f32_16x16x32_bf16 v[140:143], a[196:199], a[28:31], v[140:143]
s_add_u32 s45, s45, 3
ds_read_b64_tr_b16 a[150:151], v208 offset:44288
v_mfma_f32_16x16x32_bf16 v[140:143], a[192:195], a[12:15], v[140:143]
s_lshl_b32 s45, s45, 12
v_mfma_f32_16x16x32_bf16 v[144:147], a[200:203], a[0:3], v[144:147]
s_and_b32 s43, s33, 1
buffer_load_dwordx4 a[92:95], v233, s[16:19], s53 offen offset:3072 sc1
v_mfma_f32_16x16x32_bf16 v[144:147], a[204:207], a[16:19], v[144:147]
s_cmp_eq_u32 s48, 2
s_cselect_b32 s44, s60, 67108864
ds_read_b64_tr_b16 a[152:153], v209 offset:29696
ds_read_b64_tr_b16 a[154:155], v209 offset:29952
v_mfma_f32_16x16x32_bf16 v[148:151], a[204:207], a[20:23], v[148:151]
s_lshl_b32 s43, s43, 9
v_mfma_f32_16x16x32_bf16 v[148:151], a[200:203], a[4:7], v[148:151]
s_add_u32 s45, s45, s43
ds_read_b64_tr_b16 a[156:157], v209 offset:44032
v_mfma_f32_16x16x32_bf16 v[152:155], a[200:203], a[8:11], v[152:155]
s_add_u32 s65, s42, s45
s_mov_b64 exec, 0xffffff
buffer_load_dword v246, v255, s[8:11], s44 offen
s_mov_b64 exec, -1
v_mfma_f32_16x16x32_bf16 v[152:155], a[204:207], a[24:27], v[152:155]
s_cmp_eq_u32 s48, 2
s_cselect_b32 s44, s61, 67108864
ds_read_b64_tr_b16 a[158:159], v209 offset:44288
ds_read_b64_tr_b16 a[160:161], v208 offset:30720
v_mfma_f32_16x16x32_bf16 v[156:159], a[204:207], a[28:31], v[156:159]
s_add_u32 s45, s33, 112
v_mfma_f32_16x16x32_bf16 v[156:159], a[200:203], a[12:15], v[156:159]
s_lshl_b32 s45, s45, 12
ds_read_b64_tr_b16 a[162:163], v208 offset:30976
v_mfma_f32_16x16x32_bf16 v[160:163], a[208:211], a[0:3], v[160:163]
s_add_u32 s66, s42, s45
ds_read_b64_tr_b16 a[164:165], v208 offset:45056
v_mfma_f32_16x16x32_bf16 v[160:163], a[212:215], a[16:19], v[160:163]
s_mov_b64 exec, 0xfffffff
buffer_load_dword v246, v255, s[12:15], s44 offen
s_mov_b64 exec, -1
v_mfma_f32_16x16x32_bf16 v[164:167], a[212:215], a[20:23], v[164:167]
s_add_u32 m0, s56, 86016
ds_read_b64_tr_b16 a[166:167], v208 offset:45312
v_mfma_f32_16x16x32_bf16 v[164:167], a[208:211], a[4:7], v[164:167]
s_bfe_u32 s55, s58, 0x4001c
ds_read_b64_tr_b16 a[168:169], v209 offset:30720
v_mfma_f32_16x16x32_bf16 v[168:171], a[208:211], a[8:11], v[168:171]
s_mul_i32 s50, s55, 393216
ds_read_b64_tr_b16 a[170:171], v209 offset:30976
v_mfma_f32_16x16x32_bf16 v[168:171], a[212:215], a[24:27], v[168:171]
s_mul_i32 s51, s55, 458752
buffer_load_dwordx4 v226, s[8:11], s50 offen offset:0 lds
v_mfma_f32_16x16x32_bf16 v[172:175], a[212:215], a[28:31], v[172:175]
s_bfe_u32 s52, s58, 0x4001c
ds_read_b64_tr_b16 a[172:173], v209 offset:45056
v_mfma_f32_16x16x32_bf16 v[172:175], a[208:211], a[12:15], v[172:175]
s_lshl_b32 s52, s52, 13
ds_read_b64_tr_b16 a[174:175], v209 offset:45312
v_mfma_f32_16x16x32_bf16 v[176:179], a[216:219], a[0:3], v[176:179]
s_add_u32 s52, s52, s54
ds_read_b64_tr_b16 a[176:177], v210 offset:28672
v_mfma_f32_16x16x32_bf16 v[176:179], a[220:223], a[16:19], v[176:179]
s_add_u32 s53, s52, 4096
buffer_load_dwordx4 a[96:99], v233, s[16:19], s52 offen offset:0 sc1
v_mfma_f32_16x16x32_bf16 v[180:183], a[220:223], a[20:23], v[180:183]
s_add_u32 m0, s56, 89088
ds_read_b64_tr_b16 a[178:179], v210 offset:29696
v_mfma_f32_16x16x32_bf16 v[180:183], a[216:219], a[4:7], v[180:183]
ds_read_b64_tr_b16 a[180:181], v210 offset:43008
v_mfma_f32_16x16x32_bf16 v[184:187], a[216:219], a[8:11], v[184:187]
ds_read_b64_tr_b16 a[182:183], v210 offset:44032
v_mfma_f32_16x16x32_bf16 v[184:187], a[220:223], a[24:27], v[184:187]
buffer_load_dwordx4 v229, s[12:15], s51 offen offset:0 lds
v_mfma_f32_16x16x32_bf16 v[188:191], a[220:223], a[28:31], v[188:191]
v_mfma_f32_16x16x32_bf16 v[188:191], a[216:219], a[12:15], v[188:191]
v_mfma_f32_16x16x32_bf16 v[192:195], a[224:227], a[0:3], v[192:195]
v_mfma_f32_16x16x32_bf16 v[192:195], a[228:231], a[16:19], v[192:195]
buffer_load_dwordx4 a[112:115], v233, s[16:19], s52 offen offset:1024 sc1
v_mfma_f32_16x16x32_bf16 v[196:199], a[228:231], a[20:23], v[196:199]
v_mfma_f32_16x16x32_bf16 v[196:199], a[224:227], a[4:7], v[196:199]
v_mfma_f32_16x16x32_bf16 v[200:203], a[224:227], a[8:11], v[200:203]
v_mfma_f32_16x16x32_bf16 v[200:203], a[228:231], a[24:27], v[200:203]
v_mfma_f32_16x16x32_bf16 v[204:207], a[228:231], a[28:31], v[204:207]
v_mfma_f32_16x16x32_bf16 v[204:207], a[224:227], a[12:15], v[204:207]
s_waitcnt vmcnt(23) lgkmcnt(0)
v_mfma_f32_16x16x32_bf16 v[0:3], a[128:131], a[32:35], v[0:3]
s_lshr_b32 s45, s38, 1
buffer_load_dwordx4 v230, s[12:15], s51 offen offset:1024 lds
v_mfma_f32_16x16x32_bf16 v[0:3], a[132:135], a[48:51], v[0:3]
s_lshl_b32 s45, s45, 11
ds_read_b64_tr_b16 a[184:185], v211 offset:28672
ds_read_b64_tr_b16 a[186:187], v211 offset:29696
v_mfma_f32_16x16x32_bf16 v[4:7], a[132:135], a[52:55], v[4:7]
s_add_u32 s80, s42, s45
v_and_b32 v252, 15, v234
v_mfma_f32_16x16x32_bf16 v[4:7], a[128:131], a[36:39], v[4:7]
ds_read_b64_tr_b16 a[188:189], v211 offset:43008
v_bfe_u32 v253, v234, 4, 1
Lpad2:
s_cbranch_execz Lpad6
v_mfma_f32_16x16x32_bf16 v[8:11], a[128:131], a[40:43], v[8:11]
v_mfma_f32_16x16x32_bf16 v[8:11], a[132:135], a[56:59], v[8:11]
ds_read_b64_tr_b16 a[190:191], v211 offset:44032
v_mfma_f32_16x16x32_bf16 v[12:15], a[132:135], a[60:63], v[12:15]
buffer_load_dwordx4 a[100:103], v233, s[16:19], s52 offen offset:2048 sc1
v_mfma_f32_16x16x32_bf16 v[12:15], a[128:131], a[44:47], v[12:15]
s_add_u32 m0, s56, 86016
ds_read_b64_tr_b16 a[192:193], v212 offset:28672
v_lshrrev_b32 v254, 5, v234
v_mfma_f32_16x16x32_bf16 v[16:19], a[136:139], a[32:35], v[16:19]
v_mfma_f32_16x16x32_bf16 v[16:19], a[140:143], a[48:51], v[16:19]
ds_read_b64_tr_b16 a[194:195], v212 offset:29696
v_mfma_f32_16x16x32_bf16 v[20:23], a[140:143], a[52:55], v[20:23]
v_lshlrev_b32 v250, 4, v252
v_mfma_f32_16x16x32_bf16 v[20:23], a[136:139], a[36:39], v[20:23]
ds_read_b64_tr_b16 a[196:197], v212 offset:43008
v_mfma_f32_16x16x32_bf16 v[24:27], a[136:139], a[40:43], v[24:27]
buffer_load_dwordx4 v227, s[8:11], s50 offen offset:1024 lds
v_mfma_f32_16x16x32_bf16 v[24:27], a[140:143], a[56:59], v[24:27]
ds_read_b64_tr_b16 a[198:199], v212 offset:44032
v_lshl_add_u32 v250, v253, 10, v250
v_mfma_f32_16x16x32_bf16 v[28:31], a[140:143], a[60:63], v[28:31]
v_mfma_f32_16x16x32_bf16 v[28:31], a[136:139], a[44:47], v[28:31]
ds_read_b64_tr_b16 a[200:201], v213 offset:28672
v_mfma_f32_16x16x32_bf16 v[32:35], a[144:147], a[32:35], v[32:35]
v_lshl_add_u32 v250, v254, 8, v250
v_mfma_f32_16x16x32_bf16 v[32:35], a[148:151], a[48:51], v[32:35]
ds_read_b64_tr_b16 a[202:203], v213 offset:29696
v_mfma_f32_16x16x32_bf16 v[36:39], a[148:151], a[52:55], v[36:39]
buffer_load_dwordx4 a[116:119], v233, s[16:19], s52 offen offset:3072 sc1
v_mfma_f32_16x16x32_bf16 v[36:39], a[144:147], a[36:39], v[36:39]
s_add_u32 m0, s56, 89088
ds_read_b64_tr_b16 a[204:205], v213 offset:43008
v_mfma_f32_16x16x32_bf16 v[40:43], a[144:147], a[40:43], v[40:43]
v_lshrrev_b32 v252, 4, v234
v_mfma_f32_16x16x32_bf16 v[40:43], a[148:151], a[56:59], v[40:43]
ds_read_b64_tr_b16 a[206:207], v213 offset:44032
v_mfma_f32_16x16x32_bf16 v[44:47], a[148:151], a[60:63], v[44:47]
v_mfma_f32_16x16x32_bf16 v[44:47], a[144:147], a[44:47], v[44:47]
ds_read_b64_tr_b16 a[208:209], v214 offset:28672
v_and_b32 v254, 1, v234
v_mfma_f32_16x16x32_bf16 v[48:51], a[152:155], a[32:35], v[48:51]
buffer_load_dwordx4 v231, s[12:15], s51 offen offset:2048 lds
v_mfma_f32_16x16x32_bf16 v[48:51], a[156:159], a[48:51], v[48:51]
ds_read_b64_tr_b16 a[210:211], v214 offset:29696
v_mfma_f32_16x16x32_bf16 v[52:55], a[156:159], a[52:55], v[52:55]
ds_read_b64_tr_b16 a[212:213], v214 offset:43008
v_mfma_f32_16x16x32_bf16 v[52:55], a[152:155], a[36:39], v[52:55]
v_lshlrev_b32 v254, 4, v254
v_mfma_f32_16x16x32_bf16 v[56:59], a[152:155], a[40:43], v[56:59]
s_lshl_b32 s42, s39, 8
ds_read_b64_tr_b16 a[214:215], v214 offset:44032
v_mfma_f32_16x16x32_bf16 v[56:59], a[156:159], a[56:59], v[56:59]
v_mfma_f32_16x16x32_bf16 v[60:63], a[156:159], a[60:63], v[60:63]
buffer_load_dwordx4 a[104:107], v233, s[16:19], s53 offen offset:0 sc1
v_mfma_f32_16x16x32_bf16 v[60:63], a[152:155], a[44:47], v[60:63]
s_add_u32 m0, s56, 86016
ds_read_b64_tr_b16 a[216:217], v215 offset:28672
v_add_u32 v254, s42, v254
v_mfma_f32_16x16x32_bf16 v[64:67], a[32:35], a[160:163], v[64:67]
ds_read_b64_tr_b16 a[218:219], v215 offset:29696
v_mfma_f32_16x16x32_bf16 v[64:67], a[48:51], a[164:167], v[64:67]
v_bfe_u32 v253, v234, 1, 2
v_mfma_f32_16x16x32_bf16 v[68:71], a[52:55], a[164:167], v[68:71]
ds_read_b64_tr_b16 a[220:221], v215 offset:43008
v_mfma_f32_16x16x32_bf16 v[68:71], a[36:39], a[160:163], v[68:71]
v_mfma_f32_16x16x32_bf16 v[72:75], a[40:43], a[160:163], v[72:75]
buffer_load_dwordx4 v228, s[8:11], s50 offen offset:2048 lds
v_mfma_f32_16x16x32_bf16 v[72:75], a[56:59], a[164:167], v[72:75]
ds_read_b64_tr_b16 a[222:223], v215 offset:44032
v_xor_b32 v253, v253, v252
v_mfma_f32_16x16x32_bf16 v[76:79], a[60:63], a[164:167], v[76:79]
ds_read_b64_tr_b16 a[224:225], v216 offset:28672
v_mfma_f32_16x16x32_bf16 v[76:79], a[44:47], a[160:163], v[76:79]
v_mfma_f32_16x16x32_bf16 v[80:83], a[32:35], a[168:171], v[80:83]
ds_read_b64_tr_b16 a[226:227], v216 offset:29696
v_lshl_add_u32 v244, v253, 5, v254
v_mfma_f32_16x16x32_bf16 v[80:83], a[48:51], a[172:175], v[80:83]
v_mfma_f32_16x16x32_bf16 v[84:87], a[52:55], a[172:175], v[84:87]
buffer_load_dwordx4 a[120:123], v233, s[16:19], s53 offen offset:1024 sc1
v_mfma_f32_16x16x32_bf16 v[84:87], a[36:39], a[168:171], v[84:87]
s_add_u32 m0, s56, 89088
ds_read_b64_tr_b16 a[228:229], v216 offset:43008
v_lshrrev_b32 v253, 3, v234
v_mfma_f32_16x16x32_bf16 v[88:91], a[40:43], a[168:171], v[88:91]
ds_read_b64_tr_b16 a[230:231], v216 offset:44032
v_mfma_f32_16x16x32_bf16 v[88:91], a[56:59], a[172:175], v[88:91]
v_mfma_f32_16x16x32_bf16 v[92:95], a[60:63], a[172:175], v[92:95]
v_mfma_f32_16x16x32_bf16 v[92:95], a[44:47], a[168:171], v[92:95]
v_lshl_add_u32 v244, v253, 11, v244
v_mfma_f32_16x16x32_bf16 v[96:99], a[176:179], a[32:35], v[96:99]
buffer_load_dwordx4 v232, s[12:15], s51 offen offset:3072 lds
v_mfma_f32_16x16x32_bf16 v[96:99], a[180:183], a[48:51], v[96:99]
v_mfma_f32_16x16x32_bf16 v[100:103], a[180:183], a[52:55], v[100:103]
v_lshl_add_u32 v254, v252, 11, v254
v_mfma_f32_16x16x32_bf16 v[100:103], a[176:179], a[36:39], v[100:103]
v_mfma_f32_16x16x32_bf16 v[104:107], a[176:179], a[40:43], v[104:107]
v_mfma_f32_16x16x32_bf16 v[104:107], a[180:183], a[56:59], v[104:107]
v_mfma_f32_16x16x32_bf16 v[108:111], a[180:183], a[60:63], v[108:111]
v_mfma_f32_16x16x32_bf16 v[108:111], a[176:179], a[44:47], v[108:111]
s_waitcnt vmcnt(17) lgkmcnt(0)
s_barrier
v_mfma_f32_16x16x32_bf16 v[112:115], a[184:187], a[32:35], v[112:115]
buffer_load_dwordx4 a[108:111], v233, s[16:19], s53 offen offset:2048 sc1
v_mfma_f32_16x16x32_bf16 v[112:115], a[188:191], a[48:51], v[112:115]
ds_read_b64_tr_b16 a[128:129], v217 offset:0
ds_read_b64_tr_b16 a[130:131], v217 offset:256
v_mfma_f32_16x16x32_bf16 v[116:119], a[188:191], a[52:55], v[116:119]
ds_read_b64_tr_b16 a[132:133], v217 offset:14336
v_bfe_u32 v253, v234, 1, 3
v_mfma_f32_16x16x32_bf16 v[116:119], a[184:187], a[36:39], v[116:119]
v_mfma_f32_16x16x32_bf16 v[120:123], a[184:187], a[40:43], v[120:123]
buffer_load_dwordx4 a[124:127], v233, s[16:19], s53 offen offset:3072 sc1
v_mfma_f32_16x16x32_bf16 v[120:123], a[188:191], a[56:59], v[120:123]
s_cmp_eq_u32 s48, 3
s_cselect_b32 s44, s60, 67108864
ds_read_b64_tr_b16 a[134:135], v217 offset:14592
ds_read_b64_tr_b16 a[136:137], v218 offset:0
v_mfma_f32_16x16x32_bf16 v[124:127], a[188:191], a[60:63], v[124:127]
ds_read_b64_tr_b16 a[138:139], v218 offset:256
v_xor_b32 v253, v253, v252
v_mfma_f32_16x16x32_bf16 v[124:127], a[184:187], a[44:47], v[124:127]
v_mfma_f32_16x16x32_bf16 v[128:131], a[192:195], a[32:35], v[128:131]
s_mov_b64 exec, 0xffffff
buffer_load_dword v246, v255, s[8:11], s44 offen
s_mov_b64 exec, -1
v_mfma_f32_16x16x32_bf16 v[128:131], a[196:199], a[48:51], v[128:131]
s_cmp_eq_u32 s48, 3
s_cselect_b32 s44, s61, 67108864
ds_read_b64_tr_b16 a[140:141], v218 offset:14336
ds_read_b64_tr_b16 a[142:143], v218 offset:14592
v_mfma_f32_16x16x32_bf16 v[132:135], a[196:199], a[52:55], v[132:135]
ds_read_b64_tr_b16 a[144:145], v217 offset:1024
v_lshl_add_u32 v242, v253, 5, v254
v_mfma_f32_16x16x32_bf16 v[132:135], a[192:195], a[36:39], v[132:135]
v_mfma_f32_16x16x32_bf16 v[136:139], a[192:195], a[40:43], v[136:139]
s_mov_b64 exec, 0xfffffff
buffer_load_dword v246, v255, s[12:15], s44 offen
s_mov_b64 exec, -1
v_mfma_f32_16x16x32_bf16 v[136:139], a[196:199], a[56:59], v[136:139]
s_add_u32 m0, s56, 0
ds_read_b64_tr_b16 a[146:147], v217 offset:1280
ds_read_b64_tr_b16 a[148:149], v217 offset:15360
v_mfma_f32_16x16x32_bf16 v[140:143], a[196:199], a[60:63], v[140:143]
s_bfe_u32 s55, s59, 0x40000
ds_read_b64_tr_b16 a[150:151], v217 offset:15616
v_mfma_f32_16x16x32_bf16 v[140:143], a[192:195], a[44:47], v[140:143]
s_mul_i32 s50, s55, 393216
v_xor_b32 v253, 4, v253
v_mfma_f32_16x16x32_bf16 v[144:147], a[200:203], a[32:35], v[144:147]
s_mul_i32 s51, s55, 458752
buffer_load_dwordx4 v226, s[8:11], s50 offen offset:0 lds
v_mfma_f32_16x16x32_bf16 v[144:147], a[204:207], a[48:51], v[144:147]
s_bfe_u32 s52, s59, 0x40000
ds_read_b64_tr_b16 a[152:153], v218 offset:1024
ds_read_b64_tr_b16 a[154:155], v218 offset:1280
v_mfma_f32_16x16x32_bf16 v[148:151], a[204:207], a[52:55], v[148:151]
s_lshl_b32 s52, s52, 13
v_mfma_f32_16x16x32_bf16 v[148:151], a[200:203], a[36:39], v[148:151]
s_add_u32 s52, s52, s54
ds_read_b64_tr_b16 a[156:157], v218 offset:15360
v_mfma_f32_16x16x32_bf16 v[152:155], a[200:203], a[40:43], v[152:155]
s_add_u32 s53, s52, 4096
buffer_load_dwordx4 a[0:3], v233, s[16:19], s52 offen offset:0 sc1
v_mfma_f32_16x16x32_bf16 v[152:155], a[204:207], a[56:59], v[152:155]
s_add_u32 m0, s56, 3072
ds_read_b64_tr_b16 a[158:159], v218 offset:15616
ds_read_b64_tr_b16 a[160:161], v217 offset:2048
v_mfma_f32_16x16x32_bf16 v[156:159], a[204:207], a[60:63], v[156:159]
v_lshl_add_u32 v243, v253, 5, v254
v_mfma_f32_16x16x32_bf16 v[156:159], a[200:203], a[44:47], v[156:159]
s_lshl_b32 s42, s3, 14
ds_read_b64_tr_b16 a[162:163], v217 offset:2304
v_mfma_f32_16x16x32_bf16 v[160:163], a[208:211], a[32:35], v[160:163]
ds_read_b64_tr_b16 a[164:165], v217 offset:16384
v_mfma_f32_16x16x32_bf16 v[160:163], a[212:215], a[48:51], v[160:163]
buffer_load_dwordx4 v229, s[12:15], s51 offen offset:0 lds
v_mfma_f32_16x16x32_bf16 v[164:167], a[212:215], a[52:55], v[164:167]
ds_read_b64_tr_b16 a[166:167], v217 offset:16640
v_add_u32 v240, s42, v242
v_mfma_f32_16x16x32_bf16 v[164:167], a[208:211], a[36:39], v[164:167]
s_add_u32 s45, s42, 7168
ds_read_b64_tr_b16 a[168:169], v218 offset:2048
v_mfma_f32_16x16x32_bf16 v[168:171], a[208:211], a[40:43], v[168:171]
ds_read_b64_tr_b16 a[170:171], v218 offset:2304
v_mfma_f32_16x16x32_bf16 v[168:171], a[212:215], a[56:59], v[168:171]
buffer_load_dwordx4 a[16:19], v233, s[16:19], s52 offen offset:1024 sc1
v_mfma_f32_16x16x32_bf16 v[172:175], a[212:215], a[60:63], v[172:175]
ds_read_b64_tr_b16 a[172:173], v218 offset:16384
v_add_u32 v241, s45, v243
v_mfma_f32_16x16x32_bf16 v[172:175], a[208:211], a[44:47], v[172:175]
s_lshl_b32 s45, s40, 7
ds_read_b64_tr_b16 a[174:175], v218 offset:16640
v_mfma_f32_16x16x32_bf16 v[176:179], a[216:219], a[32:35], v[176:179]
s_add_u32 s45, s45, s42
ds_read_b64_tr_b16 a[176:177], v219 offset:0
v_mfma_f32_16x16x32_bf16 v[176:179], a[220:223], a[48:51], v[176:179]
buffer_load_dwordx4 v230, s[12:15], s51 offen offset:1024 lds
v_mfma_f32_16x16x32_bf16 v[180:183], a[220:223], a[52:55], v[180:183]
ds_read_b64_tr_b16 a[178:179], v219 offset:1024
v_mfma_f32_16x16x32_bf16 v[180:183], a[216:219], a[36:39], v[180:183]
ds_read_b64_tr_b16 a[180:181], v219 offset:14336
v_add_u32 v244, s45, v244
v_mfma_f32_16x16x32_bf16 v[184:187], a[216:219], a[40:43], v[184:187]
s_and_b32 s42, s3, 1
ds_read_b64_tr_b16 a[182:183], v219 offset:15360
v_mfma_f32_16x16x32_bf16 v[184:187], a[220:223], a[56:59], v[184:187]
s_lshl_b32 s42, s42, 4
buffer_load_dwordx4 a[4:7], v233, s[16:19], s52 offen offset:2048 sc1
v_mfma_f32_16x16x32_bf16 v[188:191], a[220:223], a[60:63], v[188:191]
s_add_u32 m0, s56, 0
v_mfma_f32_16x16x32_bf16 v[188:191], a[216:219], a[44:47], v[188:191]
s_lshr_b32 s45, s3, 1
v_mfma_f32_16x16x32_bf16 v[192:195], a[224:227], a[32:35], v[192:195]
s_lshl_b32 s45, s45, 2
v_mfma_f32_16x16x32_bf16 v[192:195], a[228:231], a[48:51], v[192:195]
s_add_u32 s42, s42, s45
buffer_load_dwordx4 v227, s[8:11], s50 offen offset:1024 lds
v_mfma_f32_16x16x32_bf16 v[196:199], a[228:231], a[52:55], v[196:199]
s_lshl_b32 s42, s42, 11
v_add_u32 v242, s42, v242
v_mfma_f32_16x16x32_bf16 v[196:199], a[224:227], a[36:39], v[196:199]
s_add_u32 s42, s42, 15360
v_mfma_f32_16x16x32_bf16 v[200:203], a[224:227], a[40:43], v[200:203]
v_mfma_f32_16x16x32_bf16 v[200:203], a[228:231], a[56:59], v[200:203]
v_mfma_f32_16x16x32_bf16 v[204:207], a[228:231], a[60:63], v[204:207]
v_mfma_f32_16x16x32_bf16 v[204:207], a[224:227], a[44:47], v[204:207]
s_waitcnt vmcnt(26) lgkmcnt(0)
v_mfma_f32_16x16x32_bf16 v[0:3], a[128:131], a[64:67], v[0:3]
buffer_load_dwordx4 a[20:23], v233, s[16:19], s52 offen offset:3072 sc1
v_mfma_f32_16x16x32_bf16 v[0:3], a[132:135], a[80:83], v[0:3]
s_add_u32 m0, s56, 3072
ds_read_b64_tr_b16 a[184:185], v220 offset:0
ds_read_b64_tr_b16 a[186:187], v220 offset:1024
v_mfma_f32_16x16x32_bf16 v[4:7], a[132:135], a[84:87], v[4:7]
v_add_u32 v243, s42, v243
v_mfma_f32_16x16x32_bf16 v[4:7], a[128:131], a[68:71], v[4:7]
s_lshl_b32 s70, s3, 11
ds_read_b64_tr_b16 a[188:189], v220 offset:14336
v_mfma_f32_16x16x32_bf16 v[8:11], a[128:131], a[72:75], v[8:11]
s_add_u32 s70, s70, 32768
v_mfma_f32_16x16x32_bf16 v[8:11], a[132:135], a[88:91], v[8:11]
s_mul_i32 s79, s38, 1835008
ds_read_b64_tr_b16 a[190:191], v220 offset:15360
v_mfma_f32_16x16x32_bf16 v[12:15], a[132:135], a[92:95], v[12:15]
s_lshl_b32 s42, s32, 7
buffer_load_dwordx4 v231, s[12:15], s51 offen offset:2048 lds
v_mfma_f32_16x16x32_bf16 v[12:15], a[128:131], a[76:79], v[12:15]
s_add_u32 s42, s42, s3
ds_read_b64_tr_b16 a[192:193], v221 offset:0
v_mfma_f32_16x16x32_bf16 v[16:19], a[136:139], a[64:67], v[16:19]
s_lshl_b32 s73, s42, 7
v_mfma_f32_16x16x32_bf16 v[16:19], a[140:143], a[80:83], v[16:19]
s_add_u32 s73, s73, 48234496
ds_read_b64_tr_b16 a[194:195], v221 offset:1024
v_mfma_f32_16x16x32_bf16 v[20:23], a[140:143], a[84:87], v[20:23]
s_lshl_b32 s76, s39, 9
v_mfma_f32_16x16x32_bf16 v[20:23], a[136:139], a[68:71], v[20:23]
s_add_u32 s76, s76, s73
ds_read_b64_tr_b16 a[196:197], v221 offset:14336
v_mfma_f32_16x16x32_bf16 v[24:27], a[136:139], a[72:75], v[24:27]
s_lshr_b32 s45, s38, 1
buffer_load_dwordx4 a[8:11], v233, s[16:19], s53 offen offset:0 sc1
v_mfma_f32_16x16x32_bf16 v[24:27], a[140:143], a[88:91], v[24:27]
s_add_u32 m0, s56, 0
ds_read_b64_tr_b16 a[198:199], v221 offset:15360
v_mfma_f32_16x16x32_bf16 v[28:31], a[140:143], a[92:95], v[28:31]
s_lshl_b32 s45, s45, 16
v_mfma_f32_16x16x32_bf16 v[28:31], a[136:139], a[76:79], v[28:31]
s_add_u32 s77, s54, s45
ds_read_b64_tr_b16 a[200:201], v222 offset:0
v_mfma_f32_16x16x32_bf16 v[32:35], a[144:147], a[64:67], v[32:35]
s_lshl_b32 s45, s39, 8
v_mfma_f32_16x16x32_bf16 v[32:35], a[148:151], a[80:83], v[32:35]
s_add_u32 s77, s77, s45
ds_read_b64_tr_b16 a[202:203], v222 offset:1024
v_mfma_f32_16x16x32_bf16 v[36:39], a[148:151], a[84:87], v[36:39]
s_lshl_b32 s45, s40, 7
buffer_load_dwordx4 v228, s[8:11], s50 offen offset:2048 lds
v_mfma_f32_16x16x32_bf16 v[36:39], a[144:147], a[68:71], v[36:39]
s_add_u32 s77, s77, s45
ds_read_b64_tr_b16 a[204:205], v222 offset:14336
v_mfma_f32_16x16x32_bf16 v[40:43], a[144:147], a[72:75], v[40:43]
s_add_u32 s42, s32, s39
v_mfma_f32_16x16x32_bf16 v[40:43], a[148:151], a[88:91], v[40:43]
s_and_b32 s42, s42, 3
ds_read_b64_tr_b16 a[206:207], v222 offset:15360
v_mfma_f32_16x16x32_bf16 v[44:47], a[148:151], a[92:95], v[44:47]
s_lshl_b32 s42, s42, 2
v_mfma_f32_16x16x32_bf16 v[44:47], a[144:147], a[76:79], v[44:47]
ds_read_b64_tr_b16 a[208:209], v223 offset:0
v_mfma_f32_16x16x32_bf16 v[48:51], a[152:155], a[64:67], v[48:51]
buffer_load_dwordx4 a[24:27], v233, s[16:19], s53 offen offset:1024 sc1
v_mfma_f32_16x16x32_bf16 v[48:51], a[156:159], a[80:83], v[48:51]
s_add_u32 m0, s56, 3072
ds_read_b64_tr_b16 a[210:211], v223 offset:1024
v_mfma_f32_16x16x32_bf16 v[52:55], a[156:159], a[84:87], v[52:55]
ds_read_b64_tr_b16 a[212:213], v223 offset:14336
v_mfma_f32_16x16x32_bf16 v[52:55], a[152:155], a[68:71], v[52:55]
v_mfma_f32_16x16x32_bf16 v[56:59], a[152:155], a[72:75], v[56:59]
ds_read_b64_tr_b16 a[214:215], v223 offset:15360
v_mfma_f32_16x16x32_bf16 v[56:59], a[156:159], a[88:91], v[56:59]
v_mfma_f32_16x16x32_bf16 v[60:63], a[156:159], a[92:95], v[60:63]
buffer_load_dwordx4 v232, s[12:15], s51 offen offset:3072 lds
v_mfma_f32_16x16x32_bf16 v[60:63], a[152:155], a[76:79], v[60:63]
ds_read_b64_tr_b16 a[216:217], v224 offset:0
v_mfma_f32_16x16x32_bf16 v[64:67], a[64:67], a[160:163], v[64:67]
ds_read_b64_tr_b16 a[218:219], v224 offset:1024
v_mfma_f32_16x16x32_bf16 v[64:67], a[80:83], a[164:167], v[64:67]
v_mfma_f32_16x16x32_bf16 v[68:71], a[84:87], a[164:167], v[68:71]
ds_read_b64_tr_b16 a[220:221], v224 offset:14336
v_mfma_f32_16x16x32_bf16 v[68:71], a[68:71], a[160:163], v[68:71]
v_mfma_f32_16x16x32_bf16 v[72:75], a[72:75], a[160:163], v[72:75]
buffer_load_dwordx4 a[12:15], v233, s[16:19], s53 offen offset:2048 sc1
v_mfma_f32_16x16x32_bf16 v[72:75], a[88:91], a[164:167], v[72:75]
ds_read_b64_tr_b16 a[222:223], v224 offset:15360
v_mfma_f32_16x16x32_bf16 v[76:79], a[92:95], a[164:167], v[76:79]
ds_read_b64_tr_b16 a[224:225], v225 offset:0
v_mfma_f32_16x16x32_bf16 v[76:79], a[76:79], a[160:163], v[76:79]
v_mfma_f32_16x16x32_bf16 v[80:83], a[64:67], a[168:171], v[80:83]
ds_read_b64_tr_b16 a[226:227], v225 offset:1024
v_mfma_f32_16x16x32_bf16 v[80:83], a[80:83], a[172:175], v[80:83]
v_mfma_f32_16x16x32_bf16 v[84:87], a[84:87], a[172:175], v[84:87]
buffer_load_dwordx4 a[28:31], v233, s[16:19], s53 offen offset:3072 sc1
v_mfma_f32_16x16x32_bf16 v[84:87], a[68:71], a[168:171], v[84:87]
s_add_u32 m0, s56, 28672
ds_read_b64_tr_b16 a[228:229], v225 offset:14336
v_mfma_f32_16x16x32_bf16 v[88:91], a[72:75], a[168:171], v[88:91]
s_bfe_u32 s55, s59, 0x40004
ds_read_b64_tr_b16 a[230:231], v225 offset:15360
v_mfma_f32_16x16x32_bf16 v[88:91], a[88:91], a[172:175], v[88:91]
s_mul_i32 s50, s55, 393216
v_mfma_f32_16x16x32_bf16 v[92:95], a[92:95], a[172:175], v[92:95]
s_mul_i32 s51, s55, 458752
v_mfma_f32_16x16x32_bf16 v[92:95], a[76:79], a[168:171], v[92:95]
v_mfma_f32_16x16x32_bf16 v[96:99], a[176:179], a[64:67], v[96:99]
buffer_load_dwordx4 v226, s[8:11], s50 offen offset:0 lds
v_mfma_f32_16x16x32_bf16 v[96:99], a[180:183], a[80:83], v[96:99]
v_mfma_f32_16x16x32_bf16 v[100:103], a[180:183], a[84:87], v[100:103]
v_mfma_f32_16x16x32_bf16 v[100:103], a[176:179], a[68:71], v[100:103]
v_mfma_f32_16x16x32_bf16 v[104:107], a[176:179], a[72:75], v[104:107]
v_mfma_f32_16x16x32_bf16 v[104:107], a[180:183], a[88:91], v[104:107]
v_mfma_f32_16x16x32_bf16 v[108:111], a[180:183], a[92:95], v[108:111]
v_mfma_f32_16x16x32_bf16 v[108:111], a[176:179], a[76:79], v[108:111]
s_waitcnt vmcnt(20) lgkmcnt(0)
s_barrier
v_mfma_f32_16x16x32_bf16 v[112:115], a[184:187], a[64:67], v[112:115]
s_bfe_u32 s52, s59, 0x40004
ds_read_b64_tr_b16 a[128:129], v217 offset:28672
v_mfma_f32_16x16x32_bf16 v[112:115], a[188:191], a[80:83], v[112:115]
s_lshl_b32 s52, s52, 13
ds_read_b64_tr_b16 a[130:131], v217 offset:28928
v_mfma_f32_16x16x32_bf16 v[116:119], a[188:191], a[84:87], v[116:119]
s_add_u32 s52, s52, s54
ds_read_b64_tr_b16 a[132:133], v217 offset:43008
v_mfma_f32_16x16x32_bf16 v[116:119], a[184:187], a[68:71], v[116:119]
s_add_u32 s53, s52, 4096
buffer_load_dwordx4 a[32:35], v233, s[16:19], s52 offen offset:0 sc1
v_mfma_f32_16x16x32_bf16 v[120:123], a[184:187], a[72:75], v[120:123]
s_add_u32 m0, s56, 31744
ds_read_b64_tr_b16 a[134:135], v217 offset:43264
v_mfma_f32_16x16x32_bf16 v[120:123], a[188:191], a[88:91], v[120:123]
s_lshr_b32 s78, 0x32103210, 0
buffer_load_dwordx4 v229, s[12:15], s51 offen offset:0 lds
v_mfma_f32_16x16x32_bf16 v[124:127], a[188:191], a[92:95], v[124:127]
ds_read_b64_tr_b16 a[136:137], v218 offset:28672
ds_read_b64_tr_b16 a[138:139], v218 offset:28928
v_mfma_f32_16x16x32_bf16 v[124:127], a[184:187], a[76:79], v[124:127]
s_and_b32 s78, s78, 0xffff
v_mfma_f32_16x16x32_bf16 v[128:131], a[192:195], a[64:67], v[128:131]
ds_read_b64_tr_b16 a[140:141], v218 offset:43008
v_mfma_f32_16x16x32_bf16 v[128:131], a[196:199], a[80:83], v[128:131]
ds_read_b64_tr_b16 a[142:143], v218 offset:43264
v_mfma_f32_16x16x32_bf16 v[132:135], a[196:199], a[84:87], v[132:135]
buffer_load_dwordx4 a[48:51], v233, s[16:19], s52 offen offset:1024 sc1
v_mfma_f32_16x16x32_bf16 v[132:135], a[192:195], a[68:71], v[132:135]
ds_read_b64_tr_b16 a[144:145], v217 offset:29696
v_mfma_f32_16x16x32_bf16 v[136:139], a[192:195], a[72:75], v[136:139]
ds_read_b64_tr_b16 a[146:147], v217 offset:29952
v_mfma_f32_16x16x32_bf16 v[136:139], a[196:199], a[88:91], v[136:139]
ds_read_b64_tr_b16 a[148:149], v217 offset:44032
v_mfma_f32_16x16x32_bf16 v[140:143], a[196:199], a[92:95], v[140:143]
ds_read_b64_tr_b16 a[150:151], v217 offset:44288
v_mfma_f32_16x16x32_bf16 v[140:143], a[192:195], a[76:79], v[140:143]
s_lshr_b32 s45, 0x32103210, s42
buffer_load_dwordx4 v230, s[12:15], s51 offen offset:1024 lds
v_mfma_f32_16x16x32_bf16 v[144:147], a[200:203], a[64:67], v[144:147]
ds_read_b64_tr_b16 a[152:153], v218 offset:29696
v_mfma_f32_16x16x32_bf16 v[144:147], a[204:207], a[80:83], v[144:147]
ds_read_b64_tr_b16 a[154:155], v218 offset:29952
v_mfma_f32_16x16x32_bf16 v[148:151], a[204:207], a[84:87], v[148:151]
v_mfma_f32_16x16x32_bf16 v[148:151], a[200:203], a[68:71], v[148:151]
ds_read_b64_tr_b16 a[156:157], v218 offset:44032
v_mfma_f32_16x16x32_bf16 v[152:155], a[200:203], a[72:75], v[152:155]
buffer_load_dwordx4 a[36:39], v233, s[16:19], s52 offen offset:2048 sc1
v_mfma_f32_16x16x32_bf16 v[152:155], a[204:207], a[88:91], v[152:155]
s_add_u32 m0, s56, 28672
ds_read_b64_tr_b16 a[158:159], v218 offset:44288
ds_read_b64_tr_b16 a[160:161], v217 offset:30720
v_mfma_f32_16x16x32_bf16 v[156:159], a[204:207], a[92:95], v[156:159]
v_mfma_f32_16x16x32_bf16 v[156:159], a[200:203], a[76:79], v[156:159]
s_lshl_b32 s45, s45, 16
ds_read_b64_tr_b16 a[162:163], v217 offset:30976
v_mfma_f32_16x16x32_bf16 v[160:163], a[208:211], a[64:67], v[160:163]
ds_read_b64_tr_b16 a[164:165], v217 offset:45056
v_mfma_f32_16x16x32_bf16 v[160:163], a[212:215], a[80:83], v[160:163]
buffer_load_dwordx4 v227, s[8:11], s50 offen offset:1024 lds
v_mfma_f32_16x16x32_bf16 v[164:167], a[212:215], a[84:87], v[164:167]
ds_read_b64_tr_b16 a[166:167], v217 offset:45312
v_mfma_f32_16x16x32_bf16 v[164:167], a[208:211], a[68:71], v[164:167]
ds_read_b64_tr_b16 a[168:169], v218 offset:30720
v_mfma_f32_16x16x32_bf16 v[168:171], a[208:211], a[72:75], v[168:171]
ds_read_b64_tr_b16 a[170:171], v218 offset:30976
v_mfma_f32_16x16x32_bf16 v[168:171], a[212:215], a[88:91], v[168:171]
ds_read_b64_tr_b16 a[172:173], v218 offset:45056
v_mfma_f32_16x16x32_bf16 v[172:175], a[212:215], a[92:95], v[172:175]
s_or_b32 s78, s78, s45
buffer_load_dwordx4 a[52:55], v233, s[16:19], s52 offen offset:3072 sc1
v_mfma_f32_16x16x32_bf16 v[172:175], a[208:211], a[76:79], v[172:175]
s_add_u32 m0, s56, 31744
ds_read_b64_tr_b16 a[174:175], v218 offset:45312
v_mfma_f32_16x16x32_bf16 v[176:179], a[216:219], a[64:67], v[176:179]
ds_read_b64_tr_b16 a[176:177], v219 offset:28672
v_mfma_f32_16x16x32_bf16 v[176:179], a[220:223], a[80:83], v[176:179]
ds_read_b64_tr_b16 a[178:179], v219 offset:29696
v_mfma_f32_16x16x32_bf16 v[180:183], a[220:223], a[84:87], v[180:183]
v_mfma_f32_16x16x32_bf16 v[180:183], a[216:219], a[68:71], v[180:183]
buffer_load_dwordx4 v231, s[12:15], s51 offen offset:2048 lds
v_mfma_f32_16x16x32_bf16 v[184:187], a[216:219], a[72:75], v[184:187]
ds_read_b64_tr_b16 a[180:181], v219 offset:43008
ds_read_b64_tr_b16 a[182:183], v219 offset:44032
v_mfma_f32_16x16x32_bf16 v[184:187], a[220:223], a[88:91], v[184:187]
v_mfma_f32_16x16x32_bf16 v[188:191], a[220:223], a[92:95], v[188:191]
s_mov_b32 s81, 0x3e8293ee
v_mfma_f32_16x16x32_bf16 v[188:191], a[216:219], a[76:79], v[188:191]
v_mfma_f32_16x16x32_bf16 v[192:195], a[224:227], a[64:67], v[192:195]
buffer_load_dwordx4 a[40:43], v233, s[16:19], s53 offen offset:0 sc1
v_mfma_f32_16x16x32_bf16 v[192:195], a[228:231], a[80:83], v[192:195]
v_mfma_f32_16x16x32_bf16 v[196:199], a[228:231], a[84:87], v[196:199]
v_mfma_f32_16x16x32_bf16 v[196:199], a[224:227], a[68:71], v[196:199]
v_mfma_f32_16x16x32_bf16 v[200:203], a[224:227], a[72:75], v[200:203]
v_mfma_f32_16x16x32_bf16 v[200:203], a[228:231], a[88:91], v[200:203]
v_mfma_f32_16x16x32_bf16 v[204:207], a[228:231], a[92:95], v[204:207]
v_mfma_f32_16x16x32_bf16 v[204:207], a[224:227], a[76:79], v[204:207]
s_waitcnt vmcnt(27) lgkmcnt(0)
v_mfma_f32_16x16x32_bf16 v[0:3], a[128:131], a[96:99], v[0:3]
s_add_u32 m0, s56, 28672
s_nop 0
buffer_load_dwordx4 v228, s[8:11], s50 offen offset:2048 lds
v_mfma_f32_16x16x32_bf16 v[0:3], a[132:135], a[112:115], v[0:3]
ds_read_b64_tr_b16 a[184:185], v220 offset:28672
ds_read_b64_tr_b16 a[186:187], v220 offset:29696
v_mfma_f32_16x16x32_bf16 v[4:7], a[132:135], a[116:119], v[4:7]
v_mfma_f32_16x16x32_bf16 v[4:7], a[128:131], a[100:103], v[4:7]
ds_read_b64_tr_b16 a[188:189], v220 offset:43008
v_mfma_f32_16x16x32_bf16 v[8:11], a[128:131], a[104:107], v[8:11]
v_mfma_f32_16x16x32_bf16 v[8:11], a[132:135], a[120:123], v[8:11]
ds_read_b64_tr_b16 a[190:191], v220 offset:44032
v_mfma_f32_16x16x32_bf16 v[12:15], a[132:135], a[124:127], v[12:15]
buffer_load_dwordx4 a[56:59], v233, s[16:19], s53 offen offset:1024 sc1
v_mfma_f32_16x16x32_bf16 v[12:15], a[128:131], a[108:111], v[12:15]
s_add_u32 m0, s56, 31744
ds_read_b64_tr_b16 a[192:193], v221 offset:28672
v_mfma_f32_16x16x32_bf16 v[16:19], a[136:139], a[96:99], v[16:19]
v_mfma_f32_16x16x32_bf16 v[16:19], a[140:143], a[112:115], v[16:19]
ds_read_b64_tr_b16 a[194:195], v221 offset:29696
v_mfma_f32_16x16x32_bf16 v[20:23], a[140:143], a[116:119], v[20:23]
v_mfma_f32_16x16x32_bf16 v[20:23], a[136:139], a[100:103], v[20:23]
ds_read_b64_tr_b16 a[196:197], v221 offset:43008
v_mfma_f32_16x16x32_bf16 v[24:27], a[136:139], a[104:107], v[24:27]
buffer_load_dwordx4 v232, s[12:15], s51 offen offset:3072 lds
v_mfma_f32_16x16x32_bf16 v[24:27], a[140:143], a[120:123], v[24:27]
ds_read_b64_tr_b16 a[198:199], v221 offset:44032
v_mfma_f32_16x16x32_bf16 v[28:31], a[140:143], a[124:127], v[28:31]
v_mfma_f32_16x16x32_bf16 v[28:31], a[136:139], a[108:111], v[28:31]
ds_read_b64_tr_b16 a[200:201], v222 offset:28672
v_mfma_f32_16x16x32_bf16 v[32:35], a[144:147], a[96:99], v[32:35]
v_mfma_f32_16x16x32_bf16 v[32:35], a[148:151], a[112:115], v[32:35]
ds_read_b64_tr_b16 a[202:203], v222 offset:29696
v_mfma_f32_16x16x32_bf16 v[36:39], a[148:151], a[116:119], v[36:39]
buffer_load_dwordx4 a[44:47], v233, s[16:19], s53 offen offset:2048 sc1
v_mfma_f32_16x16x32_bf16 v[36:39], a[144:147], a[100:103], v[36:39]
ds_read_b64_tr_b16 a[204:205], v222 offset:43008
v_mfma_f32_16x16x32_bf16 v[40:43], a[144:147], a[104:107], v[40:43]
v_mfma_f32_16x16x32_bf16 v[40:43], a[148:151], a[120:123], v[40:43]
ds_read_b64_tr_b16 a[206:207], v222 offset:44032
v_mfma_f32_16x16x32_bf16 v[44:47], a[148:151], a[124:127], v[44:47]
v_mfma_f32_16x16x32_bf16 v[44:47], a[144:147], a[108:111], v[44:47]
ds_read_b64_tr_b16 a[208:209], v223 offset:28672
v_mfma_f32_16x16x32_bf16 v[48:51], a[152:155], a[96:99], v[48:51]
buffer_load_dwordx4 a[60:63], v233, s[16:19], s53 offen offset:3072 sc1
v_mfma_f32_16x16x32_bf16 v[48:51], a[156:159], a[112:115], v[48:51]
s_add_u32 m0, s56, 57344
ds_read_b64_tr_b16 a[210:211], v223 offset:29696
v_mfma_f32_16x16x32_bf16 v[52:55], a[156:159], a[116:119], v[52:55]
s_bfe_u32 s55, s59, 0x40008
ds_read_b64_tr_b16 a[212:213], v223 offset:43008
v_mfma_f32_16x16x32_bf16 v[52:55], a[152:155], a[100:103], v[52:55]
s_mul_i32 s50, s55, 393216
v_mfma_f32_16x16x32_bf16 v[56:59], a[152:155], a[104:107], v[56:59]
s_mul_i32 s51, s55, 458752
ds_read_b64_tr_b16 a[214:215], v223 offset:44032
v_mfma_f32_16x16x32_bf16 v[56:59], a[156:159], a[120:123], v[56:59]
v_mfma_f32_16x16x32_bf16 v[60:63], a[156:159], a[124:127], v[60:63]
buffer_load_dwordx4 v226, s[8:11], s50 offen offset:0 lds
v_mfma_f32_16x16x32_bf16 v[60:63], a[152:155], a[108:111], v[60:63]
s_bfe_u32 s52, s59, 0x40008
ds_read_b64_tr_b16 a[216:217], v224 offset:28672
v_mfma_f32_16x16x32_bf16 v[64:67], a[96:99], a[160:163], v[64:67]
s_lshl_b32 s52, s52, 13
ds_read_b64_tr_b16 a[218:219], v224 offset:29696
v_mfma_f32_16x16x32_bf16 v[64:67], a[112:115], a[164:167], v[64:67]
s_add_u32 s52, s52, s54
v_mfma_f32_16x16x32_bf16 v[68:71], a[116:119], a[164:167], v[68:71]
s_add_u32 s53, s52, 4096
ds_read_b64_tr_b16 a[220:221], v224 offset:43008
v_mfma_f32_16x16x32_bf16 v[68:71], a[100:103], a[160:163], v[68:71]
v_mfma_f32_16x16x32_bf16 v[72:75], a[104:107], a[160:163], v[72:75]
buffer_load_dwordx4 a[64:67], v233, s[16:19], s52 offen offset:0 sc1
v_mfma_f32_16x16x32_bf16 v[72:75], a[120:123], a[164:167], v[72:75]
s_add_u32 m0, s56, 60416
ds_read_b64_tr_b16 a[222:223], v224 offset:44032
v_mfma_f32_16x16x32_bf16 v[76:79], a[124:127], a[164:167], v[76:79]
ds_read_b64_tr_b16 a[224:225], v225 offset:28672
v_mfma_f32_16x16x32_bf16 v[76:79], a[108:111], a[160:163], v[76:79]
v_mfma_f32_16x16x32_bf16 v[80:83], a[96:99], a[168:171], v[80:83]
ds_read_b64_tr_b16 a[226:227], v225 offset:29696
v_mfma_f32_16x16x32_bf16 v[80:83], a[112:115], a[172:175], v[80:83]
v_mfma_f32_16x16x32_bf16 v[84:87], a[116:119], a[172:175], v[84:87]
buffer_load_dwordx4 v229, s[12:15], s51 offen offset:0 lds
v_mfma_f32_16x16x32_bf16 v[84:87], a[100:103], a[168:171], v[84:87]
ds_read_b64_tr_b16 a[228:229], v225 offset:43008
v_mfma_f32_16x16x32_bf16 v[88:91], a[104:107], a[168:171], v[88:91]
ds_read_b64_tr_b16 a[230:231], v225 offset:44032
v_mfma_f32_16x16x32_bf16 v[88:91], a[120:123], a[172:175], v[88:91]
v_mfma_f32_16x16x32_bf16 v[92:95], a[124:127], a[172:175], v[92:95]
v_mfma_f32_16x16x32_bf16 v[92:95], a[108:111], a[168:171], v[92:95]
v_mfma_f32_16x16x32_bf16 v[96:99], a[176:179], a[96:99], v[96:99]
buffer_load_dwordx4 a[80:83], v233, s[16:19], s52 offen offset:1024 sc1
v_mfma_f32_16x16x32_bf16 v[96:99], a[180:183], a[112:115], v[96:99]
v_mfma_f32_16x16x32_bf16 v[100:103], a[180:183], a[116:119], v[100:103]
v_mfma_f32_16x16x32_bf16 v[100:103], a[176:179], a[100:103], v[100:103]
v_mfma_f32_16x16x32_bf16 v[104:107], a[176:179], a[104:107], v[104:107]
Lpad3:
s_cbranch_execz Lpad7
v_mfma_f32_16x16x32_bf16 v[104:107], a[180:183], a[120:123], v[104:107]
v_mfma_f32_16x16x32_bf16 v[108:111], a[180:183], a[124:127], v[108:111]
v_mfma_f32_16x16x32_bf16 v[108:111], a[176:179], a[108:111], v[108:111]
s_waitcnt vmcnt(21) lgkmcnt(0)
s_barrier
v_mfma_f32_16x16x32_bf16 v[112:115], a[184:187], a[96:99], v[112:115]
buffer_load_dwordx4 v230, s[12:15], s51 offen offset:1024 lds
v_mfma_f32_16x16x32_bf16 v[112:115], a[188:191], a[112:115], v[112:115]
ds_read_b64_tr_b16 a[128:129], v208 offset:0
ds_read_b64_tr_b16 a[130:131], v208 offset:256
v_mfma_f32_16x16x32_bf16 v[116:119], a[188:191], a[116:119], v[116:119]
ds_read_b64_tr_b16 a[132:133], v208 offset:14336
v_mfma_f32_16x16x32_bf16 v[116:119], a[184:187], a[100:103], v[116:119]
v_mfma_f32_16x16x32_bf16 v[120:123], a[184:187], a[104:107], v[120:123]
ds_read_b64_tr_b16 a[134:135], v208 offset:14592
v_mfma_f32_16x16x32_bf16 v[120:123], a[188:191], a[120:123], v[120:123]
buffer_load_dwordx4 a[68:71], v233, s[16:19], s52 offen offset:2048 sc1
v_mfma_f32_16x16x32_bf16 v[124:127], a[188:191], a[124:127], v[124:127]
s_add_u32 m0, s56, 57344
ds_read_b64_tr_b16 a[136:137], v209 offset:0
ds_read_b64_tr_b16 a[138:139], v209 offset:256
v_mfma_f32_16x16x32_bf16 v[124:127], a[184:187], a[108:111], v[124:127]
v_mfma_f32_16x16x32_bf16 v[128:131], a[192:195], a[96:99], v[128:131]
ds_read_b64_tr_b16 a[140:141], v209 offset:14336
v_mfma_f32_16x16x32_bf16 v[128:131], a[196:199], a[112:115], v[128:131]
ds_read_b64_tr_b16 a[142:143], v209 offset:14592
v_mfma_f32_16x16x32_bf16 v[132:135], a[196:199], a[116:119], v[132:135]
buffer_load_dwordx4 v227, s[8:11], s50 offen offset:1024 lds
v_mfma_f32_16x16x32_bf16 v[132:135], a[192:195], a[100:103], v[132:135]
ds_read_b64_tr_b16 a[144:145], v208 offset:1024
v_mfma_f32_16x16x32_bf16 v[136:139], a[192:195], a[104:107], v[136:139]
ds_read_b64_tr_b16 a[146:147], v208 offset:1280
v_mfma_f32_16x16x32_bf16 v[136:139], a[196:199], a[120:123], v[136:139]
ds_read_b64_tr_b16 a[148:149], v208 offset:15360
v_mfma_f32_16x16x32_bf16 v[140:143], a[196:199], a[124:127], v[140:143]
ds_read_b64_tr_b16 a[150:151], v208 offset:15616
v_mfma_f32_16x16x32_bf16 v[140:143], a[192:195], a[108:111], v[140:143]
buffer_load_dwordx4 a[84:87], v233, s[16:19], s52 offen offset:3072 sc1
v_mfma_f32_16x16x32_bf16 v[144:147], a[200:203], a[96:99], v[144:147]
s_add_u32 m0, s56, 60416
ds_read_b64_tr_b16 a[152:153], v209 offset:1024
v_mfma_f32_16x16x32_bf16 v[144:147], a[204:207], a[112:115], v[144:147]
ds_read_b64_tr_b16 a[154:155], v209 offset:1280
v_mfma_f32_16x16x32_bf16 v[148:151], a[204:207], a[116:119], v[148:151]
v_mfma_f32_16x16x32_bf16 v[148:151], a[200:203], a[100:103], v[148:151]
ds_read_b64_tr_b16 a[156:157], v209 offset:15360
v_mfma_f32_16x16x32_bf16 v[152:155], a[200:203], a[104:107], v[152:155]
buffer_load_dwordx4 v231, s[12:15], s51 offen offset:2048 lds
v_mfma_f32_16x16x32_bf16 v[152:155], a[204:207], a[120:123], v[152:155]
ds_read_b64_tr_b16 a[158:159], v209 offset:15616
ds_read_b64_tr_b16 a[160:161], v208 offset:2048
v_mfma_f32_16x16x32_bf16 v[156:159], a[204:207], a[124:127], v[156:159]
v_mfma_f32_16x16x32_bf16 v[156:159], a[200:203], a[108:111], v[156:159]
ds_read_b64_tr_b16 a[162:163], v208 offset:2304
v_mfma_f32_16x16x32_bf16 v[160:163], a[208:211], a[96:99], v[160:163]
ds_read_b64_tr_b16 a[164:165], v208 offset:16384
v_mfma_f32_16x16x32_bf16 v[160:163], a[212:215], a[112:115], v[160:163]
buffer_load_dwordx4 a[72:75], v233, s[16:19], s53 offen offset:0 sc1
v_mfma_f32_16x16x32_bf16 v[164:167], a[212:215], a[116:119], v[164:167]
s_add_u32 m0, s56, 57344
ds_read_b64_tr_b16 a[166:167], v208 offset:16640
v_mfma_f32_16x16x32_bf16 v[164:167], a[208:211], a[100:103], v[164:167]
ds_read_b64_tr_b16 a[168:169], v209 offset:2048
v_mfma_f32_16x16x32_bf16 v[168:171], a[208:211], a[104:107], v[168:171]
ds_read_b64_tr_b16 a[170:171], v209 offset:2304
v_mfma_f32_16x16x32_bf16 v[168:171], a[212:215], a[120:123], v[168:171]
ds_read_b64_tr_b16 a[172:173], v209 offset:16384
v_mfma_f32_16x16x32_bf16 v[172:175], a[212:215], a[124:127], v[172:175]
buffer_load_dwordx4 v228, s[8:11], s50 offen offset:2048 lds
v_mfma_f32_16x16x32_bf16 v[172:175], a[208:211], a[108:111], v[172:175]
ds_read_b64_tr_b16 a[174:175], v209 offset:16640
v_mfma_f32_16x16x32_bf16 v[176:179], a[216:219], a[96:99], v[176:179]
ds_read_b64_tr_b16 a[176:177], v210 offset:0
v_mfma_f32_16x16x32_bf16 v[176:179], a[220:223], a[112:115], v[176:179]
ds_read_b64_tr_b16 a[178:179], v210 offset:1024
v_mfma_f32_16x16x32_bf16 v[180:183], a[220:223], a[116:119], v[180:183]
v_mfma_f32_16x16x32_bf16 v[180:183], a[216:219], a[100:103], v[180:183]
buffer_load_dwordx4 a[88:91], v233, s[16:19], s53 offen offset:1024 sc1
v_mfma_f32_16x16x32_bf16 v[184:187], a[216:219], a[104:107], v[184:187]
s_add_u32 m0, s56, 60416
ds_read_b64_tr_b16 a[180:181], v210 offset:14336
ds_read_b64_tr_b16 a[182:183], v210 offset:15360
v_mfma_f32_16x16x32_bf16 v[184:187], a[220:223], a[120:123], v[184:187]
v_mfma_f32_16x16x32_bf16 v[188:191], a[220:223], a[124:127], v[188:191]
v_mfma_f32_16x16x32_bf16 v[188:191], a[216:219], a[108:111], v[188:191]
v_mfma_f32_16x16x32_bf16 v[192:195], a[224:227], a[96:99], v[192:195]
buffer_load_dwordx4 v232, s[12:15], s51 offen offset:3072 lds
v_mfma_f32_16x16x32_bf16 v[192:195], a[228:231], a[112:115], v[192:195]
v_mfma_f32_16x16x32_bf16 v[196:199], a[228:231], a[116:119], v[196:199]
v_mfma_f32_16x16x32_bf16 v[196:199], a[224:227], a[100:103], v[196:199]
v_mfma_f32_16x16x32_bf16 v[200:203], a[224:227], a[104:107], v[200:203]
v_mfma_f32_16x16x32_bf16 v[200:203], a[228:231], a[120:123], v[200:203]
v_mfma_f32_16x16x32_bf16 v[204:207], a[228:231], a[124:127], v[204:207]
v_mfma_f32_16x16x32_bf16 v[204:207], a[224:227], a[108:111], v[204:207]
s_waitcnt vmcnt(28) lgkmcnt(0)
v_mfma_f32_16x16x32_bf16 v[0:3], a[128:131], a[0:3], v[0:3]
buffer_load_dwordx4 a[76:79], v233, s[16:19], s53 offen offset:2048 sc1
v_mfma_f32_16x16x32_bf16 v[0:3], a[132:135], a[16:19], v[0:3]
ds_read_b64_tr_b16 a[184:185], v211 offset:0
ds_read_b64_tr_b16 a[186:187], v211 offset:1024
v_mfma_f32_16x16x32_bf16 v[4:7], a[132:135], a[20:23], v[4:7]
v_mfma_f32_16x16x32_bf16 v[4:7], a[128:131], a[4:7], v[4:7]
ds_read_b64_tr_b16 a[188:189], v211 offset:14336
v_mfma_f32_16x16x32_bf16 v[8:11], a[128:131], a[8:11], v[8:11]
buffer_load_dwordx4 a[92:95], v233, s[16:19], s53 offen offset:3072 sc1
v_mfma_f32_16x16x32_bf16 v[8:11], a[132:135], a[24:27], v[8:11]
s_cmp_eq_u32 s48, 0
s_cselect_b32 s44, s46, 67108864
ds_read_b64_tr_b16 a[190:191], v211 offset:15360
v_mfma_f32_16x16x32_bf16 v[12:15], a[132:135], a[28:31], v[12:15]
v_mfma_f32_16x16x32_bf16 v[12:15], a[128:131], a[12:15], v[12:15]
ds_read_b64_tr_b16 a[192:193], v212 offset:0
v_mfma_f32_16x16x32_bf16 v[16:19], a[136:139], a[0:3], v[16:19]
v_mfma_f32_16x16x32_bf16 v[16:19], a[140:143], a[16:19], v[16:19]
s_mov_b32 exec_hi, 0xffffff
buffer_load_dword v246, v255, s[20:23], s44 offen
s_mov_b64 exec, -1
v_mfma_f32_16x16x32_bf16 v[20:23], a[140:143], a[20:23], v[20:23]
s_cmp_eq_u32 s48, 0
s_cselect_b32 s44, s47, 67108864
ds_read_b64_tr_b16 a[194:195], v212 offset:1024
v_mfma_f32_16x16x32_bf16 v[20:23], a[136:139], a[4:7], v[20:23]
ds_read_b64_tr_b16 a[196:197], v212 offset:14336
v_mfma_f32_16x16x32_bf16 v[24:27], a[136:139], a[8:11], v[24:27]
v_mfma_f32_16x16x32_bf16 v[24:27], a[140:143], a[24:27], v[24:27]
ds_read_b64_tr_b16 a[198:199], v212 offset:15360
v_mfma_f32_16x16x32_bf16 v[28:31], a[140:143], a[28:31], v[28:31]
s_mov_b64 exec, 0xffff
buffer_load_dword v246, v255, s[24:27], s44 offen
s_mov_b64 exec, -1
v_mfma_f32_16x16x32_bf16 v[28:31], a[136:139], a[12:15], v[28:31]
s_add_u32 m0, s56, 86016
ds_read_b64_tr_b16 a[200:201], v213 offset:0
v_mfma_f32_16x16x32_bf16 v[32:35], a[144:147], a[0:3], v[32:35]
s_bfe_u32 s55, s59, 0x4000c
v_mfma_f32_16x16x32_bf16 v[32:35], a[148:151], a[16:19], v[32:35]
s_mul_i32 s50, s55, 393216
ds_read_b64_tr_b16 a[202:203], v213 offset:1024
v_mfma_f32_16x16x32_bf16 v[36:39], a[148:151], a[20:23], v[36:39]
s_mul_i32 s51, s55, 458752
v_mfma_f32_16x16x32_bf16 v[36:39], a[144:147], a[4:7], v[36:39]
buffer_load_dwordx4 v226, s[8:11], s50 offen offset:0 lds
v_mfma_f32_16x16x32_bf16 v[40:43], a[144:147], a[8:11], v[40:43]
s_bfe_u32 s52, s59, 0x4000c
ds_read_b64_tr_b16 a[204:205], v213 offset:14336
v_mfma_f32_16x16x32_bf16 v[40:43], a[148:151], a[24:27], v[40:43]
s_lshl_b32 s52, s52, 13
ds_read_b64_tr_b16 a[206:207], v213 offset:15360
v_mfma_f32_16x16x32_bf16 v[44:47], a[148:151], a[28:31], v[44:47]
s_add_u32 s52, s52, s54
v_mfma_f32_16x16x32_bf16 v[44:47], a[144:147], a[12:15], v[44:47]
s_add_u32 s53, s52, 4096
ds_read_b64_tr_b16 a[208:209], v214 offset:0
v_mfma_f32_16x16x32_bf16 v[48:51], a[152:155], a[0:3], v[48:51]
buffer_load_dwordx4 a[96:99], v233, s[16:19], s52 offen offset:0 sc1
v_mfma_f32_16x16x32_bf16 v[48:51], a[156:159], a[16:19], v[48:51]
s_add_u32 m0, s56, 89088
ds_read_b64_tr_b16 a[210:211], v214 offset:1024
v_mfma_f32_16x16x32_bf16 v[52:55], a[156:159], a[20:23], v[52:55]
ds_read_b64_tr_b16 a[212:213], v214 offset:14336
v_mfma_f32_16x16x32_bf16 v[52:55], a[152:155], a[4:7], v[52:55]
v_mfma_f32_16x16x32_bf16 v[56:59], a[152:155], a[8:11], v[56:59]
ds_read_b64_tr_b16 a[214:215], v214 offset:15360
v_mfma_f32_16x16x32_bf16 v[56:59], a[156:159], a[24:27], v[56:59]
buffer_load_dwordx4 v229, s[12:15], s51 offen offset:0 lds
v_mfma_f32_16x16x32_bf16 v[60:63], a[156:159], a[28:31], v[60:63]
ds_read_b64_tr_b16 a[216:217], v215 offset:0
v_mfma_f32_16x16x32_bf16 v[60:63], a[152:155], a[12:15], v[60:63]
v_mfma_f32_16x16x32_bf16 v[64:67], a[0:3], a[160:163], v[64:67]
ds_read_b64_tr_b16 a[218:219], v215 offset:1024
v_mfma_f32_16x16x32_bf16 v[64:67], a[16:19], a[164:167], v[64:67]
v_mfma_f32_16x16x32_bf16 v[68:71], a[20:23], a[164:167], v[68:71]
buffer_load_dwordx4 a[112:115], v233, s[16:19], s52 offen offset:1024 sc1
v_mfma_f32_16x16x32_bf16 v[68:71], a[4:7], a[160:163], v[68:71]
ds_read_b64_tr_b16 a[220:221], v215 offset:14336
v_mfma_f32_16x16x32_bf16 v[72:75], a[8:11], a[160:163], v[72:75]
ds_read_b64_tr_b16 a[222:223], v215 offset:15360
v_mfma_f32_16x16x32_bf16 v[72:75], a[24:27], a[164:167], v[72:75]
v_mfma_f32_16x16x32_bf16 v[76:79], a[28:31], a[164:167], v[76:79]
ds_read_b64_tr_b16 a[224:225], v216 offset:0
v_mfma_f32_16x16x32_bf16 v[76:79], a[12:15], a[160:163], v[76:79]
buffer_load_dwordx4 v230, s[12:15], s51 offen offset:1024 lds
v_mfma_f32_16x16x32_bf16 v[80:83], a[0:3], a[168:171], v[80:83]
ds_read_b64_tr_b16 a[226:227], v216 offset:1024
v_mfma_f32_16x16x32_bf16 v[80:83], a[16:19], a[172:175], v[80:83]
v_mfma_f32_16x16x32_bf16 v[84:87], a[20:23], a[172:175], v[84:87]
ds_read_b64_tr_b16 a[228:229], v216 offset:14336
v_mfma_f32_16x16x32_bf16 v[84:87], a[4:7], a[168:171], v[84:87]
v_mfma_f32_16x16x32_bf16 v[88:91], a[8:11], a[168:171], v[88:91]
buffer_load_dwordx4 a[100:103], v233, s[16:19], s52 offen offset:2048 sc1
v_mfma_f32_16x16x32_bf16 v[88:91], a[24:27], a[172:175], v[88:91]
s_add_u32 m0, s56, 86016
ds_read_b64_tr_b16 a[230:231], v216 offset:15360
v_mfma_f32_16x16x32_bf16 v[92:95], a[28:31], a[172:175], v[92:95]
v_mfma_f32_16x16x32_bf16 v[92:95], a[12:15], a[168:171], v[92:95]
v_mfma_f32_16x16x32_bf16 v[96:99], a[176:179], a[0:3], v[96:99]
v_mfma_f32_16x16x32_bf16 v[96:99], a[180:183], a[16:19], v[96:99]
buffer_load_dwordx4 v227, s[8:11], s50 offen offset:1024 lds
v_mfma_f32_16x16x32_bf16 v[100:103], a[180:183], a[20:23], v[100:103]
v_mfma_f32_16x16x32_bf16 v[100:103], a[176:179], a[4:7], v[100:103]
v_mfma_f32_16x16x32_bf16 v[104:107], a[176:179], a[8:11], v[104:107]
v_mfma_f32_16x16x32_bf16 v[104:107], a[180:183], a[24:27], v[104:107]
v_mfma_f32_16x16x32_bf16 v[108:111], a[180:183], a[28:31], v[108:111]
v_mfma_f32_16x16x32_bf16 v[108:111], a[176:179], a[12:15], v[108:111]
s_waitcnt vmcnt(26) lgkmcnt(0)
s_barrier
v_mfma_f32_16x16x32_bf16 v[112:115], a[184:187], a[0:3], v[112:115]
buffer_load_dwordx4 a[116:119], v233, s[16:19], s52 offen offset:3072 sc1
v_mfma_f32_16x16x32_bf16 v[112:115], a[188:191], a[16:19], v[112:115]
s_add_u32 m0, s56, 89088
ds_read_b64_tr_b16 a[128:129], v208 offset:28672
ds_read_b64_tr_b16 a[130:131], v208 offset:28928
v_mfma_f32_16x16x32_bf16 v[116:119], a[188:191], a[20:23], v[116:119]
ds_read_b64_tr_b16 a[132:133], v208 offset:43008
v_mfma_f32_16x16x32_bf16 v[116:119], a[184:187], a[4:7], v[116:119]
v_mfma_f32_16x16x32_bf16 v[120:123], a[184:187], a[8:11], v[120:123]
buffer_load_dwordx4 v231, s[12:15], s51 offen offset:2048 lds
v_mfma_f32_16x16x32_bf16 v[120:123], a[188:191], a[24:27], v[120:123]
ds_read_b64_tr_b16 a[134:135], v208 offset:43264
ds_read_b64_tr_b16 a[136:137], v209 offset:28672
v_mfma_f32_16x16x32_bf16 v[124:127], a[188:191], a[28:31], v[124:127]
ds_read_b64_tr_b16 a[138:139], v209 offset:28928
v_mfma_f32_16x16x32_bf16 v[124:127], a[184:187], a[12:15], v[124:127]
v_mfma_f32_16x16x32_bf16 v[128:131], a[192:195], a[0:3], v[128:131]
ds_read_b64_tr_b16 a[140:141], v209 offset:43008
v_mfma_f32_16x16x32_bf16 v[128:131], a[196:199], a[16:19], v[128:131]
buffer_load_dwordx4 a[104:107], v233, s[16:19], s53 offen offset:0 sc1
v_mfma_f32_16x16x32_bf16 v[132:135], a[196:199], a[20:23], v[132:135]
s_add_u32 m0, s56, 86016
ds_read_b64_tr_b16 a[142:143], v209 offset:43264
ds_read_b64_tr_b16 a[144:145], v208 offset:29696
v_mfma_f32_16x16x32_bf16 v[132:135], a[192:195], a[4:7], v[132:135]
v_mfma_f32_16x16x32_bf16 v[136:139], a[192:195], a[8:11], v[136:139]
ds_read_b64_tr_b16 a[146:147], v208 offset:29952
v_mfma_f32_16x16x32_bf16 v[136:139], a[196:199], a[24:27], v[136:139]
buffer_load_dwordx4 v228, s[8:11], s50 offen offset:2048 lds
v_mfma_f32_16x16x32_bf16 v[140:143], a[196:199], a[28:31], v[140:143]
ds_read_b64_tr_b16 a[148:149], v208 offset:44032
ds_read_b64_tr_b16 a[150:151], v208 offset:44288
v_mfma_f32_16x16x32_bf16 v[140:143], a[192:195], a[12:15], v[140:143]
v_mfma_f32_16x16x32_bf16 v[144:147], a[200:203], a[0:3], v[144:147]
ds_read_b64_tr_b16 a[152:153], v209 offset:29696
v_mfma_f32_16x16x32_bf16 v[144:147], a[204:207], a[16:19], v[144:147]
ds_read_b64_tr_b16 a[154:155], v209 offset:29952
v_mfma_f32_16x16x32_bf16 v[148:151], a[204:207], a[20:23], v[148:151]
buffer_load_dwordx4 a[120:123], v233, s[16:19], s53 offen offset:1024 sc1
v_mfma_f32_16x16x32_bf16 v[148:151], a[200:203], a[4:7], v[148:151]
s_add_u32 m0, s56, 89088
ds_read_b64_tr_b16 a[156:157], v209 offset:44032
v_mfma_f32_16x16x32_bf16 v[152:155], a[200:203], a[8:11], v[152:155]
ds_read_b64_tr_b16 a[158:159], v209 offset:44288
v_mfma_f32_16x16x32_bf16 v[152:155], a[204:207], a[24:27], v[152:155]
ds_read_b64_tr_b16 a[160:161], v208 offset:30720
v_mfma_f32_16x16x32_bf16 v[156:159], a[204:207], a[28:31], v[156:159]
v_mfma_f32_16x16x32_bf16 v[156:159], a[200:203], a[12:15], v[156:159]
buffer_load_dwordx4 v232, s[12:15], s51 offen offset:3072 lds
v_mfma_f32_16x16x32_bf16 v[160:163], a[208:211], a[0:3], v[160:163]
ds_read_b64_tr_b16 a[162:163], v208 offset:30976
ds_read_b64_tr_b16 a[164:165], v208 offset:45056
v_mfma_f32_16x16x32_bf16 v[160:163], a[212:215], a[16:19], v[160:163]
ds_read_b64_tr_b16 a[166:167], v208 offset:45312
v_mfma_f32_16x16x32_bf16 v[164:167], a[212:215], a[20:23], v[164:167]
v_mfma_f32_16x16x32_bf16 v[164:167], a[208:211], a[4:7], v[164:167]
buffer_load_dwordx4 a[108:111], v233, s[16:19], s53 offen offset:2048 sc1
v_mfma_f32_16x16x32_bf16 v[168:171], a[208:211], a[8:11], v[168:171]
ds_read_b64_tr_b16 a[168:169], v209 offset:30720
ds_read_b64_tr_b16 a[170:171], v209 offset:30976
v_mfma_f32_16x16x32_bf16 v[168:171], a[212:215], a[24:27], v[168:171]
ds_read_b64_tr_b16 a[172:173], v209 offset:45056
v_mfma_f32_16x16x32_bf16 v[172:175], a[212:215], a[28:31], v[172:175]
v_mfma_f32_16x16x32_bf16 v[172:175], a[208:211], a[12:15], v[172:175]
ds_read_b64_tr_b16 a[174:175], v209 offset:45312
v_mfma_f32_16x16x32_bf16 v[176:179], a[216:219], a[0:3], v[176:179]
buffer_load_dwordx4 a[124:127], v233, s[16:19], s53 offen offset:3072 sc1
v_mfma_f32_16x16x32_bf16 v[176:179], a[220:223], a[16:19], v[176:179]
s_cmp_eq_u32 s48, 1
s_cselect_b32 s44, s46, 67108864
ds_read_b64_tr_b16 a[176:177], v210 offset:28672
ds_read_b64_tr_b16 a[178:179], v210 offset:29696
v_mfma_f32_16x16x32_bf16 v[180:183], a[220:223], a[20:23], v[180:183]
v_mfma_f32_16x16x32_bf16 v[180:183], a[216:219], a[4:7], v[180:183]
ds_read_b64_tr_b16 a[180:181], v210 offset:43008
v_mfma_f32_16x16x32_bf16 v[184:187], a[216:219], a[8:11], v[184:187]
s_mov_b32 exec_hi, 0xffffff
buffer_load_dword v246, v255, s[20:23], s44 offen
s_mov_b64 exec, -1
v_mfma_f32_16x16x32_bf16 v[184:187], a[220:223], a[24:27], v[184:187]
s_cmp_eq_u32 s48, 1
s_cselect_b32 s44, s47, 67108864
ds_read_b64_tr_b16 a[182:183], v210 offset:44032
v_mfma_f32_16x16x32_bf16 v[188:191], a[220:223], a[28:31], v[188:191]
v_mfma_f32_16x16x32_bf16 v[188:191], a[216:219], a[12:15], v[188:191]
v_mfma_f32_16x16x32_bf16 v[192:195], a[224:227], a[0:3], v[192:195]
v_mfma_f32_16x16x32_bf16 v[192:195], a[228:231], a[16:19], v[192:195]
s_mov_b64 exec, 0xffff
buffer_load_dword v246, v255, s[24:27], s44 offen
s_mov_b64 exec, -1
v_mfma_f32_16x16x32_bf16 v[196:199], a[228:231], a[20:23], v[196:199]
v_mfma_f32_16x16x32_bf16 v[196:199], a[224:227], a[4:7], v[196:199]
v_mfma_f32_16x16x32_bf16 v[200:203], a[224:227], a[8:11], v[200:203]
v_mfma_f32_16x16x32_bf16 v[200:203], a[228:231], a[24:27], v[200:203]
v_mfma_f32_16x16x32_bf16 v[204:207], a[228:231], a[28:31], v[204:207]
v_mfma_f32_16x16x32_bf16 v[204:207], a[224:227], a[12:15], v[204:207]
s_waitcnt vmcnt(34) lgkmcnt(0)
v_mfma_f32_16x16x32_bf16 v[0:3], a[128:131], a[32:35], v[0:3]
s_add_u32 m0, s56, 0
ds_read_b64_tr_b16 a[184:185], v211 offset:28672
v_mfma_f32_16x16x32_bf16 v[0:3], a[132:135], a[48:51], v[0:3]
s_bfe_u32 s55, s59, 0x40010
ds_read_b64_tr_b16 a[186:187], v211 offset:29696
v_mfma_f32_16x16x32_bf16 v[4:7], a[132:135], a[52:55], v[4:7]
s_mul_i32 s50, s55, 393216
v_mfma_f32_16x16x32_bf16 v[4:7], a[128:131], a[36:39], v[4:7]
s_mul_i32 s51, s55, 458752
buffer_load_dwordx4 v226, s[8:11], s50 offen offset:0 lds
v_mfma_f32_16x16x32_bf16 v[8:11], a[128:131], a[40:43], v[8:11]
s_bfe_u32 s52, s59, 0x40010
ds_read_b64_tr_b16 a[188:189], v211 offset:43008
v_mfma_f32_16x16x32_bf16 v[8:11], a[132:135], a[56:59], v[8:11]
s_lshl_b32 s52, s52, 13
ds_read_b64_tr_b16 a[190:191], v211 offset:44032
v_mfma_f32_16x16x32_bf16 v[12:15], a[132:135], a[60:63], v[12:15]
s_add_u32 s52, s52, s54
v_mfma_f32_16x16x32_bf16 v[12:15], a[128:131], a[44:47], v[12:15]
s_add_u32 s53, s52, 4096
buffer_load_dwordx4 a[0:3], v233, s[16:19], s52 offen offset:0 sc1
v_mfma_f32_16x16x32_bf16 v[16:19], a[136:139], a[32:35], v[16:19]
s_add_u32 m0, s56, 3072
ds_read_b64_tr_b16 a[192:193], v212 offset:28672
v_mfma_f32_16x16x32_bf16 v[16:19], a[140:143], a[48:51], v[16:19]
ds_read_b64_tr_b16 a[194:195], v212 offset:29696
v_mfma_f32_16x16x32_bf16 v[20:23], a[140:143], a[52:55], v[20:23]
v_mfma_f32_16x16x32_bf16 v[20:23], a[136:139], a[36:39], v[20:23]
ds_read_b64_tr_b16 a[196:197], v212 offset:43008
v_mfma_f32_16x16x32_bf16 v[24:27], a[136:139], a[40:43], v[24:27]
buffer_load_dwordx4 v229, s[12:15], s51 offen offset:0 lds
v_mfma_f32_16x16x32_bf16 v[24:27], a[140:143], a[56:59], v[24:27]
ds_read_b64_tr_b16 a[198:199], v212 offset:44032
v_mfma_f32_16x16x32_bf16 v[28:31], a[140:143], a[60:63], v[28:31]
v_mfma_f32_16x16x32_bf16 v[28:31], a[136:139], a[44:47], v[28:31]
ds_read_b64_tr_b16 a[200:201], v213 offset:28672
v_mfma_f32_16x16x32_bf16 v[32:35], a[144:147], a[32:35], v[32:35]
v_mfma_f32_16x16x32_bf16 v[32:35], a[148:151], a[48:51], v[32:35]
ds_read_b64_tr_b16 a[202:203], v213 offset:29696
v_mfma_f32_16x16x32_bf16 v[36:39], a[148:151], a[52:55], v[36:39]
buffer_load_dwordx4 a[16:19], v233, s[16:19], s52 offen offset:1024 sc1
v_mfma_f32_16x16x32_bf16 v[36:39], a[144:147], a[36:39], v[36:39]
ds_read_b64_tr_b16 a[204:205], v213 offset:43008
v_mfma_f32_16x16x32_bf16 v[40:43], a[144:147], a[40:43], v[40:43]
v_mfma_f32_16x16x32_bf16 v[40:43], a[148:151], a[56:59], v[40:43]
ds_read_b64_tr_b16 a[206:207], v213 offset:44032
v_mfma_f32_16x16x32_bf16 v[44:47], a[148:151], a[60:63], v[44:47]
v_mfma_f32_16x16x32_bf16 v[44:47], a[144:147], a[44:47], v[44:47]
ds_read_b64_tr_b16 a[208:209], v214 offset:28672
v_mfma_f32_16x16x32_bf16 v[48:51], a[152:155], a[32:35], v[48:51]
buffer_load_dwordx4 v230, s[12:15], s51 offen offset:1024 lds
v_mfma_f32_16x16x32_bf16 v[48:51], a[156:159], a[48:51], v[48:51]
ds_read_b64_tr_b16 a[210:211], v214 offset:29696
v_mfma_f32_16x16x32_bf16 v[52:55], a[156:159], a[52:55], v[52:55]
ds_read_b64_tr_b16 a[212:213], v214 offset:43008
v_mfma_f32_16x16x32_bf16 v[52:55], a[152:155], a[36:39], v[52:55]
v_mfma_f32_16x16x32_bf16 v[56:59], a[152:155], a[40:43], v[56:59]
ds_read_b64_tr_b16 a[214:215], v214 offset:44032
v_mfma_f32_16x16x32_bf16 v[56:59], a[156:159], a[56:59], v[56:59]
v_mfma_f32_16x16x32_bf16 v[60:63], a[156:159], a[60:63], v[60:63]
buffer_load_dwordx4 a[4:7], v233, s[16:19], s52 offen offset:2048 sc1
v_mfma_f32_16x16x32_bf16 v[60:63], a[152:155], a[44:47], v[60:63]
s_add_u32 m0, s56, 0
ds_read_b64_tr_b16 a[216:217], v215 offset:28672
v_mfma_f32_16x16x32_bf16 v[64:67], a[32:35], a[160:163], v[64:67]
ds_read_b64_tr_b16 a[218:219], v215 offset:29696
v_mfma_f32_16x16x32_bf16 v[64:67], a[48:51], a[164:167], v[64:67]
v_mfma_f32_16x16x32_bf16 v[68:71], a[52:55], a[164:167], v[68:71]
ds_read_b64_tr_b16 a[220:221], v215 offset:43008
v_mfma_f32_16x16x32_bf16 v[68:71], a[36:39], a[160:163], v[68:71]
v_mfma_f32_16x16x32_bf16 v[72:75], a[40:43], a[160:163], v[72:75]
buffer_load_dwordx4 v227, s[8:11], s50 offen offset:1024 lds
v_mfma_f32_16x16x32_bf16 v[72:75], a[56:59], a[164:167], v[72:75]
ds_read_b64_tr_b16 a[222:223], v215 offset:44032
v_mfma_f32_16x16x32_bf16 v[76:79], a[60:63], a[164:167], v[76:79]
ds_read_b64_tr_b16 a[224:225], v216 offset:28672
v_mfma_f32_16x16x32_bf16 v[76:79], a[44:47], a[160:163], v[76:79]
v_mfma_f32_16x16x32_bf16 v[80:83], a[32:35], a[168:171], v[80:83]
ds_read_b64_tr_b16 a[226:227], v216 offset:29696
v_mfma_f32_16x16x32_bf16 v[80:83], a[48:51], a[172:175], v[80:83]
v_mfma_f32_16x16x32_bf16 v[84:87], a[52:55], a[172:175], v[84:87]
buffer_load_dwordx4 a[20:23], v233, s[16:19], s52 offen offset:3072 sc1
v_mfma_f32_16x16x32_bf16 v[84:87], a[36:39], a[168:171], v[84:87]
s_add_u32 m0, s56, 3072
ds_read_b64_tr_b16 a[228:229], v216 offset:43008
v_mfma_f32_16x16x32_bf16 v[88:91], a[40:43], a[168:171], v[88:91]
ds_read_b64_tr_b16 a[230:231], v216 offset:44032
v_mfma_f32_16x16x32_bf16 v[88:91], a[56:59], a[172:175], v[88:91]
v_mfma_f32_16x16x32_bf16 v[92:95], a[60:63], a[172:175], v[92:95]
v_mfma_f32_16x16x32_bf16 v[92:95], a[44:47], a[168:171], v[92:95]
v_mfma_f32_16x16x32_bf16 v[96:99], a[176:179], a[32:35], v[96:99]
buffer_load_dwordx4 v231, s[12:15], s51 offen offset:2048 lds
v_mfma_f32_16x16x32_bf16 v[96:99], a[180:183], a[48:51], v[96:99]
v_mfma_f32_16x16x32_bf16 v[100:103], a[180:183], a[52:55], v[100:103]
v_mfma_f32_16x16x32_bf16 v[100:103], a[176:179], a[36:39], v[100:103]
v_mfma_f32_16x16x32_bf16 v[104:107], a[176:179], a[40:43], v[104:107]
v_mfma_f32_16x16x32_bf16 v[104:107], a[180:183], a[56:59], v[104:107]
v_mfma_f32_16x16x32_bf16 v[108:111], a[180:183], a[60:63], v[108:111]
v_mfma_f32_16x16x32_bf16 v[108:111], a[176:179], a[44:47], v[108:111]
s_waitcnt vmcnt(30) lgkmcnt(0)
s_barrier
v_mfma_f32_16x16x32_bf16 v[112:115], a[184:187], a[32:35], v[112:115]
buffer_load_dwordx4 a[8:11], v233, s[16:19], s53 offen offset:0 sc1
v_mfma_f32_16x16x32_bf16 v[112:115], a[188:191], a[48:51], v[112:115]
s_add_u32 m0, s56, 0
ds_read_b64_tr_b16 a[128:129], v217 offset:0
ds_read_b64_tr_b16 a[130:131], v217 offset:256
v_mfma_f32_16x16x32_bf16 v[116:119], a[188:191], a[52:55], v[116:119]
ds_read_b64_tr_b16 a[132:133], v217 offset:14336
v_mfma_f32_16x16x32_bf16 v[116:119], a[184:187], a[36:39], v[116:119]
v_mfma_f32_16x16x32_bf16 v[120:123], a[184:187], a[40:43], v[120:123]
ds_read_b64_tr_b16 a[134:135], v217 offset:14592
v_mfma_f32_16x16x32_bf16 v[120:123], a[188:191], a[56:59], v[120:123]
buffer_load_dwordx4 v228, s[8:11], s50 offen offset:2048 lds
v_mfma_f32_16x16x32_bf16 v[124:127], a[188:191], a[60:63], v[124:127]
ds_read_b64_tr_b16 a[136:137], v218 offset:0
ds_read_b64_tr_b16 a[138:139], v218 offset:256
v_mfma_f32_16x16x32_bf16 v[124:127], a[184:187], a[44:47], v[124:127]
v_mfma_f32_16x16x32_bf16 v[128:131], a[192:195], a[32:35], v[128:131]
ds_read_b64_tr_b16 a[140:141], v218 offset:14336
v_mfma_f32_16x16x32_bf16 v[128:131], a[196:199], a[48:51], v[128:131]
ds_read_b64_tr_b16 a[142:143], v218 offset:14592
v_mfma_f32_16x16x32_bf16 v[132:135], a[196:199], a[52:55], v[132:135]
ds_read_b64_tr_b16 a[144:145], v217 offset:1024
v_mfma_f32_16x16x32_bf16 v[132:135], a[192:195], a[36:39], v[132:135]
buffer_load_dwordx4 a[24:27], v233, s[16:19], s53 offen offset:1024 sc1
v_mfma_f32_16x16x32_bf16 v[136:139], a[192:195], a[40:43], v[136:139]
s_add_u32 m0, s56, 3072
ds_read_b64_tr_b16 a[146:147], v217 offset:1280
v_mfma_f32_16x16x32_bf16 v[136:139], a[196:199], a[56:59], v[136:139]
ds_read_b64_tr_b16 a[148:149], v217 offset:15360
v_mfma_f32_16x16x32_bf16 v[140:143], a[196:199], a[60:63], v[140:143]
ds_read_b64_tr_b16 a[150:151], v217 offset:15616
v_mfma_f32_16x16x32_bf16 v[140:143], a[192:195], a[44:47], v[140:143]
v_mfma_f32_16x16x32_bf16 v[144:147], a[200:203], a[32:35], v[144:147]
ds_read_b64_tr_b16 a[152:153], v218 offset:1024
v_mfma_f32_16x16x32_bf16 v[144:147], a[204:207], a[48:51], v[144:147]
buffer_load_dwordx4 v232, s[12:15], s51 offen offset:3072 lds
v_mfma_f32_16x16x32_bf16 v[148:151], a[204:207], a[52:55], v[148:151]
ds_read_b64_tr_b16 a[154:155], v218 offset:1280
v_mfma_f32_16x16x32_bf16 v[148:151], a[200:203], a[36:39], v[148:151]
ds_read_b64_tr_b16 a[156:157], v218 offset:15360
v_mfma_f32_16x16x32_bf16 v[152:155], a[200:203], a[40:43], v[152:155]
ds_read_b64_tr_b16 a[158:159], v218 offset:15616
v_mfma_f32_16x16x32_bf16 v[152:155], a[204:207], a[56:59], v[152:155]
ds_read_b64_tr_b16 a[160:161], v217 offset:2048
v_mfma_f32_16x16x32_bf16 v[156:159], a[204:207], a[60:63], v[156:159]
v_mfma_f32_16x16x32_bf16 v[156:159], a[200:203], a[44:47], v[156:159]
buffer_load_dwordx4 a[12:15], v233, s[16:19], s53 offen offset:2048 sc1
v_mfma_f32_16x16x32_bf16 v[160:163], a[208:211], a[32:35], v[160:163]
ds_read_b64_tr_b16 a[162:163], v217 offset:2304
ds_read_b64_tr_b16 a[164:165], v217 offset:16384
v_mfma_f32_16x16x32_bf16 v[160:163], a[212:215], a[48:51], v[160:163]
ds_read_b64_tr_b16 a[166:167], v217 offset:16640
v_mfma_f32_16x16x32_bf16 v[164:167], a[212:215], a[52:55], v[164:167]
v_mfma_f32_16x16x32_bf16 v[164:167], a[208:211], a[36:39], v[164:167]
ds_read_b64_tr_b16 a[168:169], v218 offset:2048
v_mfma_f32_16x16x32_bf16 v[168:171], a[208:211], a[40:43], v[168:171]
buffer_load_dwordx4 a[28:31], v233, s[16:19], s53 offen offset:3072 sc1
v_mfma_f32_16x16x32_bf16 v[168:171], a[212:215], a[56:59], v[168:171]
s_cmp_eq_u32 s48, 2
s_cselect_b32 s44, s46, 67108864
ds_read_b64_tr_b16 a[170:171], v218 offset:2304
ds_read_b64_tr_b16 a[172:173], v218 offset:16384
v_mfma_f32_16x16x32_bf16 v[172:175], a[212:215], a[60:63], v[172:175]
v_mfma_f32_16x16x32_bf16 v[172:175], a[208:211], a[44:47], v[172:175]
ds_read_b64_tr_b16 a[174:175], v218 offset:16640
v_mfma_f32_16x16x32_bf16 v[176:179], a[216:219], a[32:35], v[176:179]
ds_read_b64_tr_b16 a[176:177], v219 offset:0
v_mfma_f32_16x16x32_bf16 v[176:179], a[220:223], a[48:51], v[176:179]
ds_read_b64_tr_b16 a[178:179], v219 offset:1024
v_mfma_f32_16x16x32_bf16 v[180:183], a[220:223], a[52:55], v[180:183]
s_mov_b32 exec_hi, 0xffffff
buffer_load_dword v246, v255, s[20:23], s44 offen
s_mov_b64 exec, -1
v_mfma_f32_16x16x32_bf16 v[180:183], a[216:219], a[36:39], v[180:183]
s_cmp_eq_u32 s48, 2
s_cselect_b32 s44, s47, 67108864
ds_read_b64_tr_b16 a[180:181], v219 offset:14336
v_mfma_f32_16x16x32_bf16 v[184:187], a[216:219], a[40:43], v[184:187]
ds_read_b64_tr_b16 a[182:183], v219 offset:15360
v_mfma_f32_16x16x32_bf16 v[184:187], a[220:223], a[56:59], v[184:187]
v_mfma_f32_16x16x32_bf16 v[188:191], a[220:223], a[60:63], v[188:191]
v_mfma_f32_16x16x32_bf16 v[188:191], a[216:219], a[44:47], v[188:191]
v_mfma_f32_16x16x32_bf16 v[192:195], a[224:227], a[32:35], v[192:195]
s_mov_b64 exec, 0xffff
buffer_load_dword v246, v255, s[24:27], s44 offen
s_mov_b64 exec, -1
v_mfma_f32_16x16x32_bf16 v[192:195], a[228:231], a[48:51], v[192:195]
v_mfma_f32_16x16x32_bf16 v[196:199], a[228:231], a[52:55], v[196:199]
v_mfma_f32_16x16x32_bf16 v[196:199], a[224:227], a[36:39], v[196:199]
v_mfma_f32_16x16x32_bf16 v[200:203], a[224:227], a[40:43], v[200:203]
v_mfma_f32_16x16x32_bf16 v[200:203], a[228:231], a[56:59], v[200:203]
v_mfma_f32_16x16x32_bf16 v[204:207], a[228:231], a[60:63], v[204:207]
v_mfma_f32_16x16x32_bf16 v[204:207], a[224:227], a[44:47], v[204:207]
s_waitcnt vmcnt(36) lgkmcnt(0)
v_mfma_f32_16x16x32_bf16 v[0:3], a[128:131], a[64:67], v[0:3]
s_add_u32 m0, s56, 28672
ds_read_b64_tr_b16 a[184:185], v220 offset:0
v_mfma_f32_16x16x32_bf16 v[0:3], a[132:135], a[80:83], v[0:3]
s_bfe_u32 s55, s59, 0x40014
ds_read_b64_tr_b16 a[186:187], v220 offset:1024
v_mfma_f32_16x16x32_bf16 v[4:7], a[132:135], a[84:87], v[4:7]
s_mul_i32 s50, s55, 393216
v_mfma_f32_16x16x32_bf16 v[4:7], a[128:131], a[68:71], v[4:7]
s_mul_i32 s51, s55, 458752
buffer_load_dwordx4 v226, s[8:11], s50 offen offset:0 lds
v_mfma_f32_16x16x32_bf16 v[8:11], a[128:131], a[72:75], v[8:11]
s_bfe_u32 s52, s59, 0x40014
ds_read_b64_tr_b16 a[188:189], v220 offset:14336
v_mfma_f32_16x16x32_bf16 v[8:11], a[132:135], a[88:91], v[8:11]
s_lshl_b32 s52, s52, 13
ds_read_b64_tr_b16 a[190:191], v220 offset:15360
v_mfma_f32_16x16x32_bf16 v[12:15], a[132:135], a[92:95], v[12:15]
s_add_u32 s52, s52, s54
v_mfma_f32_16x16x32_bf16 v[12:15], a[128:131], a[76:79], v[12:15]
s_add_u32 s53, s52, 4096
buffer_load_dwordx4 a[32:35], v233, s[16:19], s52 offen offset:0 sc1
v_mfma_f32_16x16x32_bf16 v[16:19], a[136:139], a[64:67], v[16:19]
s_add_u32 m0, s56, 31744
ds_read_b64_tr_b16 a[192:193], v221 offset:0
v_mfma_f32_16x16x32_bf16 v[16:19], a[140:143], a[80:83], v[16:19]
Lpad4:
s_cbranch_execz Lpad8
ds_read_b64_tr_b16 a[194:195], v221 offset:1024
v_mfma_f32_16x16x32_bf16 v[20:23], a[140:143], a[84:87], v[20:23]
v_mfma_f32_16x16x32_bf16 v[20:23], a[136:139], a[68:71], v[20:23]
ds_read_b64_tr_b16 a[196:197], v221 offset:14336
v_mfma_f32_16x16x32_bf16 v[24:27], a[136:139], a[72:75], v[24:27]
buffer_load_dwordx4 v229, s[12:15], s51 offen offset:0 lds
v_mfma_f32_16x16x32_bf16 v[24:27], a[140:143], a[88:91], v[24:27]
ds_read_b64_tr_b16 a[198:199], v221 offset:15360
v_mfma_f32_16x16x32_bf16 v[28:31], a[140:143], a[92:95], v[28:31]
v_mfma_f32_16x16x32_bf16 v[28:31], a[136:139], a[76:79], v[28:31]
ds_read_b64_tr_b16 a[200:201], v222 offset:0
v_mfma_f32_16x16x32_bf16 v[32:35], a[144:147], a[64:67], v[32:35]
v_mfma_f32_16x16x32_bf16 v[32:35], a[148:151], a[80:83], v[32:35]
ds_read_b64_tr_b16 a[202:203], v222 offset:1024
v_mfma_f32_16x16x32_bf16 v[36:39], a[148:151], a[84:87], v[36:39]
buffer_load_dwordx4 a[48:51], v233, s[16:19], s52 offen offset:1024 sc1
v_mfma_f32_16x16x32_bf16 v[36:39], a[144:147], a[68:71], v[36:39]
ds_read_b64_tr_b16 a[204:205], v222 offset:14336
v_mfma_f32_16x16x32_bf16 v[40:43], a[144:147], a[72:75], v[40:43]
v_mfma_f32_16x16x32_bf16 v[40:43], a[148:151], a[88:91], v[40:43]
ds_read_b64_tr_b16 a[206:207], v222 offset:15360
v_mfma_f32_16x16x32_bf16 v[44:47], a[148:151], a[92:95], v[44:47]
v_mfma_f32_16x16x32_bf16 v[44:47], a[144:147], a[76:79], v[44:47]
ds_read_b64_tr_b16 a[208:209], v223 offset:0
v_mfma_f32_16x16x32_bf16 v[48:51], a[152:155], a[64:67], v[48:51]
buffer_load_dwordx4 v230, s[12:15], s51 offen offset:1024 lds
v_mfma_f32_16x16x32_bf16 v[48:51], a[156:159], a[80:83], v[48:51]
ds_read_b64_tr_b16 a[210:211], v223 offset:1024
v_mfma_f32_16x16x32_bf16 v[52:55], a[156:159], a[84:87], v[52:55]
ds_read_b64_tr_b16 a[212:213], v223 offset:14336
v_mfma_f32_16x16x32_bf16 v[52:55], a[152:155], a[68:71], v[52:55]
v_mfma_f32_16x16x32_bf16 v[56:59], a[152:155], a[72:75], v[56:59]
ds_read_b64_tr_b16 a[214:215], v223 offset:15360
v_mfma_f32_16x16x32_bf16 v[56:59], a[156:159], a[88:91], v[56:59]
v_mfma_f32_16x16x32_bf16 v[60:63], a[156:159], a[92:95], v[60:63]
buffer_load_dwordx4 a[36:39], v233, s[16:19], s52 offen offset:2048 sc1
v_mfma_f32_16x16x32_bf16 v[60:63], a[152:155], a[76:79], v[60:63]
s_add_u32 m0, s56, 28672
ds_read_b64_tr_b16 a[216:217], v224 offset:0
v_mfma_f32_16x16x32_bf16 v[64:67], a[64:67], a[160:163], v[64:67]
ds_read_b64_tr_b16 a[218:219], v224 offset:1024
v_mfma_f32_16x16x32_bf16 v[64:67], a[80:83], a[164:167], v[64:67]
v_mfma_f32_16x16x32_bf16 v[68:71], a[84:87], a[164:167], v[68:71]
ds_read_b64_tr_b16 a[220:221], v224 offset:14336
v_mfma_f32_16x16x32_bf16 v[68:71], a[68:71], a[160:163], v[68:71]
v_mfma_f32_16x16x32_bf16 v[72:75], a[72:75], a[160:163], v[72:75]
buffer_load_dwordx4 v227, s[8:11], s50 offen offset:1024 lds
v_mfma_f32_16x16x32_bf16 v[72:75], a[88:91], a[164:167], v[72:75]
ds_read_b64_tr_b16 a[222:223], v224 offset:15360
v_mfma_f32_16x16x32_bf16 v[76:79], a[92:95], a[164:167], v[76:79]
ds_read_b64_tr_b16 a[224:225], v225 offset:0
v_mfma_f32_16x16x32_bf16 v[76:79], a[76:79], a[160:163], v[76:79]
v_mfma_f32_16x16x32_bf16 v[80:83], a[64:67], a[168:171], v[80:83]
ds_read_b64_tr_b16 a[226:227], v225 offset:1024
v_mfma_f32_16x16x32_bf16 v[80:83], a[80:83], a[172:175], v[80:83]
v_mfma_f32_16x16x32_bf16 v[84:87], a[84:87], a[172:175], v[84:87]
buffer_load_dwordx4 a[52:55], v233, s[16:19], s52 offen offset:3072 sc1
v_mfma_f32_16x16x32_bf16 v[84:87], a[68:71], a[168:171], v[84:87]
s_add_u32 m0, s56, 31744
ds_read_b64_tr_b16 a[228:229], v225 offset:14336
v_mfma_f32_16x16x32_bf16 v[88:91], a[72:75], a[168:171], v[88:91]
ds_read_b64_tr_b16 a[230:231], v225 offset:15360
v_mfma_f32_16x16x32_bf16 v[88:91], a[88:91], a[172:175], v[88:91]
v_mfma_f32_16x16x32_bf16 v[92:95], a[92:95], a[172:175], v[92:95]
v_mfma_f32_16x16x32_bf16 v[92:95], a[76:79], a[168:171], v[92:95]
v_mfma_f32_16x16x32_bf16 v[96:99], a[176:179], a[64:67], v[96:99]
buffer_load_dwordx4 v231, s[12:15], s51 offen offset:2048 lds
v_mfma_f32_16x16x32_bf16 v[96:99], a[180:183], a[80:83], v[96:99]
v_mfma_f32_16x16x32_bf16 v[100:103], a[180:183], a[84:87], v[100:103]
v_mfma_f32_16x16x32_bf16 v[100:103], a[176:179], a[68:71], v[100:103]
v_mfma_f32_16x16x32_bf16 v[104:107], a[176:179], a[72:75], v[104:107]
v_mfma_f32_16x16x32_bf16 v[104:107], a[180:183], a[88:91], v[104:107]
v_mfma_f32_16x16x32_bf16 v[108:111], a[180:183], a[92:95], v[108:111]
v_mfma_f32_16x16x32_bf16 v[108:111], a[176:179], a[76:79], v[108:111]
s_waitcnt vmcnt(30) lgkmcnt(0)
s_barrier
v_mfma_f32_16x16x32_bf16 v[112:115], a[184:187], a[64:67], v[112:115]
buffer_load_dwordx4 a[40:43], v233, s[16:19], s53 offen offset:0 sc1
v_mfma_f32_16x16x32_bf16 v[112:115], a[188:191], a[80:83], v[112:115]
s_add_u32 m0, s56, 28672
ds_read_b64_tr_b16 a[128:129], v217 offset:28672
ds_read_b64_tr_b16 a[130:131], v217 offset:28928
v_mfma_f32_16x16x32_bf16 v[116:119], a[188:191], a[84:87], v[116:119]
ds_read_b64_tr_b16 a[132:133], v217 offset:43008
v_mfma_f32_16x16x32_bf16 v[116:119], a[184:187], a[68:71], v[116:119]
v_mfma_f32_16x16x32_bf16 v[120:123], a[184:187], a[72:75], v[120:123]
ds_read_b64_tr_b16 a[134:135], v217 offset:43264
v_mfma_f32_16x16x32_bf16 v[120:123], a[188:191], a[88:91], v[120:123]
buffer_load_dwordx4 v228, s[8:11], s50 offen offset:2048 lds
v_mfma_f32_16x16x32_bf16 v[124:127], a[188:191], a[92:95], v[124:127]
ds_read_b64_tr_b16 a[136:137], v218 offset:28672
ds_read_b64_tr_b16 a[138:139], v218 offset:28928
v_mfma_f32_16x16x32_bf16 v[124:127], a[184:187], a[76:79], v[124:127]
v_mfma_f32_16x16x32_bf16 v[128:131], a[192:195], a[64:67], v[128:131]
ds_read_b64_tr_b16 a[140:141], v218 offset:43008
v_mfma_f32_16x16x32_bf16 v[128:131], a[196:199], a[80:83], v[128:131]
ds_read_b64_tr_b16 a[142:143], v218 offset:43264
v_mfma_f32_16x16x32_bf16 v[132:135], a[196:199], a[84:87], v[132:135]
ds_read_b64_tr_b16 a[144:145], v217 offset:29696
v_mfma_f32_16x16x32_bf16 v[132:135], a[192:195], a[68:71], v[132:135]
buffer_load_dwordx4 a[56:59], v233, s[16:19], s53 offen offset:1024 sc1
v_mfma_f32_16x16x32_bf16 v[136:139], a[192:195], a[72:75], v[136:139]
s_add_u32 m0, s56, 31744
ds_read_b64_tr_b16 a[146:147], v217 offset:29952
v_mfma_f32_16x16x32_bf16 v[136:139], a[196:199], a[88:91], v[136:139]
ds_read_b64_tr_b16 a[148:149], v217 offset:44032
v_mfma_f32_16x16x32_bf16 v[140:143], a[196:199], a[92:95], v[140:143]
ds_read_b64_tr_b16 a[150:151], v217 offset:44288
v_mfma_f32_16x16x32_bf16 v[140:143], a[192:195], a[76:79], v[140:143]
v_mfma_f32_16x16x32_bf16 v[144:147], a[200:203], a[64:67], v[144:147]
ds_read_b64_tr_b16 a[152:153], v218 offset:29696
v_mfma_f32_16x16x32_bf16 v[144:147], a[204:207], a[80:83], v[144:147]
buffer_load_dwordx4 v232, s[12:15], s51 offen offset:3072 lds
v_mfma_f32_16x16x32_bf16 v[148:151], a[204:207], a[84:87], v[148:151]
ds_read_b64_tr_b16 a[154:155], v218 offset:29952
v_mfma_f32_16x16x32_bf16 v[148:151], a[200:203], a[68:71], v[148:151]
ds_read_b64_tr_b16 a[156:157], v218 offset:44032
v_mfma_f32_16x16x32_bf16 v[152:155], a[200:203], a[72:75], v[152:155]
ds_read_b64_tr_b16 a[158:159], v218 offset:44288
v_mfma_f32_16x16x32_bf16 v[152:155], a[204:207], a[88:91], v[152:155]
ds_read_b64_tr_b16 a[160:161], v217 offset:30720
v_mfma_f32_16x16x32_bf16 v[156:159], a[204:207], a[92:95], v[156:159]
v_mfma_f32_16x16x32_bf16 v[156:159], a[200:203], a[76:79], v[156:159]
buffer_load_dwordx4 a[44:47], v233, s[16:19], s53 offen offset:2048 sc1
v_mfma_f32_16x16x32_bf16 v[160:163], a[208:211], a[64:67], v[160:163]
ds_read_b64_tr_b16 a[162:163], v217 offset:30976
ds_read_b64_tr_b16 a[164:165], v217 offset:45056
v_mfma_f32_16x16x32_bf16 v[160:163], a[212:215], a[80:83], v[160:163]
ds_read_b64_tr_b16 a[166:167], v217 offset:45312
v_mfma_f32_16x16x32_bf16 v[164:167], a[212:215], a[84:87], v[164:167]
v_mfma_f32_16x16x32_bf16 v[164:167], a[208:211], a[68:71], v[164:167]
ds_read_b64_tr_b16 a[168:169], v218 offset:30720
v_mfma_f32_16x16x32_bf16 v[168:171], a[208:211], a[72:75], v[168:171]
buffer_load_dwordx4 a[60:63], v233, s[16:19], s53 offen offset:3072 sc1
v_mfma_f32_16x16x32_bf16 v[168:171], a[212:215], a[88:91], v[168:171]
s_cmp_eq_u32 s48, 3
s_cselect_b32 s44, s46, 67108864
ds_read_b64_tr_b16 a[170:171], v218 offset:30976
ds_read_b64_tr_b16 a[172:173], v218 offset:45056
v_mfma_f32_16x16x32_bf16 v[172:175], a[212:215], a[92:95], v[172:175]
v_mfma_f32_16x16x32_bf16 v[172:175], a[208:211], a[76:79], v[172:175]
ds_read_b64_tr_b16 a[174:175], v218 offset:45312
v_mfma_f32_16x16x32_bf16 v[176:179], a[216:219], a[64:67], v[176:179]
ds_read_b64_tr_b16 a[176:177], v219 offset:28672
v_mfma_f32_16x16x32_bf16 v[176:179], a[220:223], a[80:83], v[176:179]
ds_read_b64_tr_b16 a[178:179], v219 offset:29696
v_mfma_f32_16x16x32_bf16 v[180:183], a[220:223], a[84:87], v[180:183]
s_mov_b32 exec_hi, 0xffffff
buffer_load_dword v246, v255, s[20:23], s44 offen
s_mov_b64 exec, -1
v_mfma_f32_16x16x32_bf16 v[180:183], a[216:219], a[68:71], v[180:183]
s_cmp_eq_u32 s48, 3
s_cselect_b32 s44, s47, 67108864
ds_read_b64_tr_b16 a[180:181], v219 offset:43008
v_mfma_f32_16x16x32_bf16 v[184:187], a[216:219], a[72:75], v[184:187]
ds_read_b64_tr_b16 a[182:183], v219 offset:44032
v_mfma_f32_16x16x32_bf16 v[184:187], a[220:223], a[88:91], v[184:187]
v_mfma_f32_16x16x32_bf16 v[188:191], a[220:223], a[92:95], v[188:191]
v_mfma_f32_16x16x32_bf16 v[188:191], a[216:219], a[76:79], v[188:191]
v_mfma_f32_16x16x32_bf16 v[192:195], a[224:227], a[64:67], v[192:195]
s_mov_b64 exec, 0xffff
buffer_load_dword v246, v255, s[24:27], s44 offen
s_mov_b64 exec, -1
v_mfma_f32_16x16x32_bf16 v[192:195], a[228:231], a[80:83], v[192:195]
v_mfma_f32_16x16x32_bf16 v[196:199], a[228:231], a[84:87], v[196:199]
v_mfma_f32_16x16x32_bf16 v[196:199], a[224:227], a[68:71], v[196:199]
v_mfma_f32_16x16x32_bf16 v[200:203], a[224:227], a[72:75], v[200:203]
v_mfma_f32_16x16x32_bf16 v[200:203], a[228:231], a[88:91], v[200:203]
v_mfma_f32_16x16x32_bf16 v[204:207], a[228:231], a[92:95], v[204:207]
v_mfma_f32_16x16x32_bf16 v[204:207], a[224:227], a[76:79], v[204:207]
s_waitcnt vmcnt(36) lgkmcnt(0)
v_mfma_f32_16x16x32_bf16 v[0:3], a[128:131], a[96:99], v[0:3]
s_add_u32 m0, s56, 57344
ds_read_b64_tr_b16 a[184:185], v220 offset:28672
v_mfma_f32_16x16x32_bf16 v[0:3], a[132:135], a[112:115], v[0:3]
s_bfe_u32 s55, s59, 0x40018
ds_read_b64_tr_b16 a[186:187], v220 offset:29696
v_mfma_f32_16x16x32_bf16 v[4:7], a[132:135], a[116:119], v[4:7]
s_mul_i32 s50, s55, 393216
v_mfma_f32_16x16x32_bf16 v[4:7], a[128:131], a[100:103], v[4:7]
s_mul_i32 s51, s55, 458752
buffer_load_dwordx4 v226, s[8:11], s50 offen offset:0 lds
v_mfma_f32_16x16x32_bf16 v[8:11], a[128:131], a[104:107], v[8:11]
s_bfe_u32 s52, s59, 0x40018
ds_read_b64_tr_b16 a[188:189], v220 offset:43008
v_mfma_f32_16x16x32_bf16 v[8:11], a[132:135], a[120:123], v[8:11]
s_lshl_b32 s52, s52, 13
ds_read_b64_tr_b16 a[190:191], v220 offset:44032
v_mfma_f32_16x16x32_bf16 v[12:15], a[132:135], a[124:127], v[12:15]
s_add_u32 s52, s52, s54
v_mfma_f32_16x16x32_bf16 v[12:15], a[128:131], a[108:111], v[12:15]
s_add_u32 s53, s52, 4096
buffer_load_dwordx4 a[64:67], v233, s[16:19], s52 offen offset:0 sc1
v_mfma_f32_16x16x32_bf16 v[16:19], a[136:139], a[96:99], v[16:19]
s_add_u32 m0, s56, 60416
ds_read_b64_tr_b16 a[192:193], v221 offset:28672
v_mfma_f32_16x16x32_bf16 v[16:19], a[140:143], a[112:115], v[16:19]
ds_read_b64_tr_b16 a[194:195], v221 offset:29696
v_mfma_f32_16x16x32_bf16 v[20:23], a[140:143], a[116:119], v[20:23]
v_mfma_f32_16x16x32_bf16 v[20:23], a[136:139], a[100:103], v[20:23]
ds_read_b64_tr_b16 a[196:197], v221 offset:43008
v_mfma_f32_16x16x32_bf16 v[24:27], a[136:139], a[104:107], v[24:27]
buffer_load_dwordx4 v229, s[12:15], s51 offen offset:0 lds
v_mfma_f32_16x16x32_bf16 v[24:27], a[140:143], a[120:123], v[24:27]
ds_read_b64_tr_b16 a[198:199], v221 offset:44032
v_mfma_f32_16x16x32_bf16 v[28:31], a[140:143], a[124:127], v[28:31]
v_mfma_f32_16x16x32_bf16 v[28:31], a[136:139], a[108:111], v[28:31]
ds_read_b64_tr_b16 a[200:201], v222 offset:28672
v_mfma_f32_16x16x32_bf16 v[32:35], a[144:147], a[96:99], v[32:35]
v_mfma_f32_16x16x32_bf16 v[32:35], a[148:151], a[112:115], v[32:35]
ds_read_b64_tr_b16 a[202:203], v222 offset:29696
v_mfma_f32_16x16x32_bf16 v[36:39], a[148:151], a[116:119], v[36:39]
buffer_load_dwordx4 a[80:83], v233, s[16:19], s52 offen offset:1024 sc1
v_mfma_f32_16x16x32_bf16 v[36:39], a[144:147], a[100:103], v[36:39]
ds_read_b64_tr_b16 a[204:205], v222 offset:43008
v_mfma_f32_16x16x32_bf16 v[40:43], a[144:147], a[104:107], v[40:43]
v_mfma_f32_16x16x32_bf16 v[40:43], a[148:151], a[120:123], v[40:43]
ds_read_b64_tr_b16 a[206:207], v222 offset:44032
v_mfma_f32_16x16x32_bf16 v[44:47], a[148:151], a[124:127], v[44:47]
v_mfma_f32_16x16x32_bf16 v[44:47], a[144:147], a[108:111], v[44:47]
ds_read_b64_tr_b16 a[208:209], v223 offset:28672
v_mfma_f32_16x16x32_bf16 v[48:51], a[152:155], a[96:99], v[48:51]
buffer_load_dwordx4 v230, s[12:15], s51 offen offset:1024 lds
v_mfma_f32_16x16x32_bf16 v[48:51], a[156:159], a[112:115], v[48:51]
ds_read_b64_tr_b16 a[210:211], v223 offset:29696
v_mfma_f32_16x16x32_bf16 v[52:55], a[156:159], a[116:119], v[52:55]
ds_read_b64_tr_b16 a[212:213], v223 offset:43008
v_mfma_f32_16x16x32_bf16 v[52:55], a[152:155], a[100:103], v[52:55]
v_mfma_f32_16x16x32_bf16 v[56:59], a[152:155], a[104:107], v[56:59]
ds_read_b64_tr_b16 a[214:215], v223 offset:44032
v_mfma_f32_16x16x32_bf16 v[56:59], a[156:159], a[120:123], v[56:59]
v_mfma_f32_16x16x32_bf16 v[60:63], a[156:159], a[124:127], v[60:63]
buffer_load_dwordx4 a[68:71], v233, s[16:19], s52 offen offset:2048 sc1
v_mfma_f32_16x16x32_bf16 v[60:63], a[152:155], a[108:111], v[60:63]
s_add_u32 m0, s56, 57344
ds_read_b64_tr_b16 a[216:217], v224 offset:28672
v_mfma_f32_16x16x32_bf16 v[64:67], a[96:99], a[160:163], v[64:67]
ds_read_b64_tr_b16 a[218:219], v224 offset:29696
v_mfma_f32_16x16x32_bf16 v[64:67], a[112:115], a[164:167], v[64:67]
v_mfma_f32_16x16x32_bf16 v[68:71], a[116:119], a[164:167], v[68:71]
ds_read_b64_tr_b16 a[220:221], v224 offset:43008
v_mfma_f32_16x16x32_bf16 v[68:71], a[100:103], a[160:163], v[68:71]
v_mfma_f32_16x16x32_bf16 v[72:75], a[104:107], a[160:163], v[72:75]
buffer_load_dwordx4 v227, s[8:11], s50 offen offset:1024 lds
v_mfma_f32_16x16x32_bf16 v[72:75], a[120:123], a[164:167], v[72:75]
ds_read_b64_tr_b16 a[222:223], v224 offset:44032
v_mfma_f32_16x16x32_bf16 v[76:79], a[124:127], a[164:167], v[76:79]
ds_read_b64_tr_b16 a[224:225], v225 offset:28672
v_mfma_f32_16x16x32_bf16 v[76:79], a[108:111], a[160:163], v[76:79]
v_mfma_f32_16x16x32_bf16 v[80:83], a[96:99], a[168:171], v[80:83]
ds_read_b64_tr_b16 a[226:227], v225 offset:29696
v_mfma_f32_16x16x32_bf16 v[80:83], a[112:115], a[172:175], v[80:83]
v_mfma_f32_16x16x32_bf16 v[84:87], a[116:119], a[172:175], v[84:87]
buffer_load_dwordx4 a[84:87], v233, s[16:19], s52 offen offset:3072 sc1
v_mfma_f32_16x16x32_bf16 v[84:87], a[100:103], a[168:171], v[84:87]
s_add_u32 m0, s56, 60416
ds_read_b64_tr_b16 a[228:229], v225 offset:43008
v_mfma_f32_16x16x32_bf16 v[88:91], a[104:107], a[168:171], v[88:91]
ds_read_b64_tr_b16 a[230:231], v225 offset:44032
v_mfma_f32_16x16x32_bf16 v[88:91], a[120:123], a[172:175], v[88:91]
v_mfma_f32_16x16x32_bf16 v[92:95], a[124:127], a[172:175], v[92:95]
v_mfma_f32_16x16x32_bf16 v[92:95], a[108:111], a[168:171], v[92:95]
v_mfma_f32_16x16x32_bf16 v[96:99], a[176:179], a[96:99], v[96:99]
buffer_load_dwordx4 v231, s[12:15], s51 offen offset:2048 lds
v_mfma_f32_16x16x32_bf16 v[96:99], a[180:183], a[112:115], v[96:99]
v_mfma_f32_16x16x32_bf16 v[100:103], a[180:183], a[116:119], v[100:103]
v_mfma_f32_16x16x32_bf16 v[100:103], a[176:179], a[100:103], v[100:103]
v_mfma_f32_16x16x32_bf16 v[104:107], a[176:179], a[104:107], v[104:107]
v_mfma_f32_16x16x32_bf16 v[104:107], a[180:183], a[120:123], v[104:107]
v_mfma_f32_16x16x32_bf16 v[108:111], a[180:183], a[124:127], v[108:111]
v_mfma_f32_16x16x32_bf16 v[108:111], a[176:179], a[108:111], v[108:111]
s_waitcnt vmcnt(30) lgkmcnt(0)
s_barrier
v_mfma_f32_16x16x32_bf16 v[112:115], a[184:187], a[96:99], v[112:115]
buffer_load_dwordx4 a[72:75], v233, s[16:19], s53 offen offset:0 sc1
v_mfma_f32_16x16x32_bf16 v[112:115], a[188:191], a[112:115], v[112:115]
s_add_u32 m0, s56, 57344
ds_read_b64_tr_b16 a[128:129], v208 offset:0
ds_read_b64_tr_b16 a[130:131], v208 offset:256
v_mfma_f32_16x16x32_bf16 v[116:119], a[188:191], a[116:119], v[116:119]
ds_read_b64_tr_b16 a[132:133], v208 offset:14336
v_mfma_f32_16x16x32_bf16 v[116:119], a[184:187], a[100:103], v[116:119]
v_mfma_f32_16x16x32_bf16 v[120:123], a[184:187], a[104:107], v[120:123]
ds_read_b64_tr_b16 a[134:135], v208 offset:14592
v_mfma_f32_16x16x32_bf16 v[120:123], a[188:191], a[120:123], v[120:123]
buffer_load_dwordx4 v228, s[8:11], s50 offen offset:2048 lds
v_mfma_f32_16x16x32_bf16 v[124:127], a[188:191], a[124:127], v[124:127]
ds_read_b64_tr_b16 a[136:137], v209 offset:0
ds_read_b64_tr_b16 a[138:139], v209 offset:256
v_mfma_f32_16x16x32_bf16 v[124:127], a[184:187], a[108:111], v[124:127]
v_mfma_f32_16x16x32_bf16 v[128:131], a[192:195], a[96:99], v[128:131]
ds_read_b64_tr_b16 a[140:141], v209 offset:14336
v_mfma_f32_16x16x32_bf16 v[128:131], a[196:199], a[112:115], v[128:131]
ds_read_b64_tr_b16 a[142:143], v209 offset:14592
v_mfma_f32_16x16x32_bf16 v[132:135], a[196:199], a[116:119], v[132:135]
buffer_load_dwordx4 a[88:91], v233, s[16:19], s53 offen offset:1024 sc1
v_mfma_f32_16x16x32_bf16 v[132:135], a[192:195], a[100:103], v[132:135]
s_add_u32 m0, s56, 60416
ds_read_b64_tr_b16 a[144:145], v208 offset:1024
v_mfma_f32_16x16x32_bf16 v[136:139], a[192:195], a[104:107], v[136:139]
ds_read_b64_tr_b16 a[146:147], v208 offset:1280
v_mfma_f32_16x16x32_bf16 v[136:139], a[196:199], a[120:123], v[136:139]
ds_read_b64_tr_b16 a[148:149], v208 offset:15360
v_mfma_f32_16x16x32_bf16 v[140:143], a[196:199], a[124:127], v[140:143]
ds_read_b64_tr_b16 a[150:151], v208 offset:15616
v_mfma_f32_16x16x32_bf16 v[140:143], a[192:195], a[108:111], v[140:143]
buffer_load_dwordx4 v232, s[12:15], s51 offen offset:3072 lds
v_mfma_f32_16x16x32_bf16 v[144:147], a[200:203], a[96:99], v[144:147]
ds_read_b64_tr_b16 a[152:153], v209 offset:1024
v_mfma_f32_16x16x32_bf16 v[144:147], a[204:207], a[112:115], v[144:147]
ds_read_b64_tr_b16 a[154:155], v209 offset:1280
v_mfma_f32_16x16x32_bf16 v[148:151], a[204:207], a[116:119], v[148:151]
v_mfma_f32_16x16x32_bf16 v[148:151], a[200:203], a[100:103], v[148:151]
ds_read_b64_tr_b16 a[156:157], v209 offset:15360
v_mfma_f32_16x16x32_bf16 v[152:155], a[200:203], a[104:107], v[152:155]
buffer_load_dwordx4 a[76:79], v233, s[16:19], s53 offen offset:2048 sc1
v_mfma_f32_16x16x32_bf16 v[152:155], a[204:207], a[120:123], v[152:155]
ds_read_b64_tr_b16 a[158:159], v209 offset:15616
ds_read_b64_tr_b16 a[160:161], v208 offset:2048
v_mfma_f32_16x16x32_bf16 v[156:159], a[204:207], a[124:127], v[156:159]
v_mfma_f32_16x16x32_bf16 v[156:159], a[200:203], a[108:111], v[156:159]
ds_read_b64_tr_b16 a[162:163], v208 offset:2304
v_mfma_f32_16x16x32_bf16 v[160:163], a[208:211], a[96:99], v[160:163]
ds_read_b64_tr_b16 a[164:165], v208 offset:16384
v_mfma_f32_16x16x32_bf16 v[160:163], a[212:215], a[112:115], v[160:163]
buffer_load_dwordx4 a[92:95], v233, s[16:19], s53 offen offset:3072 sc1
v_mfma_f32_16x16x32_bf16 v[164:167], a[212:215], a[116:119], v[164:167]
s_add_u32 m0, s56, 86016
ds_read_b64_tr_b16 a[166:167], v208 offset:16640
v_mfma_f32_16x16x32_bf16 v[164:167], a[208:211], a[100:103], v[164:167]
s_bfe_u32 s55, s59, 0x4001c
ds_read_b64_tr_b16 a[168:169], v209 offset:2048
v_mfma_f32_16x16x32_bf16 v[168:171], a[208:211], a[104:107], v[168:171]
s_mul_i32 s50, s55, 393216
ds_read_b64_tr_b16 a[170:171], v209 offset:2304
v_mfma_f32_16x16x32_bf16 v[168:171], a[212:215], a[120:123], v[168:171]
s_mul_i32 s51, s55, 458752
ds_read_b64_tr_b16 a[172:173], v209 offset:16384
v_mfma_f32_16x16x32_bf16 v[172:175], a[212:215], a[124:127], v[172:175]
buffer_load_dwordx4 v226, s[8:11], s50 offen offset:0 lds
v_mfma_f32_16x16x32_bf16 v[172:175], a[208:211], a[108:111], v[172:175]
s_add_u32 m0, s56, 89088
ds_read_b64_tr_b16 a[174:175], v209 offset:16640
v_mfma_f32_16x16x32_bf16 v[176:179], a[216:219], a[96:99], v[176:179]
ds_read_b64_tr_b16 a[176:177], v210 offset:0
v_mfma_f32_16x16x32_bf16 v[176:179], a[220:223], a[112:115], v[176:179]
ds_read_b64_tr_b16 a[178:179], v210 offset:1024
v_mfma_f32_16x16x32_bf16 v[180:183], a[220:223], a[116:119], v[180:183]
v_mfma_f32_16x16x32_bf16 v[180:183], a[216:219], a[100:103], v[180:183]
buffer_load_dwordx4 v229, s[12:15], s51 offen offset:0 lds
v_mfma_f32_16x16x32_bf16 v[184:187], a[216:219], a[104:107], v[184:187]
ds_read_b64_tr_b16 a[180:181], v210 offset:14336
ds_read_b64_tr_b16 a[182:183], v210 offset:15360
v_mfma_f32_16x16x32_bf16 v[184:187], a[220:223], a[120:123], v[184:187]
v_mfma_f32_16x16x32_bf16 v[188:191], a[220:223], a[124:127], v[188:191]
v_mfma_f32_16x16x32_bf16 v[188:191], a[216:219], a[108:111], v[188:191]
v_mfma_f32_16x16x32_bf16 v[192:195], a[224:227], a[96:99], v[192:195]
buffer_load_dwordx4 v230, s[12:15], s51 offen offset:1024 lds
v_mfma_f32_16x16x32_bf16 v[192:195], a[228:231], a[112:115], v[192:195]
v_mfma_f32_16x16x32_bf16 v[196:199], a[228:231], a[116:119], v[196:199]
v_mfma_f32_16x16x32_bf16 v[196:199], a[224:227], a[100:103], v[196:199]
v_mfma_f32_16x16x32_bf16 v[200:203], a[224:227], a[104:107], v[200:203]
v_mfma_f32_16x16x32_bf16 v[200:203], a[228:231], a[120:123], v[200:203]
v_mfma_f32_16x16x32_bf16 v[204:207], a[228:231], a[124:127], v[204:207]
v_mfma_f32_16x16x32_bf16 v[204:207], a[224:227], a[108:111], v[204:207]
s_waitcnt vmcnt(37) lgkmcnt(0)
v_mfma_f32_16x16x32_bf16 v[0:3], a[128:131], a[0:3], v[0:3]
s_add_u32 m0, s56, 86016
s_nop 0
buffer_load_dwordx4 v227, s[8:11], s50 offen offset:1024 lds
v_mfma_f32_16x16x32_bf16 v[0:3], a[132:135], a[16:19], v[0:3]
s_add_u32 m0, s56, 89088
ds_read_b64_tr_b16 a[184:185], v211 offset:0
ds_read_b64_tr_b16 a[186:187], v211 offset:1024
v_mfma_f32_16x16x32_bf16 v[4:7], a[132:135], a[20:23], v[4:7]
v_mfma_f32_16x16x32_bf16 v[4:7], a[128:131], a[4:7], v[4:7]
ds_read_b64_tr_b16 a[188:189], v211 offset:14336
v_mfma_f32_16x16x32_bf16 v[8:11], a[128:131], a[8:11], v[8:11]
v_mfma_f32_16x16x32_bf16 v[8:11], a[132:135], a[24:27], v[8:11]
ds_read_b64_tr_b16 a[190:191], v211 offset:15360
v_mfma_f32_16x16x32_bf16 v[12:15], a[132:135], a[28:31], v[12:15]
buffer_load_dwordx4 v231, s[12:15], s51 offen offset:2048 lds
v_mfma_f32_16x16x32_bf16 v[12:15], a[128:131], a[12:15], v[12:15]
s_add_u32 m0, s56, 86016
ds_read_b64_tr_b16 a[192:193], v212 offset:0
v_mfma_f32_16x16x32_bf16 v[16:19], a[136:139], a[0:3], v[16:19]
v_mfma_f32_16x16x32_bf16 v[16:19], a[140:143], a[16:19], v[16:19]
ds_read_b64_tr_b16 a[194:195], v212 offset:1024
v_mfma_f32_16x16x32_bf16 v[20:23], a[140:143], a[20:23], v[20:23]
v_mfma_f32_16x16x32_bf16 v[20:23], a[136:139], a[4:7], v[20:23]
ds_read_b64_tr_b16 a[196:197], v212 offset:14336
v_mfma_f32_16x16x32_bf16 v[24:27], a[136:139], a[8:11], v[24:27]
buffer_load_dwordx4 v228, s[8:11], s50 offen offset:2048 lds
v_mfma_f32_16x16x32_bf16 v[24:27], a[140:143], a[24:27], v[24:27]
s_add_u32 m0, s56, 89088
ds_read_b64_tr_b16 a[198:199], v212 offset:15360
v_mfma_f32_16x16x32_bf16 v[28:31], a[140:143], a[28:31], v[28:31]
v_mfma_f32_16x16x32_bf16 v[28:31], a[136:139], a[12:15], v[28:31]
ds_read_b64_tr_b16 a[200:201], v213 offset:0
v_mfma_f32_16x16x32_bf16 v[32:35], a[144:147], a[0:3], v[32:35]
v_mfma_f32_16x16x32_bf16 v[32:35], a[148:151], a[16:19], v[32:35]
ds_read_b64_tr_b16 a[202:203], v213 offset:1024
v_mfma_f32_16x16x32_bf16 v[36:39], a[148:151], a[20:23], v[36:39]
buffer_load_dwordx4 v232, s[12:15], s51 offen offset:3072 lds
v_mfma_f32_16x16x32_bf16 v[36:39], a[144:147], a[4:7], v[36:39]
s_bfe_u32 s52, s59, 0x4001c
ds_read_b64_tr_b16 a[204:205], v213 offset:14336
v_mfma_f32_16x16x32_bf16 v[40:43], a[144:147], a[8:11], v[40:43]
s_lshl_b32 s52, s52, 13
v_mfma_f32_16x16x32_bf16 v[40:43], a[148:151], a[24:27], v[40:43]
s_add_u32 s52, s52, s54
ds_read_b64_tr_b16 a[206:207], v213 offset:15360
v_mfma_f32_16x16x32_bf16 v[44:47], a[148:151], a[28:31], v[44:47]
s_add_u32 s53, s52, 4096
v_mfma_f32_16x16x32_bf16 v[44:47], a[144:147], a[12:15], v[44:47]
ds_read_b64_tr_b16 a[208:209], v214 offset:0
v_mfma_f32_16x16x32_bf16 v[48:51], a[152:155], a[0:3], v[48:51]
buffer_load_dwordx4 a[96:99], v233, s[16:19], s52 offen offset:0 sc1
v_mfma_f32_16x16x32_bf16 v[48:51], a[156:159], a[16:19], v[48:51]
ds_read_b64_tr_b16 a[210:211], v214 offset:1024
v_mfma_f32_16x16x32_bf16 v[52:55], a[156:159], a[20:23], v[52:55]
ds_read_b64_tr_b16 a[212:213], v214 offset:14336
v_mfma_f32_16x16x32_bf16 v[52:55], a[152:155], a[4:7], v[52:55]
v_mfma_f32_16x16x32_bf16 v[56:59], a[152:155], a[8:11], v[56:59]
ds_read_b64_tr_b16 a[214:215], v214 offset:15360
v_mfma_f32_16x16x32_bf16 v[56:59], a[156:159], a[24:27], v[56:59]
v_mfma_f32_16x16x32_bf16 v[60:63], a[156:159], a[28:31], v[60:63]
buffer_load_dwordx4 a[112:115], v233, s[16:19], s52 offen offset:1024 sc1
v_mfma_f32_16x16x32_bf16 v[60:63], a[152:155], a[12:15], v[60:63]
ds_read_b64_tr_b16 a[216:217], v215 offset:0
v_mfma_f32_16x16x32_bf16 v[64:67], a[0:3], a[160:163], v[64:67]
ds_read_b64_tr_b16 a[218:219], v215 offset:1024
v_mfma_f32_16x16x32_bf16 v[64:67], a[16:19], a[164:167], v[64:67]
v_mfma_f32_16x16x32_bf16 v[68:71], a[20:23], a[164:167], v[68:71]
ds_read_b64_tr_b16 a[220:221], v215 offset:14336
v_mfma_f32_16x16x32_bf16 v[68:71], a[4:7], a[160:163], v[68:71]
v_mfma_f32_16x16x32_bf16 v[72:75], a[8:11], a[160:163], v[72:75]
buffer_load_dwordx4 a[100:103], v233, s[16:19], s52 offen offset:2048 sc1
v_mfma_f32_16x16x32_bf16 v[72:75], a[24:27], a[164:167], v[72:75]
ds_read_b64_tr_b16 a[222:223], v215 offset:15360
v_mfma_f32_16x16x32_bf16 v[76:79], a[28:31], a[164:167], v[76:79]
ds_read_b64_tr_b16 a[224:225], v216 offset:0
v_mfma_f32_16x16x32_bf16 v[76:79], a[12:15], a[160:163], v[76:79]
v_mfma_f32_16x16x32_bf16 v[80:83], a[0:3], a[168:171], v[80:83]
ds_read_b64_tr_b16 a[226:227], v216 offset:1024
v_mfma_f32_16x16x32_bf16 v[80:83], a[16:19], a[172:175], v[80:83]
v_mfma_f32_16x16x32_bf16 v[84:87], a[20:23], a[172:175], v[84:87]
buffer_load_dwordx4 a[116:119], v233, s[16:19], s52 offen offset:3072 sc1
v_mfma_f32_16x16x32_bf16 v[84:87], a[4:7], a[168:171], v[84:87]
ds_read_b64_tr_b16 a[228:229], v216 offset:14336
v_mfma_f32_16x16x32_bf16 v[88:91], a[8:11], a[168:171], v[88:91]
ds_read_b64_tr_b16 a[230:231], v216 offset:15360
v_mfma_f32_16x16x32_bf16 v[88:91], a[24:27], a[172:175], v[88:91]
v_mfma_f32_16x16x32_bf16 v[92:95], a[28:31], a[172:175], v[92:95]
v_mfma_f32_16x16x32_bf16 v[92:95], a[12:15], a[168:171], v[92:95]
v_mfma_f32_16x16x32_bf16 v[96:99], a[176:179], a[0:3], v[96:99]
buffer_load_dwordx4 a[104:107], v233, s[16:19], s53 offen offset:0 sc1
v_mfma_f32_16x16x32_bf16 v[96:99], a[180:183], a[16:19], v[96:99]
v_mfma_f32_16x16x32_bf16 v[100:103], a[180:183], a[20:23], v[100:103]
v_mfma_f32_16x16x32_bf16 v[100:103], a[176:179], a[4:7], v[100:103]
v_mfma_f32_16x16x32_bf16 v[104:107], a[176:179], a[8:11], v[104:107]
v_mfma_f32_16x16x32_bf16 v[104:107], a[180:183], a[24:27], v[104:107]
v_mfma_f32_16x16x32_bf16 v[108:111], a[180:183], a[28:31], v[108:111]
v_mfma_f32_16x16x32_bf16 v[108:111], a[176:179], a[12:15], v[108:111]
s_waitcnt vmcnt(5) lgkmcnt(0)
s_barrier
v_mfma_f32_16x16x32_bf16 v[112:115], a[184:187], a[0:3], v[112:115]
buffer_load_dwordx4 a[120:123], v233, s[16:19], s53 offen offset:1024 sc1
v_mfma_f32_16x16x32_bf16 v[112:115], a[188:191], a[16:19], v[112:115]
ds_read_b64_tr_b16 a[128:129], v208 offset:29696
ds_read_b64_tr_b16 a[130:131], v208 offset:29952
v_mfma_f32_16x16x32_bf16 v[116:119], a[188:191], a[20:23], v[116:119]
ds_read_b64_tr_b16 a[132:133], v208 offset:44032
v_mfma_f32_16x16x32_bf16 v[116:119], a[184:187], a[4:7], v[116:119]
v_mfma_f32_16x16x32_bf16 v[120:123], a[184:187], a[8:11], v[120:123]
ds_read_b64_tr_b16 a[134:135], v208 offset:44288
v_mfma_f32_16x16x32_bf16 v[120:123], a[188:191], a[24:27], v[120:123]
ds_read_b64_tr_b16 a[136:137], v217 offset:1024
v_mfma_f32_16x16x32_bf16 v[124:127], a[188:191], a[28:31], v[124:127]
buffer_load_dwordx4 a[108:111], v233, s[16:19], s53 offen offset:2048 sc1
v_mfma_f32_16x16x32_bf16 v[124:127], a[184:187], a[12:15], v[124:127]
ds_read_b64_tr_b16 a[138:139], v217 offset:1280
v_mfma_f32_16x16x32_bf16 v[128:131], a[192:195], a[0:3], v[128:131]
ds_read_b64_tr_b16 a[140:141], v217 offset:15360
v_mfma_f32_16x16x32_bf16 v[128:131], a[196:199], a[16:19], v[128:131]
ds_read_b64_tr_b16 a[142:143], v217 offset:15616
v_mfma_f32_16x16x32_bf16 v[132:135], a[196:199], a[20:23], v[132:135]
ds_read_b64_tr_b16 a[144:145], v217 offset:29696
v_mfma_f32_16x16x32_bf16 v[132:135], a[192:195], a[4:7], v[132:135]
v_mfma_f32_16x16x32_bf16 v[136:139], a[192:195], a[8:11], v[136:139]
buffer_load_dwordx4 a[124:127], v233, s[16:19], s53 offen offset:3072 sc1
v_mfma_f32_16x16x32_bf16 v[136:139], a[196:199], a[24:27], v[136:139]
ds_read_b64_tr_b16 a[146:147], v217 offset:29952
ds_read_b64_tr_b16 a[148:149], v217 offset:44032
v_mfma_f32_16x16x32_bf16 v[140:143], a[196:199], a[28:31], v[140:143]
ds_read_b64_tr_b16 a[150:151], v217 offset:44288
v_mfma_f32_16x16x32_bf16 v[140:143], a[192:195], a[12:15], v[140:143]
v_mfma_f32_16x16x32_bf16 v[144:147], a[200:203], a[0:3], v[144:147]
ds_read_b64_tr_b16 a[152:153], v209 offset:29696
v_mfma_f32_16x16x32_bf16 v[144:147], a[204:207], a[16:19], v[144:147]
ds_read_b64_tr_b16 a[154:155], v209 offset:29952
v_mfma_f32_16x16x32_bf16 v[148:151], a[204:207], a[20:23], v[148:151]
v_mfma_f32_16x16x32_bf16 v[148:151], a[200:203], a[4:7], v[148:151]
ds_read_b64_tr_b16 a[156:157], v209 offset:44032
v_mfma_f32_16x16x32_bf16 v[152:155], a[200:203], a[8:11], v[152:155]
ds_read_b64_tr_b16 a[158:159], v209 offset:44288
v_mfma_f32_16x16x32_bf16 v[152:155], a[204:207], a[24:27], v[152:155]
ds_read_b64_tr_b16 a[160:161], v218 offset:1024
v_mfma_f32_16x16x32_bf16 v[156:159], a[204:207], a[28:31], v[156:159]
v_mfma_f32_16x16x32_bf16 v[156:159], a[200:203], a[12:15], v[156:159]
ds_read_b64_tr_b16 a[162:163], v218 offset:1280
v_mfma_f32_16x16x32_bf16 v[160:163], a[208:211], a[0:3], v[160:163]
ds_read_b64_tr_b16 a[164:165], v218 offset:15360
v_mfma_f32_16x16x32_bf16 v[160:163], a[212:215], a[16:19], v[160:163]
ds_read_b64_tr_b16 a[166:167], v218 offset:15616
v_mfma_f32_16x16x32_bf16 v[164:167], a[212:215], a[20:23], v[164:167]
v_mfma_f32_16x16x32_bf16 v[164:167], a[208:211], a[4:7], v[164:167]
ds_read_b64_tr_b16 a[168:169], v218 offset:29696
v_mfma_f32_16x16x32_bf16 v[168:171], a[208:211], a[8:11], v[168:171]
ds_read_b64_tr_b16 a[170:171], v218 offset:29952
Lpad5:
s_cbranch_execz Lpad9
v_mfma_f32_16x16x32_bf16 v[168:171], a[212:215], a[24:27], v[168:171]
ds_read_b64_tr_b16 a[172:173], v218 offset:44032
v_mfma_f32_16x16x32_bf16 v[172:175], a[212:215], a[28:31], v[172:175]
v_mfma_f32_16x16x32_bf16 v[172:175], a[208:211], a[12:15], v[172:175]
ds_read_b64_tr_b16 a[174:175], v218 offset:44288
v_mfma_f32_16x16x32_bf16 v[176:179], a[216:219], a[0:3], v[176:179]
ds_read_b64_tr_b16 a[176:177], v208 offset:30720
v_mfma_f32_16x16x32_bf16 v[176:179], a[220:223], a[16:19], v[176:179]
ds_read_b64_tr_b16 a[178:179], v208 offset:30976
v_mfma_f32_16x16x32_bf16 v[180:183], a[220:223], a[20:23], v[180:183]
v_mfma_f32_16x16x32_bf16 v[180:183], a[216:219], a[4:7], v[180:183]
ds_read_b64_tr_b16 a[180:181], v208 offset:45056
v_mfma_f32_16x16x32_bf16 v[184:187], a[216:219], a[8:11], v[184:187]
ds_read_b64_tr_b16 a[182:183], v208 offset:45312
v_mfma_f32_16x16x32_bf16 v[184:187], a[220:223], a[24:27], v[184:187]
v_mfma_f32_16x16x32_bf16 v[188:191], a[220:223], a[28:31], v[188:191]
v_mfma_f32_16x16x32_bf16 v[188:191], a[216:219], a[12:15], v[188:191]
v_mfma_f32_16x16x32_bf16 v[192:195], a[224:227], a[0:3], v[192:195]
v_mfma_f32_16x16x32_bf16 v[192:195], a[228:231], a[16:19], v[192:195]
v_mfma_f32_16x16x32_bf16 v[196:199], a[228:231], a[20:23], v[196:199]
v_mfma_f32_16x16x32_bf16 v[196:199], a[224:227], a[4:7], v[196:199]
v_mfma_f32_16x16x32_bf16 v[200:203], a[224:227], a[8:11], v[200:203]
v_mfma_f32_16x16x32_bf16 v[200:203], a[228:231], a[24:27], v[200:203]
v_mfma_f32_16x16x32_bf16 v[204:207], a[228:231], a[28:31], v[204:207]
v_mfma_f32_16x16x32_bf16 v[204:207], a[224:227], a[12:15], v[204:207]
s_waitcnt vmcnt(0) lgkmcnt(0)
v_mfma_f32_16x16x32_bf16 v[32:35], a[128:131], a[32:35], v[32:35]
ds_read_b64_tr_b16 a[184:185], v217 offset:2048
v_mfma_f32_16x16x32_bf16 v[32:35], a[132:135], a[48:51], v[32:35]
ds_read_b64_tr_b16 a[186:187], v217 offset:2304
v_lshlrev_b32 v255, 9, v234
s_lshl_b32 s53, s3, 15
s_add_u32 s53, s53, 48234496
s_cmp_lt_u32 s34, 48235008
s_cselect_b32 s53, s53, 67108864
s_cselect_b64 exec, -1, 1
buffer_load_dwordx2 v[246:247], v255, s[16:19], s53 offen sc1
s_mov_b64 exec, -1
v_mfma_f32_16x16x32_bf16 v[32:35], a[136:139], a[64:67], v[32:35]
v_mfma_f32_16x16x32_bf16 v[32:35], a[140:143], a[80:83], v[32:35]
ds_read_b64_tr_b16 a[188:189], v217 offset:16384
v_lshrrev_b32 v252, 2, v234
v_mfma_f32_16x16x32_bf16 v[32:35], a[144:147], a[96:99], v[32:35]
v_lshlrev_b32 v252, 11, v252
v_and_b32 v253, 1, v234
v_mfma_f32_16x16x32_bf16 v[32:35], a[148:151], a[112:115], v[32:35]
ds_read_b64_tr_b16 a[190:191], v217 offset:16640
v_lshl_add_u32 v252, v253, 7, v252
v_mfma_f32_16x16x32_bf16 v[36:39], a[148:151], a[116:119], v[36:39]
v_bfe_u32 v253, v234, 1, 1
v_lshl_add_u32 v252, v253, 10, v252
v_mfma_f32_16x16x32_bf16 v[36:39], a[144:147], a[100:103], v[36:39]
s_lshr_b32 s52, s2, 3
ds_read_b64_tr_b16 a[192:193], v217 offset:30720
s_lshl_b32 s52, s52, 2
v_mfma_f32_16x16x32_bf16 v[36:39], a[140:143], a[84:87], v[36:39]
s_add_u32 s52, s52, s3
s_mul_i32 s54, s52, 14336
s_add_u32 s54, s54, s79
v_mfma_f32_16x16x32_bf16 v[36:39], a[136:139], a[68:71], v[36:39]
ds_read_b64_tr_b16 a[194:195], v217 offset:30976
v_mul_f32 v32, s81, v32
v_mfma_f32_16x16x32_bf16 v[36:39], a[132:135], a[52:55], v[36:39]
v_mul_f32 v33, s81, v33
v_mul_f32 v34, s81, v34
v_mfma_f32_16x16x32_bf16 v[36:39], a[128:131], a[36:39], v[36:39]
ds_read_b64_tr_b16 a[196:197], v217 offset:45056
v_mul_f32 v35, s81, v35
v_mfma_f32_16x16x32_bf16 v[40:43], a[128:131], a[40:43], v[40:43]
s_mov_b64 exec, 0xfffffff
buffer_load_dword v226, v252, s[20:23], s54 offen offset:256
s_mov_b64 exec, -1
v_mfma_f32_16x16x32_bf16 v[40:43], a[132:135], a[56:59], v[40:43]
ds_read_b64_tr_b16 a[198:199], v217 offset:45312
v_mfma_f32_16x16x32_bf16 v[40:43], a[136:139], a[72:75], v[40:43]
v_mfma_f32_16x16x32_bf16 v[40:43], a[140:143], a[88:91], v[40:43]
ds_read_b64_tr_b16 a[200:201], v209 offset:30720
v_mul_f32 v36, s81, v36
v_mfma_f32_16x16x32_bf16 v[40:43], a[144:147], a[104:107], v[40:43]
v_mul_f32 v37, s81, v37
v_mul_f32 v38, s81, v38
v_mfma_f32_16x16x32_bf16 v[40:43], a[148:151], a[120:123], v[40:43]
ds_read_b64_tr_b16 a[202:203], v209 offset:30976
v_mul_f32 v39, s81, v39
v_mfma_f32_16x16x32_bf16 v[44:47], a[148:151], a[124:127], v[44:47]
v_mfma_f32_16x16x32_bf16 v[44:47], a[144:147], a[108:111], v[44:47]
ds_read_b64_tr_b16 a[204:205], v209 offset:45056
v_mfma_f32_16x16x32_bf16 v[44:47], a[140:143], a[92:95], v[44:47]
v_mfma_f32_16x16x32_bf16 v[44:47], a[136:139], a[76:79], v[44:47]
ds_read_b64_tr_b16 a[206:207], v209 offset:45312
v_mul_f32 v40, s81, v40
v_mfma_f32_16x16x32_bf16 v[44:47], a[132:135], a[60:63], v[44:47]
v_mul_f32 v41, s81, v41
v_mul_f32 v42, s81, v42
v_mfma_f32_16x16x32_bf16 v[44:47], a[128:131], a[44:47], v[44:47]
ds_read_b64_tr_b16 a[208:209], v218 offset:2048
v_mul_f32 v43, s81, v43
v_mfma_f32_16x16x32_bf16 v[48:51], a[152:155], a[32:35], v[48:51]
ds_read_b64_tr_b16 a[210:211], v218 offset:2304
v_mfma_f32_16x16x32_bf16 v[48:51], a[156:159], a[48:51], v[48:51]
v_mfma_f32_16x16x32_bf16 v[48:51], a[160:163], a[64:67], v[48:51]
ds_read_b64_tr_b16 a[212:213], v218 offset:16384
v_mfma_f32_16x16x32_bf16 v[48:51], a[164:167], a[80:83], v[48:51]
v_mul_f32 v44, s81, v44
v_mul_f32 v45, s81, v45
v_mfma_f32_16x16x32_bf16 v[48:51], a[168:171], a[96:99], v[48:51]
ds_read_b64_tr_b16 a[214:215], v218 offset:16640
v_mul_f32 v46, s81, v46
v_mfma_f32_16x16x32_bf16 v[48:51], a[172:175], a[112:115], v[48:51]
v_mul_f32 v47, s81, v47
v_mfma_f32_16x16x32_bf16 v[52:55], a[172:175], a[116:119], v[52:55]
ds_read_b64_tr_b16 a[216:217], v218 offset:30720
v_mfma_f32_16x16x32_bf16 v[52:55], a[168:171], a[100:103], v[52:55]
v_mfma_f32_16x16x32_bf16 v[52:55], a[164:167], a[84:87], v[52:55]
ds_read_b64_tr_b16 a[218:219], v218 offset:30976
v_mfma_f32_16x16x32_bf16 v[52:55], a[160:163], a[68:71], v[52:55]
s_nop 0
v_mul_f32 v48, s81, v48
v_mul_f32 v49, s81, v49
v_mfma_f32_16x16x32_bf16 v[52:55], a[156:159], a[52:55], v[52:55]
ds_read_b64_tr_b16 a[220:221], v218 offset:45056
v_mul_f32 v50, s81, v50
v_mfma_f32_16x16x32_bf16 v[52:55], a[152:155], a[36:39], v[52:55]
v_mul_f32 v51, s81, v51
v_cvt_pk_bf16_f32 v32, v32, v33
v_mfma_f32_16x16x32_bf16 v[56:59], a[152:155], a[40:43], v[56:59]
ds_read_b64_tr_b16 a[222:223], v218 offset:45312
v_cvt_pk_bf16_f32 v33, v34, v35
v_mfma_f32_16x16x32_bf16 v[56:59], a[156:159], a[56:59], v[56:59]
v_cvt_pk_bf16_f32 v34, v48, v49
v_cvt_pk_bf16_f32 v35, v50, v51
v_mfma_f32_16x16x32_bf16 v[56:59], a[160:163], a[72:75], v[56:59]
ds_read_b64_tr_b16 a[224:225], v210 offset:28672
v_mfma_f32_16x16x32_bf16 v[56:59], a[164:167], a[88:91], v[56:59]
buffer_store_dwordx4 v[32:35], v233, s[16:19], s62 offen offset:0 sc1
v_mfma_f32_16x16x32_bf16 v[56:59], a[168:171], a[104:107], v[56:59]
ds_read_b64_tr_b16 a[226:227], v210 offset:29696
v_mfma_f32_16x16x32_bf16 v[56:59], a[172:175], a[120:123], v[56:59]
ds_write_b128 v248, v[32:35] offset:0
v_mfma_f32_16x16x32_bf16 v[60:63], a[172:175], a[124:127], v[60:63]
ds_read_b64_tr_b16 a[228:229], v210 offset:43008
v_mul_f32 v52, s81, v52
v_mfma_f32_16x16x32_bf16 v[60:63], a[168:171], a[108:111], v[60:63]
v_mul_f32 v53, s81, v53
v_mul_f32 v54, s81, v54
v_mfma_f32_16x16x32_bf16 v[60:63], a[164:167], a[92:95], v[60:63]
ds_read_b64_tr_b16 a[230:231], v210 offset:44032
v_mul_f32 v55, s81, v55
v_mfma_f32_16x16x32_bf16 v[60:63], a[160:163], a[76:79], v[60:63]
v_cvt_pk_bf16_f32 v36, v36, v37
v_cvt_pk_bf16_f32 v37, v38, v39
v_mfma_f32_16x16x32_bf16 v[60:63], a[156:159], a[60:63], v[60:63]
v_cvt_pk_bf16_f32 v38, v52, v53
v_cvt_pk_bf16_f32 v39, v54, v55
v_mfma_f32_16x16x32_bf16 v[60:63], a[152:155], a[44:47], v[60:63]
buffer_store_dwordx4 v[36:39], v233, s[16:19], s62 offen offset:1024 sc1
s_waitcnt vmcnt(3)
s_cmp_lt_u32 s34, 48235008
s_cbranch_scc0 Lnoep
v_cmp_ne_u64 vcc, s[36:37], v[246:247]
s_mov_b32 s49, 262144
s_cbranch_vccnz Lsp4
Lok3:
Lnoep:
v_mfma_f32_16x16x32_bf16 v[64:67], a[32:35], a[176:179], v[64:67]
ds_write_b128 v248, v[36:39] offset:1024
v_mfma_f32_16x16x32_bf16 v[64:67], a[48:51], a[180:183], v[64:67]
v_mul_f32 v56, s81, v56
v_mul_f32 v57, s81, v57
v_mfma_f32_16x16x32_bf16 v[68:71], a[52:55], a[180:183], v[68:71]
v_mul_f32 v58, s81, v58
v_mul_f32 v59, s81, v59
v_mfma_f32_16x16x32_bf16 v[68:71], a[36:39], a[176:179], v[68:71]
v_cvt_pk_bf16_f32 v40, v40, v41
v_cvt_pk_bf16_f32 v41, v42, v43
v_mfma_f32_16x16x32_bf16 v[72:75], a[40:43], a[176:179], v[72:75]
v_cvt_pk_bf16_f32 v42, v56, v57
v_cvt_pk_bf16_f32 v43, v58, v59
v_mfma_f32_16x16x32_bf16 v[72:75], a[56:59], a[180:183], v[72:75]
buffer_store_dwordx4 v[40:43], v233, s[16:19], s62 offen offset:2048 sc1
v_mfma_f32_16x16x32_bf16 v[76:79], a[60:63], a[180:183], v[76:79]
ds_write_b128 v248, v[40:43] offset:2048
v_mfma_f32_16x16x32_bf16 v[76:79], a[44:47], a[176:179], v[76:79]
v_mul_f32 v60, s81, v60
v_mul_f32 v61, s81, v61
s_waitcnt lgkmcnt(0)
v_mfma_f32_16x16x32_bf16 v[64:67], a[64:67], a[184:187], v[64:67]
ds_read_b64_tr_b16 a[128:129], v219 offset:0
v_mul_f32 v62, s81, v62
v_mfma_f32_16x16x32_bf16 v[64:67], a[80:83], a[188:191], v[64:67]
ds_read_b64_tr_b16 a[130:131], v219 offset:1024
v_mul_f32 v63, s81, v63
v_mfma_f32_16x16x32_bf16 v[64:67], a[96:99], a[192:195], v[64:67]
ds_read_b64_tr_b16 a[132:133], v219 offset:14336
v_cvt_pk_bf16_f32 v44, v44, v45
v_mfma_f32_16x16x32_bf16 v[64:67], a[112:115], a[196:199], v[64:67]
v_cvt_pk_bf16_f32 v45, v46, v47
v_cvt_pk_bf16_f32 v46, v60, v61
v_mfma_f32_16x16x32_bf16 v[68:71], a[116:119], a[196:199], v[68:71]
ds_read_b64_tr_b16 a[134:135], v219 offset:15360
v_cvt_pk_bf16_f32 v47, v62, v63
v_mfma_f32_16x16x32_bf16 v[68:71], a[100:103], a[192:195], v[68:71]
ds_read_b64_tr_b16 a[136:137], v219 offset:28672
v_mfma_f32_16x16x32_bf16 v[68:71], a[84:87], a[188:191], v[68:71]
ds_read_b64_tr_b16 a[138:139], v219 offset:29696
v_mfma_f32_16x16x32_bf16 v[68:71], a[68:71], a[184:187], v[68:71]
buffer_store_dwordx4 v[44:47], v233, s[16:19], s62 offen offset:3072 sc1
v_mfma_f32_16x16x32_bf16 v[72:75], a[72:75], a[184:187], v[72:75]
ds_read_b64_tr_b16 a[140:141], v219 offset:43008
v_mfma_f32_16x16x32_bf16 v[72:75], a[88:91], a[188:191], v[72:75]
ds_read_b64_tr_b16 a[142:143], v219 offset:44032
v_mfma_f32_16x16x32_bf16 v[72:75], a[104:107], a[192:195], v[72:75]
ds_read_b64_tr_b16 a[144:145], v211 offset:28672
v_mfma_f32_16x16x32_bf16 v[72:75], a[120:123], a[196:199], v[72:75]
ds_write_b128 v248, v[44:47] offset:3072
v_mfma_f32_16x16x32_bf16 v[76:79], a[124:127], a[196:199], v[76:79]
ds_read_b64_tr_b16 a[146:147], v211 offset:29696
v_cvt_pk_bf16_f32 v64, v64, v65
v_mfma_f32_16x16x32_bf16 v[76:79], a[108:111], a[192:195], v[76:79]
ds_read_b64_tr_b16 a[148:149], v211 offset:43008
v_cvt_pk_bf16_f32 v65, v66, v67
v_mfma_f32_16x16x32_bf16 v[76:79], a[92:95], a[188:191], v[76:79]
ds_read_b64_tr_b16 a[150:151], v211 offset:44032
v_cvt_pk_bf16_f32 v66, v68, v69
v_mfma_f32_16x16x32_bf16 v[76:79], a[76:79], a[184:187], v[76:79]
v_cvt_pk_bf16_f32 v67, v70, v71
v_and_b32 v252, 15, v234
v_mfma_f32_16x16x32_bf16 v[80:83], a[32:35], a[200:203], v[80:83]
ds_read_b64_tr_b16 a[152:153], v220 offset:0
v_lshrrev_b32 v253, 4, v234
v_mfma_f32_16x16x32_bf16 v[80:83], a[48:51], a[204:207], v[80:83]
ds_read_b64_tr_b16 a[154:155], v220 offset:1024
v_lshlrev_b32 v253, 2, v253
v_mfma_f32_16x16x32_bf16 v[80:83], a[64:67], a[208:211], v[80:83]
buffer_store_dwordx4 v[64:67], v233, s[16:19], s63 offen offset:0 sc1
v_mfma_f32_16x16x32_bf16 v[80:83], a[80:83], a[212:215], v[80:83]
ds_read_b64_tr_b16 a[156:157], v220 offset:14336
v_mfma_f32_16x16x32_bf16 v[80:83], a[96:99], a[216:219], v[80:83]
ds_read_b64_tr_b16 a[158:159], v220 offset:15360
v_mov_b32 v58, 0xf149f2ca
v_mfma_f32_16x16x32_bf16 v[80:83], a[112:115], a[220:223], v[80:83]
ds_read_b64_tr_b16 a[160:161], v220 offset:28672
v_mfma_f32_16x16x32_bf16 v[84:87], a[116:119], a[220:223], v[84:87]
ds_write_b128 v249, v[64:67] offset:0
v_mfma_f32_16x16x32_bf16 v[84:87], a[100:103], a[216:219], v[84:87]
ds_read_b64_tr_b16 a[162:163], v220 offset:29696
v_cvt_pk_bf16_f32 v72, v72, v73
v_mfma_f32_16x16x32_bf16 v[84:87], a[84:87], a[212:215], v[84:87]
ds_read_b64_tr_b16 a[164:165], v220 offset:43008
v_cvt_pk_bf16_f32 v73, v74, v75
v_mfma_f32_16x16x32_bf16 v[84:87], a[68:71], a[208:211], v[84:87]
ds_read_b64_tr_b16 a[166:167], v220 offset:44032
v_cvt_pk_bf16_f32 v74, v76, v77
v_mfma_f32_16x16x32_bf16 v[84:87], a[52:55], a[204:207], v[84:87]
v_cvt_pk_bf16_f32 v75, v78, v79
v_add_u32 v254, 0, v253
v_mfma_f32_16x16x32_bf16 v[84:87], a[36:39], a[200:203], v[84:87]
ds_read_b64_tr_b16 a[168:169], v212 offset:28672
v_cmp_le_u32 s[42:43], v254, v252
v_mfma_f32_16x16x32_bf16 v[88:91], a[40:43], a[200:203], v[88:91]
ds_read_b64_tr_b16 a[170:171], v212 offset:29696
v_cndmask_b32_e64 v48, v58, 0, s[42:43]
v_mfma_f32_16x16x32_bf16 v[88:91], a[56:59], a[204:207], v[88:91]
ds_read_b64_tr_b16 a[172:173], v212 offset:43008
v_cndmask_b32_e64 v52, 0, v58, s[42:43]
v_mfma_f32_16x16x32_bf16 v[88:91], a[72:75], a[208:211], v[88:91]
buffer_store_dwordx4 v[72:75], v233, s[16:19], s63 offen offset:2048 sc1
v_mfma_f32_16x16x32_bf16 v[88:91], a[88:91], a[212:215], v[88:91]
ds_read_b64_tr_b16 a[174:175], v212 offset:44032
v_mfma_f32_16x16x32_bf16 v[88:91], a[104:107], a[216:219], v[88:91]
ds_read_b64_tr_b16 a[176:177], v221 offset:0
v_add_u32 v254, 1, v253
v_mfma_f32_16x16x32_bf16 v[88:91], a[120:123], a[220:223], v[88:91]
ds_read_b64_tr_b16 a[178:179], v221 offset:1024
v_mfma_f32_16x16x32_bf16 v[92:95], a[124:127], a[220:223], v[92:95]
ds_write_b128 v249, v[72:75] offset:2048
v_mfma_f32_16x16x32_bf16 v[92:95], a[108:111], a[216:219], v[92:95]
ds_read_b64_tr_b16 a[180:181], v221 offset:14336
v_cvt_pk_bf16_f32 v80, v80, v81
v_mfma_f32_16x16x32_bf16 v[92:95], a[92:95], a[212:215], v[92:95]
ds_read_b64_tr_b16 a[182:183], v221 offset:15360
v_cvt_pk_bf16_f32 v81, v82, v83
v_mfma_f32_16x16x32_bf16 v[92:95], a[76:79], a[208:211], v[92:95]
v_cvt_pk_bf16_f32 v82, v84, v85
v_cvt_pk_bf16_f32 v83, v86, v87
v_mfma_f32_16x16x32_bf16 v[92:95], a[60:63], a[204:207], v[92:95]
buffer_store_dwordx4 v[80:83], v233, s[16:19], s63 offen offset:1024 sc1
v_mfma_f32_16x16x32_bf16 v[92:95], a[44:47], a[200:203], v[92:95]
ds_write_b128 v249, v[80:83] offset:1024
v_mfma_f32_16x16x32_bf16 v[96:99], a[224:227], a[32:35], v[96:99]
v_cmp_le_u32 s[42:43], v254, v252
s_nop 1
v_cndmask_b32_e64 v49, v58, 0, s[42:43]
v_mfma_f32_16x16x32_bf16 v[96:99], a[228:231], a[48:51], v[96:99]
v_cndmask_b32_e64 v53, 0, v58, s[42:43]
v_add_u32 v254, 2, v253
v_mfma_f32_16x16x32_bf16 v[100:103], a[228:231], a[52:55], v[100:103]
v_mfma_f32_16x16x32_bf16 v[100:103], a[224:227], a[36:39], v[100:103]
v_cvt_pk_bf16_f32 v88, v88, v89
v_cvt_pk_bf16_f32 v89, v90, v91
v_mfma_f32_16x16x32_bf16 v[104:107], a[224:227], a[40:43], v[104:107]
v_cvt_pk_bf16_f32 v90, v92, v93
v_cvt_pk_bf16_f32 v91, v94, v95
v_mfma_f32_16x16x32_bf16 v[104:107], a[228:231], a[56:59], v[104:107]
buffer_store_dwordx4 v[88:91], v233, s[16:19], s63 offen offset:3072 sc1
v_mfma_f32_16x16x32_bf16 v[108:111], a[228:231], a[60:63], v[108:111]
ds_write_b128 v249, v[88:91] offset:3072
v_mfma_f32_16x16x32_bf16 v[108:111], a[224:227], a[44:47], v[108:111]
v_cmp_le_u32 s[42:43], v254, v252
s_nop 1
v_cndmask_b32_e64 v50, v58, 0, s[42:43]
s_waitcnt lgkmcnt(0)
v_mfma_f32_16x16x32_bf16 v[96:99], a[128:131], a[64:67], v[96:99]
ds_read_b64_tr_b16 a[184:185], v221 offset:28672
v_mfma_f32_16x16x32_bf16 v[96:99], a[132:135], a[80:83], v[96:99]
ds_read_b64_tr_b16 a[186:187], v221 offset:29696
v_cndmask_b32_e64 v54, 0, v58, s[42:43]
v_mfma_f32_16x16x32_bf16 v[96:99], a[136:139], a[96:99], v[96:99]
v_mfma_f32_16x16x32_bf16 v[96:99], a[140:143], a[112:115], v[96:99]
ds_read_b64_tr_b16 a[188:189], v221 offset:43008
v_add_u32 v254, 3, v253
v_mfma_f32_16x16x32_bf16 v[100:103], a[140:143], a[116:119], v[100:103]
v_mfma_f32_16x16x32_bf16 v[100:103], a[136:139], a[100:103], v[100:103]
ds_read_b64_tr_b16 a[190:191], v221 offset:44032
v_cmp_le_u32 s[42:43], v254, v252
v_mfma_f32_16x16x32_bf16 v[100:103], a[132:135], a[84:87], v[100:103]
v_mfma_f32_16x16x32_bf16 v[100:103], a[128:131], a[68:71], v[100:103]
ds_read_b64_tr_b16 a[192:193], v213 offset:28672
v_mfma_f32_16x16x32_bf16 v[104:107], a[128:131], a[72:75], v[104:107]
v_cndmask_b32_e64 v51, v58, 0, s[42:43]
v_mfma_f32_16x16x32_bf16 v[104:107], a[132:135], a[88:91], v[104:107]
ds_read_b64_tr_b16 a[194:195], v213 offset:29696
v_mfma_f32_16x16x32_bf16 v[104:107], a[136:139], a[104:107], v[104:107]
v_cndmask_b32_e64 v55, 0, v58, s[42:43]
v_mfma_f32_16x16x32_bf16 v[104:107], a[140:143], a[120:123], v[104:107]
s_lshl_b32 s45, s38, 12
ds_read_b64_tr_b16 a[196:197], v213 offset:43008
v_mfma_f32_16x16x32_bf16 v[108:111], a[140:143], a[124:127], v[108:111]
v_mfma_f32_16x16x32_bf16 v[108:111], a[136:139], a[108:111], v[108:111]
ds_read_b64_tr_b16 a[198:199], v213 offset:44032
v_and_b32 v235, 7, v234
v_mfma_f32_16x16x32_bf16 v[108:111], a[132:135], a[92:95], v[108:111]
v_mfma_f32_16x16x32_bf16 v[108:111], a[128:131], a[76:79], v[108:111]
ds_read_b64_tr_b16 a[200:201], v222 offset:0
v_lshlrev_b32 v235, 9, v235
v_mfma_f32_16x16x32_bf16 v[112:115], a[144:147], a[32:35], v[112:115]
v_mfma_f32_16x16x32_bf16 v[112:115], a[148:151], a[48:51], v[112:115]
ds_read_b64_tr_b16 a[202:203], v222 offset:1024
v_add_u32 v235, s45, v235
v_mfma_f32_16x16x32_bf16 v[112:115], a[152:155], a[64:67], v[112:115]
v_mfma_f32_16x16x32_bf16 v[112:115], a[156:159], a[80:83], v[112:115]
ds_read_b64_tr_b16 a[204:205], v222 offset:14336
v_mfma_f32_16x16x32_bf16 v[112:115], a[160:163], a[96:99], v[112:115]
v_add_u32 v57, 4294950912, v249
v_mfma_f32_16x16x32_bf16 v[112:115], a[164:167], a[112:115], v[112:115]
ds_read_b64_tr_b16 a[206:207], v222 offset:15360
v_mfma_f32_16x16x32_bf16 v[116:119], a[164:167], a[116:119], v[116:119]
v_add_u32 v56, 4294950912, v248
v_mfma_f32_16x16x32_bf16 v[116:119], a[160:163], a[100:103], v[116:119]
ds_read_b64_tr_b16 a[208:209], v222 offset:28672
v_mfma_f32_16x16x32_bf16 v[116:119], a[156:159], a[84:87], v[116:119]
ds_read_b64_tr_b16 a[210:211], v222 offset:29696
v_mfma_f32_16x16x32_bf16 v[116:119], a[152:155], a[68:71], v[116:119]
v_cvt_pk_bf16_f32 v96, v96, v97
v_cvt_pk_bf16_f32 v97, v98, v99
v_mfma_f32_16x16x32_bf16 v[116:119], a[148:151], a[52:55], v[116:119]
ds_read_b64_tr_b16 a[212:213], v222 offset:43008
v_cvt_pk_bf16_f32 v98, v112, v113
v_mfma_f32_16x16x32_bf16 v[116:119], a[144:147], a[36:39], v[116:119]
v_cvt_pk_bf16_f32 v99, v114, v115
v_pk_max_i16 v96, v96, 0
v_mfma_f32_16x16x32_bf16 v[120:123], a[144:147], a[40:43], v[120:123]
ds_read_b64_tr_b16 a[214:215], v222 offset:44032
v_pk_max_i16 v97, v97, 0
v_mfma_f32_16x16x32_bf16 v[120:123], a[148:151], a[56:59], v[120:123]
v_pk_max_i16 v98, v98, 0
v_pk_max_i16 v99, v99, 0
v_mfma_f32_16x16x32_bf16 v[120:123], a[152:155], a[72:75], v[120:123]
ds_read_b64_tr_b16 a[216:217], v214 offset:28672
v_mfma_f32_16x16x32_bf16 v[120:123], a[156:159], a[88:91], v[120:123]
buffer_store_dwordx4 v[96:99], v233, s[16:19], s64 offen offset:0 sc1
v_mfma_f32_16x16x32_bf16 v[120:123], a[160:163], a[104:107], v[120:123]
ds_read_b64_tr_b16 a[218:219], v214 offset:29696
v_cvt_pk_bf16_f32 v100, v100, v101
v_mfma_f32_16x16x32_bf16 v[120:123], a[164:167], a[120:123], v[120:123]
v_cvt_pk_bf16_f32 v101, v102, v103
v_cvt_pk_bf16_f32 v102, v116, v117
v_mfma_f32_16x16x32_bf16 v[124:127], a[164:167], a[124:127], v[124:127]
ds_read_b64_tr_b16 a[220:221], v214 offset:43008
v_cvt_pk_bf16_f32 v103, v118, v119
v_mfma_f32_16x16x32_bf16 v[124:127], a[160:163], a[108:111], v[124:127]
v_pk_max_i16 v100, v100, 0
v_pk_max_i16 v101, v101, 0
v_mfma_f32_16x16x32_bf16 v[124:127], a[156:159], a[92:95], v[124:127]
ds_read_b64_tr_b16 a[222:223], v214 offset:44032
v_pk_max_i16 v102, v102, 0
v_mfma_f32_16x16x32_bf16 v[124:127], a[152:155], a[76:79], v[124:127]
v_pk_max_i16 v103, v103, 0
v_mfma_f32_16x16x32_bf16 v[124:127], a[148:151], a[60:63], v[124:127]
ds_read_b64_tr_b16 a[224:225], v223 offset:0
v_mfma_f32_16x16x32_bf16 v[124:127], a[144:147], a[44:47], v[124:127]
buffer_store_dwordx4 v[100:103], v233, s[16:19], s64 offen offset:1024 sc1
v_mfma_f32_16x16x32_bf16 v[128:131], a[168:171], a[32:35], v[128:131]
ds_read_b64_tr_b16 a[226:227], v223 offset:1024
v_cvt_pk_bf16_f32 v104, v104, v105
v_mfma_f32_16x16x32_bf16 v[128:131], a[172:175], a[48:51], v[128:131]
v_cvt_pk_bf16_f32 v105, v106, v107
v_cvt_pk_bf16_f32 v106, v120, v121
v_mfma_f32_16x16x32_bf16 v[128:131], a[176:179], a[64:67], v[128:131]
ds_read_b64_tr_b16 a[228:229], v223 offset:14336
v_cvt_pk_bf16_f32 v107, v122, v123
v_mfma_f32_16x16x32_bf16 v[128:131], a[180:183], a[80:83], v[128:131]
v_pk_max_i16 v104, v104, 0
v_pk_max_i16 v105, v105, 0
v_mfma_f32_16x16x32_bf16 v[132:135], a[180:183], a[84:87], v[132:135]
ds_read_b64_tr_b16 a[230:231], v223 offset:15360
v_pk_max_i16 v106, v106, 0
v_mfma_f32_16x16x32_bf16 v[132:135], a[176:179], a[68:71], v[132:135]
v_pk_max_i16 v107, v107, 0
v_mfma_f32_16x16x32_bf16 v[132:135], a[172:175], a[52:55], v[132:135]
buffer_store_dwordx4 v[104:107], v233, s[16:19], s64 offen offset:2048 sc1
v_mfma_f32_16x16x32_bf16 v[132:135], a[168:171], a[36:39], v[132:135]
v_cvt_pk_bf16_f32 v108, v108, v109
v_cvt_pk_bf16_f32 v109, v110, v111
v_mfma_f32_16x16x32_bf16 v[136:139], a[168:171], a[40:43], v[136:139]
v_cvt_pk_bf16_f32 v110, v124, v125
v_cvt_pk_bf16_f32 v111, v126, v127
s_waitcnt vmcnt(3)
s_add_u32 s50, s34, 131072
buffer_store_dwordx2 v[238:239], v237, s[16:19], s50 offen sc1
v_mfma_f32_16x16x32_bf16 v[136:139], a[172:175], a[56:59], v[136:139]
v_pk_max_i16 v108, v108, 0
v_pk_max_i16 v109, v109, 0
v_mfma_f32_16x16x32_bf16 v[136:139], a[176:179], a[72:75], v[136:139]
v_pk_max_i16 v110, v110, 0
v_pk_max_i16 v111, v111, 0
v_mfma_f32_16x16x32_bf16 v[136:139], a[180:183], a[88:91], v[136:139]
buffer_store_dwordx4 v[108:111], v233, s[16:19], s64 offen offset:3072 sc1
v_mfma_f32_16x16x32_bf16 v[140:143], a[180:183], a[92:95], v[140:143]
s_add_u32 s64, s64, 4096
v_mfma_f32_16x16x32_bf16 v[140:143], a[176:179], a[76:79], v[140:143]
v_mfma_f32_16x16x32_bf16 v[140:143], a[172:175], a[60:63], v[140:143]
v_mfma_f32_16x16x32_bf16 v[140:143], a[168:171], a[44:47], v[140:143]
s_waitcnt lgkmcnt(0)
v_mfma_f32_16x16x32_bf16 v[128:131], a[184:187], a[96:99], v[128:131]
ds_read_b64_tr_b16 a[128:129], v223 offset:28672
v_mfma_f32_16x16x32_bf16 v[128:131], a[188:191], a[112:115], v[128:131]
ds_read_b64_tr_b16 a[130:131], v223 offset:29696
v_mfma_f32_16x16x32_bf16 v[132:135], a[188:191], a[116:119], v[132:135]
ds_read_b64_tr_b16 a[132:133], v223 offset:43008
v_mfma_f32_16x16x32_bf16 v[132:135], a[184:187], a[100:103], v[132:135]
v_mfma_f32_16x16x32_bf16 v[136:139], a[184:187], a[104:107], v[136:139]
ds_read_b64_tr_b16 a[134:135], v223 offset:44032
v_mfma_f32_16x16x32_bf16 v[136:139], a[188:191], a[120:123], v[136:139]
ds_read_b64_tr_b16 a[136:137], v215 offset:28672
v_mfma_f32_16x16x32_bf16 v[140:143], a[188:191], a[124:127], v[140:143]
ds_read_b64_tr_b16 a[138:139], v215 offset:29696
v_mfma_f32_16x16x32_bf16 v[140:143], a[184:187], a[108:111], v[140:143]
v_mfma_f32_16x16x32_bf16 v[144:147], a[192:195], a[32:35], v[144:147]
ds_read_b64_tr_b16 a[140:141], v215 offset:43008
v_mfma_f32_16x16x32_bf16 v[144:147], a[196:199], a[48:51], v[144:147]
ds_read_b64_tr_b16 a[142:143], v215 offset:44032
v_mfma_f32_16x16x32_bf16 v[144:147], a[200:203], a[64:67], v[144:147]
ds_read_b64_tr_b16 a[144:145], v224 offset:0
v_mfma_f32_16x16x32_bf16 v[144:147], a[204:207], a[80:83], v[144:147]
v_mfma_f32_16x16x32_bf16 v[144:147], a[208:211], a[96:99], v[144:147]
ds_read_b64_tr_b16 a[146:147], v224 offset:1024
v_mfma_f32_16x16x32_bf16 v[144:147], a[212:215], a[112:115], v[144:147]
ds_read_b64_tr_b16 a[148:149], v224 offset:14336
v_mfma_f32_16x16x32_bf16 v[148:151], a[212:215], a[116:119], v[148:151]
ds_read_b64_tr_b16 a[150:151], v224 offset:15360
v_mfma_f32_16x16x32_bf16 v[148:151], a[208:211], a[100:103], v[148:151]
v_mfma_f32_16x16x32_bf16 v[148:151], a[204:207], a[84:87], v[148:151]
ds_read_b64_tr_b16 a[152:153], v224 offset:28672
v_mfma_f32_16x16x32_bf16 v[148:151], a[200:203], a[68:71], v[148:151]
ds_read_b64_tr_b16 a[154:155], v224 offset:29696
v_cvt_pk_bf16_f32 v128, v128, v129
v_mfma_f32_16x16x32_bf16 v[148:151], a[196:199], a[52:55], v[148:151]
v_cvt_pk_bf16_f32 v129, v130, v131
v_cvt_pk_bf16_f32 v130, v144, v145
v_mfma_f32_16x16x32_bf16 v[148:151], a[192:195], a[36:39], v[148:151]
ds_read_b64_tr_b16 a[156:157], v224 offset:43008
v_cvt_pk_bf16_f32 v131, v146, v147
v_mfma_f32_16x16x32_bf16 v[152:155], a[192:195], a[40:43], v[152:155]
ds_read_b64_tr_b16 a[158:159], v224 offset:44032
v_pk_max_i16 v128, v128, 0
v_mfma_f32_16x16x32_bf16 v[152:155], a[196:199], a[56:59], v[152:155]
ds_read_b64_tr_b16 a[160:161], v216 offset:28672
v_pk_max_i16 v129, v129, 0
v_mfma_f32_16x16x32_bf16 v[152:155], a[200:203], a[72:75], v[152:155]
v_pk_max_i16 v130, v130, 0
v_pk_max_i16 v131, v131, 0
v_mfma_f32_16x16x32_bf16 v[152:155], a[204:207], a[88:91], v[152:155]
ds_read_b64_tr_b16 a[162:163], v216 offset:29696
v_mfma_f32_16x16x32_bf16 v[152:155], a[208:211], a[104:107], v[152:155]
ds_read_b64_tr_b16 a[164:165], v216 offset:43008
v_mfma_f32_16x16x32_bf16 v[152:155], a[212:215], a[120:123], v[152:155]
ds_read_b64_tr_b16 a[166:167], v216 offset:44032
v_mfma_f32_16x16x32_bf16 v[156:159], a[212:215], a[124:127], v[156:159]
buffer_store_dwordx4 v[128:131], v233, s[16:19], s64 offen offset:0 sc1
v_mfma_f32_16x16x32_bf16 v[156:159], a[208:211], a[108:111], v[156:159]
ds_read_b64_tr_b16 a[168:169], v225 offset:0
v_cvt_pk_bf16_f32 v132, v132, v133
v_mfma_f32_16x16x32_bf16 v[156:159], a[204:207], a[92:95], v[156:159]
ds_read_b64_tr_b16 a[170:171], v225 offset:1024
v_cvt_pk_bf16_f32 v133, v134, v135
v_mfma_f32_16x16x32_bf16 v[156:159], a[200:203], a[76:79], v[156:159]
ds_read_b64_tr_b16 a[172:173], v225 offset:14336
v_cvt_pk_bf16_f32 v134, v148, v149
v_mfma_f32_16x16x32_bf16 v[156:159], a[196:199], a[60:63], v[156:159]
v_cvt_pk_bf16_f32 v135, v150, v151
v_pk_max_i16 v132, v132, 0
v_mfma_f32_16x16x32_bf16 v[156:159], a[192:195], a[44:47], v[156:159]
ds_read_b64_tr_b16 a[174:175], v225 offset:15360
v_pk_max_i16 v133, v133, 0
v_mfma_f32_16x16x32_bf16 v[160:163], a[216:219], a[32:35], v[160:163]
ds_read_b64_tr_b16 a[176:177], v225 offset:28672
v_pk_max_i16 v134, v134, 0
v_mfma_f32_16x16x32_bf16 v[160:163], a[220:223], a[48:51], v[160:163]
ds_read_b64_tr_b16 a[178:179], v225 offset:29696
v_pk_max_i16 v135, v135, 0
v_mfma_f32_16x16x32_bf16 v[160:163], a[224:227], a[64:67], v[160:163]
buffer_store_dwordx4 v[132:135], v233, s[16:19], s64 offen offset:1024 sc1
v_mfma_f32_16x16x32_bf16 v[160:163], a[228:231], a[80:83], v[160:163]
ds_read_b64_tr_b16 a[180:181], v225 offset:43008
v_cvt_pk_bf16_f32 v136, v136, v137
v_mfma_f32_16x16x32_bf16 v[164:167], a[228:231], a[84:87], v[164:167]
ds_read_b64_tr_b16 a[182:183], v225 offset:44032
v_cvt_pk_bf16_f32 v137, v138, v139
v_mfma_f32_16x16x32_bf16 v[164:167], a[224:227], a[68:71], v[164:167]
v_cvt_pk_bf16_f32 v138, v152, v153
v_cvt_pk_bf16_f32 v139, v154, v155
v_mfma_f32_16x16x32_bf16 v[164:167], a[220:223], a[52:55], v[164:167]
v_pk_max_i16 v136, v136, 0
v_pk_max_i16 v137, v137, 0
v_mfma_f32_16x16x32_bf16 v[164:167], a[216:219], a[36:39], v[164:167]
v_pk_max_i16 v138, v138, 0
v_pk_max_i16 v139, v139, 0
v_mfma_f32_16x16x32_bf16 v[168:171], a[216:219], a[40:43], v[168:171]
buffer_store_dwordx4 v[136:139], v233, s[16:19], s64 offen offset:2048 sc1
v_mfma_f32_16x16x32_bf16 v[168:171], a[220:223], a[56:59], v[168:171]
v_cvt_pk_bf16_f32 v140, v140, v141
v_cvt_pk_bf16_f32 v141, v142, v143
v_mfma_f32_16x16x32_bf16 v[168:171], a[224:227], a[72:75], v[168:171]
v_cvt_pk_bf16_f32 v142, v156, v157
v_cvt_pk_bf16_f32 v143, v158, v159
v_mfma_f32_16x16x32_bf16 v[168:171], a[228:231], a[88:91], v[168:171]
Lpad6:
s_cbranch_execz Lpad10
v_pk_max_i16 v140, v140, 0
v_pk_max_i16 v141, v141, 0
v_mfma_f32_16x16x32_bf16 v[172:175], a[228:231], a[92:95], v[172:175]
v_pk_max_i16 v142, v142, 0
v_pk_max_i16 v143, v143, 0
v_mfma_f32_16x16x32_bf16 v[172:175], a[224:227], a[76:79], v[172:175]
buffer_store_dwordx4 v[140:143], v233, s[16:19], s64 offen offset:3072 sc1
v_mfma_f32_16x16x32_bf16 v[172:175], a[220:223], a[60:63], v[172:175]
s_add_u32 s64, s64, 4096
v_mfma_f32_16x16x32_bf16 v[172:175], a[216:219], a[44:47], v[172:175]
s_waitcnt lgkmcnt(0)
v_mfma_f32_16x16x32_bf16 v[160:163], a[128:131], a[96:99], v[160:163]
ds_read_b64_tr_b16 a[184:185], v208 offset:28672
v_mfma_f32_16x16x32_bf16 v[160:163], a[132:135], a[112:115], v[160:163]
ds_read_b64_tr_b16 a[186:187], v208 offset:28928
v_mfma_f32_16x16x32_bf16 v[164:167], a[132:135], a[116:119], v[164:167]
v_mfma_f32_16x16x32_bf16 v[164:167], a[128:131], a[100:103], v[164:167]
ds_read_b64_tr_b16 a[188:189], v208 offset:43008
v_mfma_f32_16x16x32_bf16 v[168:171], a[128:131], a[104:107], v[168:171]
v_mfma_f32_16x16x32_bf16 v[168:171], a[132:135], a[120:123], v[168:171]
ds_read_b64_tr_b16 a[190:191], v208 offset:43264
v_mfma_f32_16x16x32_bf16 v[172:175], a[132:135], a[124:127], v[172:175]
v_mfma_f32_16x16x32_bf16 v[172:175], a[128:131], a[108:111], v[172:175]
ds_read_b64_tr_b16 a[192:193], v217 offset:0
v_mfma_f32_16x16x32_bf16 v[176:179], a[136:139], a[32:35], v[176:179]
v_mfma_f32_16x16x32_bf16 v[176:179], a[140:143], a[48:51], v[176:179]
ds_read_b64_tr_b16 a[194:195], v217 offset:256
v_mfma_f32_16x16x32_bf16 v[176:179], a[144:147], a[64:67], v[176:179]
v_mfma_f32_16x16x32_bf16 v[176:179], a[148:151], a[80:83], v[176:179]
ds_read_b64_tr_b16 a[196:197], v217 offset:14336
v_mfma_f32_16x16x32_bf16 v[176:179], a[152:155], a[96:99], v[176:179]
v_mfma_f32_16x16x32_bf16 v[176:179], a[156:159], a[112:115], v[176:179]
ds_read_b64_tr_b16 a[198:199], v217 offset:14592
v_mfma_f32_16x16x32_bf16 v[180:183], a[156:159], a[116:119], v[180:183]
v_mfma_f32_16x16x32_bf16 v[180:183], a[152:155], a[100:103], v[180:183]
ds_read_b64_tr_b16 a[200:201], v217 offset:28672
v_mfma_f32_16x16x32_bf16 v[180:183], a[148:151], a[84:87], v[180:183]
v_mfma_f32_16x16x32_bf16 v[180:183], a[144:147], a[68:71], v[180:183]
ds_read_b64_tr_b16 a[202:203], v217 offset:28928
v_cvt_pk_bf16_f32 v160, v160, v161
v_mfma_f32_16x16x32_bf16 v[180:183], a[140:143], a[52:55], v[180:183]
v_cvt_pk_bf16_f32 v161, v162, v163
v_cvt_pk_bf16_f32 v162, v176, v177
v_mfma_f32_16x16x32_bf16 v[180:183], a[136:139], a[36:39], v[180:183]
ds_read_b64_tr_b16 a[204:205], v217 offset:43008
v_cvt_pk_bf16_f32 v163, v178, v179
v_mfma_f32_16x16x32_bf16 v[184:187], a[136:139], a[40:43], v[184:187]
v_pk_max_i16 v160, v160, 0
v_pk_max_i16 v161, v161, 0
v_mfma_f32_16x16x32_bf16 v[184:187], a[140:143], a[56:59], v[184:187]
ds_read_b64_tr_b16 a[206:207], v217 offset:43264
v_pk_max_i16 v162, v162, 0
v_mfma_f32_16x16x32_bf16 v[184:187], a[144:147], a[72:75], v[184:187]
v_pk_max_i16 v163, v163, 0
v_mfma_f32_16x16x32_bf16 v[184:187], a[148:151], a[88:91], v[184:187]
ds_read_b64_tr_b16 a[208:209], v209 offset:28672
v_cvt_pk_bf16_f32 v164, v164, v165
v_mfma_f32_16x16x32_bf16 v[184:187], a[152:155], a[104:107], v[184:187]
ds_read_b64_tr_b16 a[210:211], v209 offset:28928
v_cvt_pk_bf16_f32 v165, v166, v167
v_mfma_f32_16x16x32_bf16 v[184:187], a[156:159], a[120:123], v[184:187]
v_cvt_pk_bf16_f32 v166, v180, v181
v_cvt_pk_bf16_f32 v167, v182, v183
v_mfma_f32_16x16x32_bf16 v[188:191], a[156:159], a[124:127], v[188:191]
ds_read_b64_tr_b16 a[212:213], v209 offset:43008
v_pk_max_i16 v164, v164, 0
v_mfma_f32_16x16x32_bf16 v[188:191], a[152:155], a[108:111], v[188:191]
v_pk_max_i16 v165, v165, 0
v_pk_max_i16 v166, v166, 0
v_mfma_f32_16x16x32_bf16 v[188:191], a[148:151], a[92:95], v[188:191]
ds_read_b64_tr_b16 a[214:215], v209 offset:43264
v_pk_max_i16 v167, v167, 0
v_mfma_f32_16x16x32_bf16 v[188:191], a[144:147], a[76:79], v[188:191]
v_cvt_pk_bf16_f32 v168, v168, v169
v_cvt_pk_bf16_f32 v169, v170, v171
v_mfma_f32_16x16x32_bf16 v[188:191], a[140:143], a[60:63], v[188:191]
ds_read_b64_tr_b16 a[216:217], v218 offset:0
v_cvt_pk_bf16_f32 v170, v184, v185
v_mfma_f32_16x16x32_bf16 v[188:191], a[136:139], a[44:47], v[188:191]
v_cvt_pk_bf16_f32 v171, v186, v187
v_pk_max_i16 v168, v168, 0
v_mfma_f32_16x16x32_bf16 v[192:195], a[160:163], a[32:35], v[192:195]
ds_read_b64_tr_b16 a[218:219], v218 offset:256
v_pk_max_i16 v169, v169, 0
v_mfma_f32_16x16x32_bf16 v[192:195], a[164:167], a[48:51], v[192:195]
v_pk_max_i16 v170, v170, 0
v_pk_max_i16 v171, v171, 0
v_mfma_f32_16x16x32_bf16 v[192:195], a[168:171], a[64:67], v[192:195]
ds_read_b64_tr_b16 a[220:221], v218 offset:14336
s_add_u32 s51, s67, 131072
buffer_load_dwordx2 v[246:247], v245, s[16:19], s51 offen sc1
v_mfma_f32_16x16x32_bf16 v[192:195], a[172:175], a[80:83], v[192:195]
v_cvt_pk_bf16_f32 v172, v172, v173
v_cvt_pk_bf16_f32 v173, v174, v175
v_mfma_f32_16x16x32_bf16 v[192:195], a[176:179], a[96:99], v[192:195]
ds_read_b64_tr_b16 a[222:223], v218 offset:14592
v_cvt_pk_bf16_f32 v174, v188, v189
v_mfma_f32_16x16x32_bf16 v[192:195], a[180:183], a[112:115], v[192:195]
v_cvt_pk_bf16_f32 v175, v190, v191
v_pk_max_i16 v172, v172, 0
v_mfma_f32_16x16x32_bf16 v[196:199], a[180:183], a[116:119], v[196:199]
ds_read_b64_tr_b16 a[224:225], v218 offset:28672
v_pk_max_i16 v173, v173, 0
v_mfma_f32_16x16x32_bf16 v[196:199], a[176:179], a[100:103], v[196:199]
v_pk_max_i16 v174, v174, 0
v_pk_max_i16 v175, v175, 0
v_mfma_f32_16x16x32_bf16 v[196:199], a[172:175], a[84:87], v[196:199]
ds_read_b64_tr_b16 a[226:227], v218 offset:28928
v_mfma_f32_16x16x32_bf16 v[196:199], a[168:171], a[68:71], v[196:199]
v_mfma_f32_16x16x32_bf16 v[196:199], a[164:167], a[52:55], v[196:199]
ds_read_b64_tr_b16 a[228:229], v218 offset:43008
v_mfma_f32_16x16x32_bf16 v[196:199], a[160:163], a[36:39], v[196:199]
v_mfma_f32_16x16x32_bf16 v[200:203], a[160:163], a[40:43], v[200:203]
ds_read_b64_tr_b16 a[230:231], v218 offset:43264
v_mfma_f32_16x16x32_bf16 v[200:203], a[164:167], a[56:59], v[200:203]
v_mfma_f32_16x16x32_bf16 v[200:203], a[168:171], a[72:75], v[200:203]
v_mfma_f32_16x16x32_bf16 v[200:203], a[172:175], a[88:91], v[200:203]
v_cvt_pk_bf16_f32 v192, v192, v193
v_cvt_pk_bf16_f32 v193, v194, v195
v_mfma_f32_16x16x32_bf16 v[200:203], a[176:179], a[104:107], v[200:203]
v_cvt_pk_bf16_f32 v194, v196, v197
v_cvt_pk_bf16_f32 v195, v198, v199
v_mfma_f32_16x16x32_bf16 v[200:203], a[180:183], a[120:123], v[200:203]
v_pk_max_i16 v192, v192, 0
v_pk_max_i16 v193, v193, 0
v_mfma_f32_16x16x32_bf16 v[204:207], a[180:183], a[124:127], v[204:207]
v_pk_max_i16 v194, v194, 0
v_pk_max_i16 v195, v195, 0
v_mfma_f32_16x16x32_bf16 v[204:207], a[176:179], a[108:111], v[204:207]
v_permlane16_swap_b32 v192, v194
v_permlane16_swap_b32 v193, v195
v_mfma_f32_16x16x32_bf16 v[204:207], a[172:175], a[92:95], v[204:207]
v_mfma_f32_16x16x32_bf16 v[204:207], a[168:171], a[76:79], v[204:207]
v_mfma_f32_16x16x32_bf16 v[204:207], a[164:167], a[60:63], v[204:207]
v_mfma_f32_16x16x32_bf16 v[204:207], a[160:163], a[44:47], v[204:207]
s_waitcnt lgkmcnt(0)
v_mfma_f32_16x16x32_bf16 v[0:3], a[184:187], a[32:35], v[0:3]
v_lshrrev_b32 v252, 2, v234
v_and_b32 v253, 3, v234
v_mfma_f32_16x16x32_bf16 v[0:3], a[188:191], a[48:51], v[0:3]
v_lshlrev_b32 v253, 3, v253
v_add_u32 v253, 32768, v253
v_mfma_f32_16x16x32_bf16 v[0:3], a[192:195], a[64:67], v[0:3]
v_lshl_add_u32 v254, v252, 7, v253
v_lshl_add_u32 v253, v252, 8, v253
v_mfma_f32_16x16x32_bf16 v[0:3], a[196:199], a[80:83], v[0:3]
v_cvt_pk_bf16_f32 v200, v200, v201
v_cvt_pk_bf16_f32 v201, v202, v203
v_mfma_f32_16x16x32_bf16 v[0:3], a[200:203], a[96:99], v[0:3]
v_cvt_pk_bf16_f32 v202, v204, v205
v_cvt_pk_bf16_f32 v203, v206, v207
v_mfma_f32_16x16x32_bf16 v[0:3], a[204:207], a[112:115], v[0:3]
v_pk_max_i16 v200, v200, 0
v_pk_max_i16 v201, v201, 0
v_mfma_f32_16x16x32_bf16 v[4:7], a[204:207], a[116:119], v[4:7]
v_pk_max_i16 v202, v202, 0
v_pk_max_i16 v203, v203, 0
v_mfma_f32_16x16x32_bf16 v[4:7], a[200:203], a[100:103], v[4:7]
v_permlane16_swap_b32 v200, v202
v_permlane16_swap_b32 v201, v203
v_mfma_f32_16x16x32_bf16 v[4:7], a[196:199], a[84:87], v[4:7]
v_and_b32 v252, 7, v252
s_lshl_b32 s45, s40, 2
v_mfma_f32_16x16x32_bf16 v[4:7], a[192:195], a[68:71], v[4:7]
v_xor_b32 v252, s45, v252
v_xor_b32 v255, 0, v252
v_mfma_f32_16x16x32_bf16 v[4:7], a[188:191], a[52:55], v[4:7]
v_lshl_add_u32 v208, v255, 5, v253
v_add_u32 v216, 49152, v208
v_mfma_f32_16x16x32_bf16 v[4:7], a[184:187], a[36:39], v[4:7]
v_xor_b32 v255, 1, v252
v_lshl_add_u32 v209, v255, 5, v253
v_mfma_f32_16x16x32_bf16 v[8:11], a[184:187], a[40:43], v[8:11]
v_add_u32 v217, 49152, v209
v_xor_b32 v255, 2, v252
v_mfma_f32_16x16x32_bf16 v[8:11], a[188:191], a[56:59], v[8:11]
v_lshl_add_u32 v210, v255, 5, v253
v_add_u32 v218, 49152, v210
s_waitcnt vmcnt(0)
v_cmp_ne_u64 vcc, s[36:37], v[246:247]
s_mov_b32 s49, 262144
s_cbranch_vccnz Lsp6
Lok5:
s_lshl_b32 s44, s3, 12
s_add_u32 m0, s44, 131072
s_nop 0
buffer_load_dwordx4 v233, s[16:19], s68 offen offset:0 sc1 lds
buffer_load_dwordx4 v233, s[16:19], s68 offen offset:1024 sc1 lds
buffer_load_dwordx4 v233, s[16:19], s68 offen offset:2048 sc1 lds
buffer_load_dwordx4 v233, s[16:19], s68 offen offset:3072 sc1 lds
s_lshl_b32 s44, s3, 12
s_add_u32 m0, s44, 0
s_nop 0
buffer_load_dwordx4 v233, s[16:19], s69 offen offset:0 sc1 lds
buffer_load_dwordx4 v233, s[16:19], s69 offen offset:1024 sc1 lds
buffer_load_dwordx4 v233, s[16:19], s69 offen offset:2048 sc1 lds
buffer_load_dwordx4 v233, s[16:19], s69 offen offset:3072 sc1 lds
s_add_u32 s50, s34, 262144
buffer_store_dwordx2 v[238:239], v237, s[16:19], s50 offen sc1
v_mfma_f32_16x16x32_bf16 v[8:11], a[192:195], a[72:75], v[8:11]
v_xor_b32 v255, 3, v252
v_lshl_add_u32 v211, v255, 5, v253
v_mfma_f32_16x16x32_bf16 v[8:11], a[196:199], a[88:91], v[8:11]
v_add_u32 v219, 49152, v211
v_xor_b32 v255, 4, v252
v_mfma_f32_16x16x32_bf16 v[8:11], a[200:203], a[104:107], v[8:11]
v_lshl_add_u32 v212, v255, 5, v253
v_add_u32 v220, 49152, v212
v_mfma_f32_16x16x32_bf16 v[8:11], a[204:207], a[120:123], v[8:11]
v_xor_b32 v255, 5, v252
v_lshl_add_u32 v213, v255, 5, v253
v_mfma_f32_16x16x32_bf16 v[12:15], a[204:207], a[124:127], v[12:15]
v_add_u32 v221, 49152, v213
v_xor_b32 v255, 6, v252
v_mfma_f32_16x16x32_bf16 v[12:15], a[200:203], a[108:111], v[12:15]
v_lshl_add_u32 v214, v255, 5, v253
v_add_u32 v222, 49152, v214
v_mfma_f32_16x16x32_bf16 v[12:15], a[196:199], a[92:95], v[12:15]
v_xor_b32 v255, 7, v252
v_lshl_add_u32 v215, v255, 5, v253
v_mfma_f32_16x16x32_bf16 v[12:15], a[192:195], a[76:79], v[12:15]
v_add_u32 v223, 49152, v215
v_and_b32 v232, 3, v234
v_mfma_f32_16x16x32_bf16 v[12:15], a[188:191], a[60:63], v[12:15]
v_lshlrev_b32 v232, 12, v232
v_bfe_u32 v252, v234, 3, 2
v_mfma_f32_16x16x32_bf16 v[12:15], a[184:187], a[44:47], v[12:15]
v_xor_b32 v255, 0, v252
v_lshl_add_u32 v224, v255, 5, v254
v_mfma_f32_16x16x32_bf16 v[16:19], a[208:211], a[32:35], v[16:19]
v_add_u32 v228, 49152, v224
v_xor_b32 v255, 1, v252
v_mfma_f32_16x16x32_bf16 v[16:19], a[212:215], a[48:51], v[16:19]
v_lshl_add_u32 v225, v255, 5, v254
v_add_u32 v229, 49152, v225
v_mfma_f32_16x16x32_bf16 v[16:19], a[216:219], a[64:67], v[16:19]
v_xor_b32 v255, 2, v252
v_lshl_add_u32 v226, v255, 5, v254
v_mfma_f32_16x16x32_bf16 v[16:19], a[220:223], a[80:83], v[16:19]
v_add_u32 v230, 49152, v226
v_xor_b32 v255, 3, v252
v_mfma_f32_16x16x32_bf16 v[16:19], a[224:227], a[96:99], v[16:19]
v_lshl_add_u32 v227, v255, 5, v254
v_add_u32 v231, 49152, v227
v_mfma_f32_16x16x32_bf16 v[16:19], a[228:231], a[112:115], v[16:19]
v_mfma_f32_16x16x32_bf16 v[20:23], a[228:231], a[116:119], v[20:23]
v_mfma_f32_16x16x32_bf16 v[20:23], a[224:227], a[100:103], v[20:23]
v_mfma_f32_16x16x32_bf16 v[20:23], a[220:223], a[84:87], v[20:23]
v_mfma_f32_16x16x32_bf16 v[20:23], a[216:219], a[68:71], v[20:23]
v_cvt_pk_bf16_f32 v0, v0, v1
v_cvt_pk_bf16_f32 v1, v2, v3
v_mfma_f32_16x16x32_bf16 v[20:23], a[212:215], a[52:55], v[20:23]
s_nop 0
v_cvt_pk_bf16_f32 v2, v16, v17
v_cvt_pk_bf16_f32 v3, v18, v19
v_mfma_f32_16x16x32_bf16 v[20:23], a[208:211], a[36:39], v[20:23]
v_mfma_f32_16x16x32_bf16 v[24:27], a[208:211], a[40:43], v[24:27]
v_mfma_f32_16x16x32_bf16 v[24:27], a[212:215], a[56:59], v[24:27]
v_mfma_f32_16x16x32_bf16 v[24:27], a[216:219], a[72:75], v[24:27]
v_mfma_f32_16x16x32_bf16 v[24:27], a[220:223], a[88:91], v[24:27]
v_cvt_pk_bf16_f32 v4, v4, v5
v_cvt_pk_bf16_f32 v5, v6, v7
v_mfma_f32_16x16x32_bf16 v[24:27], a[224:227], a[104:107], v[24:27]
s_nop 0
v_cvt_pk_bf16_f32 v6, v20, v21
v_cvt_pk_bf16_f32 v7, v22, v23
v_mfma_f32_16x16x32_bf16 v[24:27], a[228:231], a[120:123], v[24:27]
v_mfma_f32_16x16x32_bf16 v[28:31], a[228:231], a[124:127], v[28:31]
v_mfma_f32_16x16x32_bf16 v[28:31], a[224:227], a[108:111], v[28:31]
v_mfma_f32_16x16x32_bf16 v[28:31], a[220:223], a[92:95], v[28:31]
v_mfma_f32_16x16x32_bf16 v[28:31], a[216:219], a[76:79], v[28:31]
v_cvt_pk_bf16_f32 v8, v8, v9
v_cvt_pk_bf16_f32 v9, v10, v11
v_mfma_f32_16x16x32_bf16 v[28:31], a[212:215], a[60:63], v[28:31]
s_nop 0
v_cvt_pk_bf16_f32 v10, v24, v25
v_cvt_pk_bf16_f32 v11, v26, v27
v_mfma_f32_16x16x32_bf16 v[28:31], a[208:211], a[44:47], v[28:31]
v_cvt_pk_bf16_f32 v12, v12, v13
v_cvt_pk_bf16_f32 v13, v14, v15
s_nop 5
v_cvt_pk_bf16_f32 v14, v28, v29
v_cvt_pk_bf16_f32 v15, v30, v31
s_waitcnt vmcnt(1) lgkmcnt(0)
s_barrier
s_cmp_eq_u32 s34, 48234496
s_cselect_b32 s45, 0, 67108864
s_add_u32 s45, s45, 49217536
buffer_store_dwordx2 v[238:239], v237, s[16:19], s45 offen sc1
s_mul_i32 s57, s38, 114688
s_add_u32 s57, s57, s80
ds_read_b128 a[192:195], v56 offset:0
ds_read_b128 a[196:199], v56 offset:1024
ds_read_b128 a[200:203], v56 offset:2048
ds_read_b128 a[204:207], v56 offset:3072
ds_read_b128 a[208:211], v57 offset:0
ds_read_b128 a[212:215], v57 offset:1024
s_waitcnt lgkmcnt(4)
v_mfma_f32_16x16x32_bf16 v[112:115], a[192:195], v[0:3], v[52:55]
v_mfma_f32_16x16x32_bf16 v[116:119], a[196:199], v[0:3], 0
v_mfma_f32_16x16x32_bf16 v[124:127], a[196:199], v[4:7], v[52:55]
s_waitcnt lgkmcnt(2)
v_mfma_f32_16x16x32_bf16 v[128:131], a[200:203], v[0:3], 0
s_add_u32 m0, s70, 0
ds_read_b128 a[192:195], v56 offset:4096
ds_read_b128 a[196:199], v56 offset:5120
ds_read_b128 a[216:219], v57 offset:2048
ds_read_b128 a[220:223], v57 offset:3072
v_exp_f32 v112, v112
v_exp_f32 v113, v113
v_exp_f32 v114, v114
v_cvt_pk_bf16_f32 v144, v112, v113
v_exp_f32 v115, v115
v_mfma_f32_16x16x32_bf16 v[132:135], a[204:207], v[0:3], 0
s_bfe_u32 s71, s78, 0x40000
v_exp_f32 v116, v116
v_cvt_pk_bf16_f32 v145, v114, v115
v_exp_f32 v117, v117
v_exp_f32 v118, v118
v_mfma_f32_16x16x32_bf16 v[136:139], a[200:203], v[4:7], 0
buffer_store_dwordx4 v[160:163], v233, s[16:19], s64 offen offset:0 sc1
s_mul_i32 s71, s71, 458752
v_cvt_pk_bf16_f32 v146, v116, v117
v_exp_f32 v119, v119
v_mov_b32 v148, 0
v_cvt_pk_bf16_f32 v147, v118, v119
v_mov_b32 v149, 0
v_exp_f32 v124, v124
v_mfma_f32_16x16x32_bf16 v[140:143], a[204:207], v[4:7], 0
s_add_u32 s71, s71, s79
v_exp_f32 v125, v125
v_exp_f32 v126, v126
v_cvt_pk_bf16_f32 v150, v124, v125
v_exp_f32 v127, v127
v_mfma_f32_16x16x32_bf16 v[112:115], a[200:203], v[8:11], v[52:55]
v_cvt_pk_bf16_f32 v151, v126, v127
v_exp_f32 v128, v128
v_exp_f32 v129, v129
v_mfma_f32_16x16x32_bf16 v[116:119], a[204:207], v[8:11], 0
v_exp_f32 v130, v130
v_cvt_pk_bf16_f32 v152, v128, v129
v_exp_f32 v131, v131
v_mfma_f32_16x16x32_bf16 v[124:127], a[204:207], v[12:15], v[52:55]
s_waitcnt lgkmcnt(4)
buffer_load_dwordx4 v240, s[20:23], s71 offen lds
v_exp_f32 v132, v132
v_cvt_pk_bf16_f32 v153, v130, v131
v_exp_f32 v133, v133
v_mfma_f32_16x16x32_bf16 v[64:67], a[208:211], v[144:147], 0
v_exp_f32 v134, v134
v_cvt_pk_bf16_f32 v154, v132, v133
v_mfma_f32_16x16x32_bf16 v[68:71], a[212:215], v[144:147], 0
v_exp_f32 v135, v135
v_exp_f32 v136, v136
v_cvt_pk_bf16_f32 v155, v134, v135
v_mfma_f32_16x16x32_bf16 v[96:99], a[232:235], v[144:147], 0
buffer_load_dwordx4 v241, s[20:23], s71 offen offset:1024 lds
v_exp_f32 v137, v137
v_exp_f32 v138, v138
v_mfma_f32_16x16x32_bf16 v[72:75], a[208:211], v[148:151], 0
s_add_u32 m0, s70, 8192
v_cvt_pk_bf16_f32 v156, v136, v137
v_exp_f32 v139, v139
v_exp_f32 v140, v140
v_mfma_f32_16x16x32_bf16 v[76:79], a[212:215], v[148:151], 0
s_add_u32 s71, s71, 65536
v_cvt_pk_bf16_f32 v157, v138, v139
v_exp_f32 v141, v141
v_exp_f32 v142, v142
v_mfma_f32_16x16x32_bf16 v[100:103], a[232:235], v[148:151], 0
buffer_load_dwordx4 v240, s[20:23], s71 offen lds
v_cvt_pk_bf16_f32 v158, v140, v141
v_exp_f32 v143, v143
s_waitcnt lgkmcnt(2)
v_mfma_f32_16x16x32_bf16 v[128:131], a[192:195], v[0:3], 0
ds_read_b128 a[200:203], v56 offset:6144
ds_read_b128 a[204:207], v56 offset:7168
ds_read_b128 a[224:227], v57 offset:4096
ds_read_b128 a[228:231], v57 offset:5120
v_cvt_pk_bf16_f32 v159, v142, v143
v_exp_f32 v112, v112
v_exp_f32 v113, v113
v_mfma_f32_16x16x32_bf16 v[132:135], a[196:199], v[0:3], 0
v_exp_f32 v114, v114
v_mfma_f32_16x16x32_bf16 v[136:139], a[192:195], v[4:7], 0
buffer_store_dwordx4 v[164:167], v233, s[16:19], s64 offen offset:1024 sc1
buffer_load_dwordx4 v241, s[20:23], s71 offen offset:1024 lds
v_cvt_pk_bf16_f32 v144, v112, v113
v_exp_f32 v115, v115
v_mfma_f32_16x16x32_bf16 v[140:143], a[196:199], v[4:7], 0
s_waitcnt lgkmcnt(4)
s_add_u32 m0, s70, 16384
v_exp_f32 v116, v116
v_cvt_pk_bf16_f32 v145, v114, v115
v_mfma_f32_16x16x32_bf16 v[64:67], a[216:219], v[152:155], v[64:67]
s_add_u32 s71, s71, 196608
v_exp_f32 v117, v117
v_exp_f32 v118, v118
v_mfma_f32_16x16x32_bf16 v[68:71], a[220:223], v[152:155], v[68:71]
buffer_load_dwordx4 v240, s[20:23], s71 offen lds
v_cvt_pk_bf16_f32 v146, v116, v117
v_exp_f32 v119, v119
v_mfma_f32_16x16x32_bf16 v[96:99], a[232:235], v[152:155], v[96:99]
v_mov_b32 v148, 0
v_cvt_pk_bf16_f32 v147, v118, v119
v_mov_b32 v149, 0
v_mfma_f32_16x16x32_bf16 v[72:75], a[216:219], v[156:159], v[72:75]
v_exp_f32 v124, v124
v_exp_f32 v125, v125
v_mfma_f32_16x16x32_bf16 v[76:79], a[220:223], v[156:159], v[76:79]
buffer_load_dwordx4 v241, s[20:23], s71 offen offset:1024 lds
v_exp_f32 v126, v126
v_mfma_f32_16x16x32_bf16 v[100:103], a[232:235], v[156:159], v[100:103]
s_add_u32 m0, s70, 24576
v_cvt_pk_bf16_f32 v150, v124, v125
v_exp_f32 v127, v127
v_mfma_f32_16x16x32_bf16 v[112:115], a[192:195], v[8:11], 0
s_add_u32 s71, s71, 65536
v_cvt_pk_bf16_f32 v151, v126, v127
v_exp_f32 v128, v128
v_exp_f32 v129, v129
v_mfma_f32_16x16x32_bf16 v[116:119], a[196:199], v[8:11], 0
v_exp_f32 v130, v130
v_cvt_pk_bf16_f32 v152, v128, v129
v_mfma_f32_16x16x32_bf16 v[120:123], a[192:195], v[12:15], 0
buffer_load_dwordx4 v240, s[20:23], s71 offen lds
v_exp_f32 v131, v131
v_exp_f32 v132, v132
v_mfma_f32_16x16x32_bf16 v[124:127], a[196:199], v[12:15], 0
v_cvt_pk_bf16_f32 v153, v130, v131
v_exp_f32 v133, v133
v_exp_f32 v134, v134
v_mfma_f32_16x16x32_bf16 v[80:83], a[216:219], v[144:147], 0
v_cvt_pk_bf16_f32 v154, v132, v133
v_exp_f32 v135, v135
v_mfma_f32_16x16x32_bf16 v[84:87], a[220:223], v[144:147], 0
buffer_load_dwordx4 v241, s[20:23], s71 offen offset:1024 lds
v_exp_f32 v136, v136
v_cvt_pk_bf16_f32 v155, v134, v135
v_exp_f32 v137, v137
v_mfma_f32_16x16x32_bf16 v[104:107], a[232:235], v[144:147], 0
s_add_u32 m0, s70, 32768
v_exp_f32 v138, v138
v_cvt_pk_bf16_f32 v156, v136, v137
v_mfma_f32_16x16x32_bf16 v[88:91], a[216:219], v[148:151], 0
s_bfe_u32 s71, s78, 0x40004
v_exp_f32 v139, v139
v_exp_f32 v140, v140
v_mfma_f32_16x16x32_bf16 v[92:95], a[220:223], v[148:151], 0
s_mul_i32 s71, s71, 458752
v_cvt_pk_bf16_f32 v157, v138, v139
v_exp_f32 v141, v141
v_exp_f32 v142, v142
v_mfma_f32_16x16x32_bf16 v[108:111], a[232:235], v[148:151], 0
s_add_u32 s71, s71, s79
v_cvt_pk_bf16_f32 v158, v140, v141
v_exp_f32 v143, v143
s_waitcnt lgkmcnt(2)
v_mfma_f32_16x16x32_bf16 v[128:131], a[200:203], v[0:3], 0
ds_read_b128 a[192:195], v56 offset:8192
ds_read_b128 a[196:199], v56 offset:9216
ds_read_b128 a[208:211], v57 offset:6144
ds_read_b128 a[212:215], v57 offset:7168
v_cvt_pk_bf16_f32 v159, v142, v143
v_exp_f32 v112, v112
v_exp_f32 v113, v113
v_mfma_f32_16x16x32_bf16 v[132:135], a[204:207], v[0:3], 0
v_exp_f32 v114, v114
v_cvt_pk_bf16_f32 v144, v112, v113
v_mfma_f32_16x16x32_bf16 v[136:139], a[200:203], v[4:7], 0
buffer_store_dwordx4 v[168:171], v233, s[16:19], s64 offen offset:2048 sc1
buffer_load_dwordx4 v240, s[20:23], s71 offen lds
v_exp_f32 v115, v115
v_exp_f32 v116, v116
v_mfma_f32_16x16x32_bf16 v[140:143], a[204:207], v[4:7], 0
s_waitcnt lgkmcnt(4)
v_cvt_pk_bf16_f32 v145, v114, v115
v_exp_f32 v117, v117
v_exp_f32 v118, v118
s_cmp_eq_u32 s35, 2
s_cbranch_scc1 Lrs7o
Lrs7:
v_mfma_f32_16x16x32_bf16 v[64:67], a[224:227], v[152:155], v[64:67]
v_cvt_pk_bf16_f32 v146, v116, v117
v_exp_f32 v119, v119
v_mfma_f32_16x16x32_bf16 v[68:71], a[228:231], v[152:155], v[68:71]
buffer_load_dwordx4 v241, s[20:23], s71 offen offset:1024 lds
v_exp_f32 v120, v120
v_cvt_pk_bf16_f32 v147, v118, v119
v_exp_f32 v121, v121
v_mfma_f32_16x16x32_bf16 v[96:99], a[232:235], v[152:155], v[96:99]
s_add_u32 m0, s70, 40960
v_exp_f32 v122, v122
v_cvt_pk_bf16_f32 v148, v120, v121
v_mfma_f32_16x16x32_bf16 v[72:75], a[224:227], v[156:159], v[72:75]
s_add_u32 s71, s71, 65536
v_exp_f32 v123, v123
v_exp_f32 v124, v124
v_mfma_f32_16x16x32_bf16 v[76:79], a[228:231], v[156:159], v[76:79]
buffer_load_dwordx4 v240, s[20:23], s71 offen lds
v_cvt_pk_bf16_f32 v149, v122, v123
v_exp_f32 v125, v125
v_exp_f32 v126, v126
v_mfma_f32_16x16x32_bf16 v[100:103], a[232:235], v[156:159], v[100:103]
v_cvt_pk_bf16_f32 v150, v124, v125
v_exp_f32 v127, v127
v_mfma_f32_16x16x32_bf16 v[112:115], a[200:203], v[8:11], 0
v_cvt_pk_bf16_f32 v151, v126, v127
v_exp_f32 v128, v128
v_exp_f32 v129, v129
v_mfma_f32_16x16x32_bf16 v[116:119], a[204:207], v[8:11], 0
s_add_u32 s51, s73, 262144
s_mov_b64 exec, 0xff
buffer_load_dwordx2 v[246:247], v235, s[16:19], s51 offen sc1
s_mov_b64 exec, -1
v_exp_f32 v130, v130
v_cvt_pk_bf16_f32 v152, v128, v129
v_mfma_f32_16x16x32_bf16 v[120:123], a[200:203], v[12:15], 0
buffer_load_dwordx4 v241, s[20:23], s71 offen offset:1024 lds
v_exp_f32 v131, v131
v_exp_f32 v132, v132
v_mfma_f32_16x16x32_bf16 v[124:127], a[204:207], v[12:15], 0
s_add_u32 m0, s70, 49152
v_cvt_pk_bf16_f32 v153, v130, v131
v_exp_f32 v133, v133
v_exp_f32 v134, v134
v_mfma_f32_16x16x32_bf16 v[80:83], a[224:227], v[144:147], v[80:83]
s_add_u32 s71, s71, 196608
v_cvt_pk_bf16_f32 v154, v132, v133
v_exp_f32 v135, v135
v_mfma_f32_16x16x32_bf16 v[84:87], a[228:231], v[144:147], v[84:87]
buffer_load_dwordx4 v240, s[20:23], s71 offen lds
v_exp_f32 v136, v136
v_cvt_pk_bf16_f32 v155, v134, v135
v_exp_f32 v137, v137
v_mfma_f32_16x16x32_bf16 v[104:107], a[232:235], v[144:147], v[104:107]
v_exp_f32 v138, v138
v_cvt_pk_bf16_f32 v156, v136, v137
v_mfma_f32_16x16x32_bf16 v[88:91], a[224:227], v[148:151], v[88:91]
v_exp_f32 v139, v139
v_exp_f32 v140, v140
v_mfma_f32_16x16x32_bf16 v[92:95], a[228:231], v[148:151], v[92:95]
buffer_load_dwordx4 v241, s[20:23], s71 offen offset:1024 lds
v_cvt_pk_bf16_f32 v157, v138, v139
v_exp_f32 v141, v141
v_exp_f32 v142, v142
v_mfma_f32_16x16x32_bf16 v[108:111], a[232:235], v[148:151], v[108:111]
s_add_u32 m0, s70, 57344
v_cvt_pk_bf16_f32 v158, v140, v141
v_exp_f32 v143, v143
s_waitcnt lgkmcnt(2)
v_mfma_f32_16x16x32_bf16 v[128:131], a[192:195], v[0:3], 0
s_add_u32 s71, s71, 65536
ds_read_b128 a[200:203], v56 offset:10240
ds_read_b128 a[204:207], v56 offset:11264
ds_read_b128 a[216:219], v57 offset:8192
ds_read_b128 a[220:223], v57 offset:9216
v_cvt_pk_bf16_f32 v159, v142, v143
v_exp_f32 v112, v112
v_exp_f32 v113, v113
v_mfma_f32_16x16x32_bf16 v[132:135], a[196:199], v[0:3], 0
v_exp_f32 v114, v114
v_cvt_pk_bf16_f32 v144, v112, v113
v_mfma_f32_16x16x32_bf16 v[136:139], a[192:195], v[4:7], 0
buffer_store_dwordx4 v[172:175], v233, s[16:19], s64 offen offset:3072 sc1
buffer_load_dwordx4 v240, s[20:23], s71 offen lds
v_exp_f32 v115, v115
v_exp_f32 v116, v116
v_mfma_f32_16x16x32_bf16 v[140:143], a[196:199], v[4:7], 0
s_waitcnt lgkmcnt(4)
v_cvt_pk_bf16_f32 v145, v114, v115
v_exp_f32 v117, v117
v_exp_f32 v118, v118
v_mfma_f32_16x16x32_bf16 v[64:67], a[208:211], v[152:155], v[64:67]
v_cvt_pk_bf16_f32 v146, v116, v117
v_exp_f32 v119, v119
v_mfma_f32_16x16x32_bf16 v[68:71], a[212:215], v[152:155], v[68:71]
buffer_load_dwordx4 v241, s[20:23], s71 offen offset:1024 lds
v_exp_f32 v120, v120
v_cvt_pk_bf16_f32 v147, v118, v119
v_exp_f32 v121, v121
v_mfma_f32_16x16x32_bf16 v[96:99], a[232:235], v[152:155], v[96:99]
v_exp_f32 v122, v122
v_cvt_pk_bf16_f32 v148, v120, v121
v_mfma_f32_16x16x32_bf16 v[72:75], a[208:211], v[156:159], v[72:75]
v_exp_f32 v123, v123
v_exp_f32 v124, v124
v_mfma_f32_16x16x32_bf16 v[76:79], a[212:215], v[156:159], v[76:79]
v_cvt_pk_bf16_f32 v149, v122, v123
v_exp_f32 v125, v125
v_exp_f32 v126, v126
v_mfma_f32_16x16x32_bf16 v[100:103], a[232:235], v[156:159], v[100:103]
v_cvt_pk_bf16_f32 v150, v124, v125
v_exp_f32 v127, v127
v_mfma_f32_16x16x32_bf16 v[112:115], a[192:195], v[8:11], 0
Lpad7:
s_cbranch_execz Lpad11
v_cvt_pk_bf16_f32 v151, v126, v127
v_exp_f32 v128, v128
v_exp_f32 v129, v129
v_mfma_f32_16x16x32_bf16 v[116:119], a[196:199], v[8:11], 0
v_exp_f32 v130, v130
v_cvt_pk_bf16_f32 v152, v128, v129
v_mfma_f32_16x16x32_bf16 v[120:123], a[192:195], v[12:15], 0
v_exp_f32 v131, v131
v_exp_f32 v132, v132
v_mfma_f32_16x16x32_bf16 v[124:127], a[196:199], v[12:15], 0
v_cvt_pk_bf16_f32 v153, v130, v131
v_exp_f32 v133, v133
v_exp_f32 v134, v134
v_mfma_f32_16x16x32_bf16 v[80:83], a[208:211], v[144:147], v[80:83]
v_cvt_pk_bf16_f32 v154, v132, v133
v_exp_f32 v135, v135
v_mfma_f32_16x16x32_bf16 v[84:87], a[212:215], v[144:147], v[84:87]
v_exp_f32 v136, v136
v_cvt_pk_bf16_f32 v155, v134, v135
v_exp_f32 v137, v137
v_mfma_f32_16x16x32_bf16 v[104:107], a[232:235], v[144:147], v[104:107]
v_exp_f32 v138, v138
v_cvt_pk_bf16_f32 v156, v136, v137
v_mfma_f32_16x16x32_bf16 v[88:91], a[208:211], v[148:151], v[88:91]
v_exp_f32 v139, v139
v_exp_f32 v140, v140
v_mfma_f32_16x16x32_bf16 v[92:95], a[212:215], v[148:151], v[92:95]
v_cvt_pk_bf16_f32 v157, v138, v139
v_exp_f32 v141, v141
v_exp_f32 v142, v142
v_mfma_f32_16x16x32_bf16 v[108:111], a[232:235], v[148:151], v[108:111]
v_cvt_pk_bf16_f32 v158, v140, v141
v_exp_f32 v143, v143
s_waitcnt lgkmcnt(2)
v_mfma_f32_16x16x32_bf16 v[128:131], a[200:203], v[0:3], 0
ds_read_b128 a[192:195], v56 offset:12288
ds_read_b128 a[196:199], v56 offset:13312
ds_read_b128 a[224:227], v57 offset:10240
ds_read_b128 a[228:231], v57 offset:11264
v_cvt_pk_bf16_f32 v159, v142, v143
v_exp_f32 v112, v112
v_exp_f32 v113, v113
v_mfma_f32_16x16x32_bf16 v[132:135], a[204:207], v[0:3], 0
s_waitcnt vmcnt(6)
v_cmp_ne_u64 vcc, s[36:37], v[246:247]
s_mov_b32 s49, 262144
s_cbranch_vccnz Lsp9
Lok8:
s_bfe_u32 s72, s78, 0x40000
v_exp_f32 v114, v114
v_cvt_pk_bf16_f32 v144, v112, v113
v_mfma_f32_16x16x32_bf16 v[136:139], a[200:203], v[4:7], 0
buffer_store_dwordx4 v[192:195], v250, s[16:19], s65 offen offset:0 sc1
s_mul_i32 s72, s72, 28672
v_exp_f32 v115, v115
v_exp_f32 v116, v116
v_mfma_f32_16x16x32_bf16 v[140:143], a[204:207], v[4:7], 0
s_waitcnt lgkmcnt(4)
s_add_u32 s72, s72, s57
v_cvt_pk_bf16_f32 v145, v114, v115
v_exp_f32 v117, v117
v_exp_f32 v118, v118
s_cmp_eq_u32 s35, 4
s_cbranch_scc1 Lrs10o
Lrs10:
v_mfma_f32_16x16x32_bf16 v[64:67], a[216:219], v[152:155], v[64:67]
v_cvt_pk_bf16_f32 v146, v116, v117
v_exp_f32 v119, v119
v_mfma_f32_16x16x32_bf16 v[68:71], a[220:223], v[152:155], v[68:71]
buffer_load_dwordx4 a[0:3], v233, s[16:19], s72 offen offset:0 sc1
v_exp_f32 v120, v120
v_cvt_pk_bf16_f32 v147, v118, v119
v_exp_f32 v121, v121
v_mfma_f32_16x16x32_bf16 v[96:99], a[232:235], v[152:155], v[96:99]
v_exp_f32 v122, v122
v_cvt_pk_bf16_f32 v148, v120, v121
v_mfma_f32_16x16x32_bf16 v[72:75], a[216:219], v[156:159], v[72:75]
v_exp_f32 v123, v123
v_exp_f32 v124, v124
v_mfma_f32_16x16x32_bf16 v[76:79], a[220:223], v[156:159], v[76:79]
buffer_load_dwordx4 a[4:7], v233, s[16:19], s72 offen offset:1024 sc1
v_cvt_pk_bf16_f32 v149, v122, v123
v_exp_f32 v125, v125
v_exp_f32 v126, v126
v_mfma_f32_16x16x32_bf16 v[100:103], a[232:235], v[156:159], v[100:103]
s_xor_b32 s41, s72, 2048
v_cvt_pk_bf16_f32 v150, v124, v125
v_exp_f32 v127, v127
v_mfma_f32_16x16x32_bf16 v[112:115], a[200:203], v[8:11], 0
v_cvt_pk_bf16_f32 v151, v126, v127
v_exp_f32 v128, v128
v_exp_f32 v129, v129
v_mfma_f32_16x16x32_bf16 v[116:119], a[204:207], v[8:11], 0
v_exp_f32 v130, v130
v_cvt_pk_bf16_f32 v152, v128, v129
v_mfma_f32_16x16x32_bf16 v[120:123], a[200:203], v[12:15], 0
buffer_load_dwordx4 a[8:11], v233, s[16:19], s41 offen offset:0 sc1
v_exp_f32 v131, v131
v_exp_f32 v132, v132
v_mfma_f32_16x16x32_bf16 v[124:127], a[204:207], v[12:15], 0
v_cvt_pk_bf16_f32 v153, v130, v131
v_exp_f32 v133, v133
v_exp_f32 v134, v134
v_mfma_f32_16x16x32_bf16 v[80:83], a[216:219], v[144:147], v[80:83]
v_cvt_pk_bf16_f32 v154, v132, v133
v_exp_f32 v135, v135
v_mfma_f32_16x16x32_bf16 v[84:87], a[220:223], v[144:147], v[84:87]
buffer_load_dwordx4 a[12:15], v233, s[16:19], s41 offen offset:1024 sc1
v_exp_f32 v136, v136
v_cvt_pk_bf16_f32 v155, v134, v135
v_exp_f32 v137, v137
v_mfma_f32_16x16x32_bf16 v[104:107], a[232:235], v[144:147], v[104:107]
s_add_u32 s72, s72, 4096
v_exp_f32 v138, v138
v_cvt_pk_bf16_f32 v156, v136, v137
v_mfma_f32_16x16x32_bf16 v[88:91], a[216:219], v[148:151], v[88:91]
v_exp_f32 v139, v139
v_exp_f32 v140, v140
v_mfma_f32_16x16x32_bf16 v[92:95], a[220:223], v[148:151], v[92:95]
buffer_load_dwordx4 a[16:19], v233, s[16:19], s72 offen offset:0 sc1
v_cvt_pk_bf16_f32 v157, v138, v139
v_exp_f32 v141, v141
v_exp_f32 v142, v142
v_mfma_f32_16x16x32_bf16 v[108:111], a[232:235], v[148:151], v[108:111]
v_cvt_pk_bf16_f32 v158, v140, v141
v_exp_f32 v143, v143
s_waitcnt lgkmcnt(2)
v_mfma_f32_16x16x32_bf16 v[128:131], a[192:195], v[0:3], 0
ds_read_b128 a[200:203], v56 offset:14336
ds_read_b128 a[204:207], v56 offset:15360
ds_read_b128 a[208:211], v57 offset:12288
ds_read_b128 a[212:215], v57 offset:13312
v_cvt_pk_bf16_f32 v159, v142, v143
v_exp_f32 v112, v112
v_exp_f32 v113, v113
v_mfma_f32_16x16x32_bf16 v[132:135], a[196:199], v[0:3], 0
v_exp_f32 v114, v114
v_cvt_pk_bf16_f32 v144, v112, v113
v_mfma_f32_16x16x32_bf16 v[136:139], a[192:195], v[4:7], 0
buffer_store_dwordx4 v[200:203], v250, s[16:19], s65 offen offset:2048 sc1
buffer_load_dwordx4 a[20:23], v233, s[16:19], s72 offen offset:1024 sc1
v_exp_f32 v115, v115
v_exp_f32 v116, v116
v_mfma_f32_16x16x32_bf16 v[140:143], a[196:199], v[4:7], 0
s_waitcnt lgkmcnt(4)
s_xor_b32 s41, s72, 2048
v_cvt_pk_bf16_f32 v145, v114, v115
v_exp_f32 v117, v117
v_exp_f32 v118, v118
v_mfma_f32_16x16x32_bf16 v[64:67], a[224:227], v[152:155], v[64:67]
v_cvt_pk_bf16_f32 v146, v116, v117
v_exp_f32 v119, v119
v_mfma_f32_16x16x32_bf16 v[68:71], a[228:231], v[152:155], v[68:71]
buffer_load_dwordx4 a[24:27], v233, s[16:19], s41 offen offset:0 sc1
v_exp_f32 v120, v120
v_cvt_pk_bf16_f32 v147, v118, v119
v_exp_f32 v121, v121
v_mfma_f32_16x16x32_bf16 v[96:99], a[232:235], v[152:155], v[96:99]
v_exp_f32 v122, v122
v_cvt_pk_bf16_f32 v148, v120, v121
v_mfma_f32_16x16x32_bf16 v[72:75], a[224:227], v[156:159], v[72:75]
v_exp_f32 v123, v123
v_exp_f32 v124, v124
v_mfma_f32_16x16x32_bf16 v[76:79], a[228:231], v[156:159], v[76:79]
buffer_load_dwordx4 a[28:31], v233, s[16:19], s41 offen offset:1024 sc1
v_cvt_pk_bf16_f32 v149, v122, v123
v_exp_f32 v125, v125
v_exp_f32 v126, v126
v_mfma_f32_16x16x32_bf16 v[100:103], a[232:235], v[156:159], v[100:103]
s_add_u32 s72, s72, 12288
v_cvt_pk_bf16_f32 v150, v124, v125
v_exp_f32 v127, v127
v_mfma_f32_16x16x32_bf16 v[112:115], a[192:195], v[8:11], 0
v_cvt_pk_bf16_f32 v151, v126, v127
v_exp_f32 v128, v128
v_exp_f32 v129, v129
v_mfma_f32_16x16x32_bf16 v[116:119], a[196:199], v[8:11], 0
v_exp_f32 v130, v130
v_cvt_pk_bf16_f32 v152, v128, v129
v_mfma_f32_16x16x32_bf16 v[120:123], a[192:195], v[12:15], 0
buffer_load_dwordx4 a[32:35], v233, s[16:19], s72 offen offset:0 sc1
v_exp_f32 v131, v131
v_exp_f32 v132, v132
v_mfma_f32_16x16x32_bf16 v[124:127], a[196:199], v[12:15], 0
v_cvt_pk_bf16_f32 v153, v130, v131
v_exp_f32 v133, v133
v_exp_f32 v134, v134
v_mfma_f32_16x16x32_bf16 v[80:83], a[224:227], v[144:147], v[80:83]
v_cvt_pk_bf16_f32 v154, v132, v133
v_exp_f32 v135, v135
v_mfma_f32_16x16x32_bf16 v[84:87], a[228:231], v[144:147], v[84:87]
buffer_load_dwordx4 a[36:39], v233, s[16:19], s72 offen offset:1024 sc1
v_exp_f32 v136, v136
v_cvt_pk_bf16_f32 v155, v134, v135
v_exp_f32 v137, v137
v_mfma_f32_16x16x32_bf16 v[104:107], a[232:235], v[144:147], v[104:107]
s_xor_b32 s41, s72, 2048
v_exp_f32 v138, v138
v_cvt_pk_bf16_f32 v156, v136, v137
v_mfma_f32_16x16x32_bf16 v[88:91], a[224:227], v[148:151], v[88:91]
v_exp_f32 v139, v139
v_exp_f32 v140, v140
v_mfma_f32_16x16x32_bf16 v[92:95], a[228:231], v[148:151], v[92:95]
buffer_load_dwordx4 a[40:43], v233, s[16:19], s41 offen offset:0 sc1
v_cvt_pk_bf16_f32 v157, v138, v139
v_exp_f32 v141, v141
v_exp_f32 v142, v142
v_mfma_f32_16x16x32_bf16 v[108:111], a[232:235], v[148:151], v[108:111]
v_cvt_pk_bf16_f32 v158, v140, v141
v_exp_f32 v143, v143
s_waitcnt lgkmcnt(2)
v_mfma_f32_16x16x32_bf16 v[128:131], a[200:203], v[0:3], 0
ds_read_b128 a[192:195], v56 offset:16384
ds_read_b128 a[196:199], v56 offset:17408
ds_read_b128 a[216:219], v57 offset:14336
ds_read_b128 a[220:223], v57 offset:15360
v_cvt_pk_bf16_f32 v159, v142, v143
v_exp_f32 v112, v112
v_exp_f32 v113, v113
v_mfma_f32_16x16x32_bf16 v[132:135], a[204:207], v[0:3], 0
v_exp_f32 v114, v114
v_cvt_pk_bf16_f32 v144, v112, v113
v_mfma_f32_16x16x32_bf16 v[136:139], a[200:203], v[4:7], 0
buffer_load_dwordx4 a[44:47], v233, s[16:19], s41 offen offset:1024 sc1
v_exp_f32 v115, v115
v_exp_f32 v116, v116
v_mfma_f32_16x16x32_bf16 v[140:143], a[204:207], v[4:7], 0
s_waitcnt lgkmcnt(4)
s_add_u32 s72, s72, 4096
v_cvt_pk_bf16_f32 v145, v114, v115
v_exp_f32 v117, v117
v_exp_f32 v118, v118
s_cmp_eq_u32 s35, 6
s_cbranch_scc1 Lrs11o
Lrs11:
v_mfma_f32_16x16x32_bf16 v[64:67], a[208:211], v[152:155], v[64:67]
v_cvt_pk_bf16_f32 v146, v116, v117
v_exp_f32 v119, v119
v_mfma_f32_16x16x32_bf16 v[68:71], a[212:215], v[152:155], v[68:71]
buffer_load_dwordx4 a[48:51], v233, s[16:19], s72 offen offset:0 sc1
v_exp_f32 v120, v120
v_cvt_pk_bf16_f32 v147, v118, v119
v_exp_f32 v121, v121
v_mfma_f32_16x16x32_bf16 v[96:99], a[232:235], v[152:155], v[96:99]
v_exp_f32 v122, v122
v_cvt_pk_bf16_f32 v148, v120, v121
v_mfma_f32_16x16x32_bf16 v[72:75], a[208:211], v[156:159], v[72:75]
v_exp_f32 v123, v123
v_exp_f32 v124, v124
v_mfma_f32_16x16x32_bf16 v[76:79], a[212:215], v[156:159], v[76:79]
buffer_load_dwordx4 a[52:55], v233, s[16:19], s72 offen offset:1024 sc1
v_cvt_pk_bf16_f32 v149, v122, v123
v_exp_f32 v125, v125
v_exp_f32 v126, v126
v_mfma_f32_16x16x32_bf16 v[100:103], a[232:235], v[156:159], v[100:103]
s_xor_b32 s41, s72, 2048
v_cvt_pk_bf16_f32 v150, v124, v125
v_exp_f32 v127, v127
v_mfma_f32_16x16x32_bf16 v[112:115], a[200:203], v[8:11], 0
v_cvt_pk_bf16_f32 v151, v126, v127
v_exp_f32 v128, v128
v_exp_f32 v129, v129
v_mfma_f32_16x16x32_bf16 v[116:119], a[204:207], v[8:11], 0
v_exp_f32 v130, v130
v_cvt_pk_bf16_f32 v152, v128, v129
v_mfma_f32_16x16x32_bf16 v[120:123], a[200:203], v[12:15], 0
buffer_load_dwordx4 a[56:59], v233, s[16:19], s41 offen offset:0 sc1
v_exp_f32 v131, v131
v_exp_f32 v132, v132
v_mfma_f32_16x16x32_bf16 v[124:127], a[204:207], v[12:15], 0
v_cvt_pk_bf16_f32 v153, v130, v131
v_exp_f32 v133, v133
v_exp_f32 v134, v134
v_mfma_f32_16x16x32_bf16 v[80:83], a[208:211], v[144:147], v[80:83]
v_cvt_pk_bf16_f32 v154, v132, v133
v_exp_f32 v135, v135
v_mfma_f32_16x16x32_bf16 v[84:87], a[212:215], v[144:147], v[84:87]
buffer_load_dwordx4 a[60:63], v233, s[16:19], s41 offen offset:1024 sc1
v_exp_f32 v136, v136
v_cvt_pk_bf16_f32 v155, v134, v135
v_exp_f32 v137, v137
v_mfma_f32_16x16x32_bf16 v[104:107], a[232:235], v[144:147], v[104:107]
s_bfe_u32 s72, s78, 0x40004
v_exp_f32 v138, v138
v_cvt_pk_bf16_f32 v156, v136, v137
v_mfma_f32_16x16x32_bf16 v[88:91], a[208:211], v[148:151], v[88:91]
s_mul_i32 s72, s72, 28672
v_exp_f32 v139, v139
v_exp_f32 v140, v140
v_mfma_f32_16x16x32_bf16 v[92:95], a[212:215], v[148:151], v[92:95]
s_add_u32 s72, s72, s57
v_cvt_pk_bf16_f32 v157, v138, v139
v_exp_f32 v141, v141
v_exp_f32 v142, v142
v_mfma_f32_16x16x32_bf16 v[108:111], a[232:235], v[148:151], v[108:111]
v_cvt_pk_bf16_f32 v158, v140, v141
v_exp_f32 v143, v143
s_waitcnt lgkmcnt(2)
v_mfma_f32_16x16x32_bf16 v[128:131], a[192:195], v[0:3], v[48:51]
ds_read_b128 a[200:203], v56 offset:18432
ds_read_b128 a[204:207], v56 offset:19456
ds_read_b128 a[224:227], v57 offset:16384
ds_read_b128 a[228:231], v57 offset:17408
v_cvt_pk_bf16_f32 v159, v142, v143
v_exp_f32 v112, v112
v_exp_f32 v113, v113
v_mfma_f32_16x16x32_bf16 v[136:139], a[192:195], v[4:7], 0
v_exp_f32 v114, v114
v_cvt_pk_bf16_f32 v144, v112, v113
v_exp_f32 v115, v115
v_mfma_f32_16x16x32_bf16 v[140:143], a[196:199], v[4:7], v[48:51]
s_waitcnt lgkmcnt(4)
buffer_load_dwordx4 a[64:67], v233, s[16:19], s72 offen offset:0 sc1
v_exp_f32 v116, v116
v_cvt_pk_bf16_f32 v145, v114, v115
v_exp_f32 v117, v117
v_mfma_f32_16x16x32_bf16 v[64:67], a[216:219], v[152:155], v[64:67]
v_exp_f32 v118, v118
v_cvt_pk_bf16_f32 v146, v116, v117
v_mfma_f32_16x16x32_bf16 v[68:71], a[220:223], v[152:155], v[68:71]
v_exp_f32 v119, v119
v_exp_f32 v120, v120
v_cvt_pk_bf16_f32 v147, v118, v119
v_mfma_f32_16x16x32_bf16 v[96:99], a[232:235], v[152:155], v[96:99]
buffer_load_dwordx4 a[68:71], v233, s[16:19], s72 offen offset:1024 sc1
v_exp_f32 v121, v121
v_exp_f32 v122, v122
v_mfma_f32_16x16x32_bf16 v[72:75], a[216:219], v[156:159], v[72:75]
s_xor_b32 s41, s72, 2048
v_cvt_pk_bf16_f32 v148, v120, v121
v_exp_f32 v123, v123
v_exp_f32 v124, v124
v_mfma_f32_16x16x32_bf16 v[76:79], a[220:223], v[156:159], v[76:79]
v_cvt_pk_bf16_f32 v149, v122, v123
v_exp_f32 v125, v125
v_exp_f32 v126, v126
v_mfma_f32_16x16x32_bf16 v[100:103], a[232:235], v[156:159], v[100:103]
buffer_load_dwordx4 a[72:75], v233, s[16:19], s41 offen offset:0 sc1
v_cvt_pk_bf16_f32 v150, v124, v125
v_exp_f32 v127, v127
v_mfma_f32_16x16x32_bf16 v[112:115], a[192:195], v[8:11], 0
v_cvt_pk_bf16_f32 v151, v126, v127
v_exp_f32 v128, v128
v_exp_f32 v129, v129
v_mfma_f32_16x16x32_bf16 v[116:119], a[196:199], v[8:11], 0
v_exp_f32 v130, v130
v_mfma_f32_16x16x32_bf16 v[120:123], a[192:195], v[12:15], 0
buffer_load_dwordx4 a[76:79], v233, s[16:19], s41 offen offset:1024 sc1
v_cvt_pk_bf16_f32 v152, v128, v129
v_exp_f32 v131, v131
v_mfma_f32_16x16x32_bf16 v[124:127], a[196:199], v[12:15], 0
s_add_u32 s72, s72, 4096
v_mov_b32 v154, 0
v_cvt_pk_bf16_f32 v153, v130, v131
v_mov_b32 v155, 0
v_mfma_f32_16x16x32_bf16 v[80:83], a[216:219], v[144:147], v[80:83]
v_exp_f32 v136, v136
v_exp_f32 v137, v137
v_mfma_f32_16x16x32_bf16 v[84:87], a[220:223], v[144:147], v[84:87]
buffer_load_dwordx4 a[80:83], v233, s[16:19], s72 offen offset:0 sc1
v_exp_f32 v138, v138
v_cvt_pk_bf16_f32 v156, v136, v137
v_mfma_f32_16x16x32_bf16 v[104:107], a[232:235], v[144:147], v[104:107]
v_exp_f32 v139, v139
v_exp_f32 v140, v140
v_mfma_f32_16x16x32_bf16 v[88:91], a[216:219], v[148:151], v[88:91]
v_cvt_pk_bf16_f32 v157, v138, v139
v_exp_f32 v141, v141
v_mfma_f32_16x16x32_bf16 v[92:95], a[220:223], v[148:151], v[92:95]
buffer_load_dwordx4 a[84:87], v233, s[16:19], s72 offen offset:1024 sc1
v_exp_f32 v142, v142
v_mfma_f32_16x16x32_bf16 v[108:111], a[232:235], v[148:151], v[108:111]
s_xor_b32 s41, s72, 2048
v_cvt_pk_bf16_f32 v158, v140, v141
v_exp_f32 v143, v143
s_waitcnt lgkmcnt(2)
v_mfma_f32_16x16x32_bf16 v[128:131], a[200:203], v[8:11], v[48:51]
ds_read_b128 a[208:211], v57 offset:18432
ds_read_b128 a[212:215], v57 offset:19456
v_cvt_pk_bf16_f32 v159, v142, v143
v_exp_f32 v112, v112
v_exp_f32 v113, v113
v_mfma_f32_16x16x32_bf16 v[136:139], a[200:203], v[12:15], 0
s_waitcnt vmcnt(17)
s_add_u32 s50, s34, 524288
buffer_store_dwordx2 v[238:239], v237, s[16:19], s50 offen sc1
v_exp_f32 v114, v114
v_cvt_pk_bf16_f32 v144, v112, v113
v_exp_f32 v115, v115
v_mfma_f32_16x16x32_bf16 v[140:143], a[204:207], v[12:15], v[48:51]
s_waitcnt lgkmcnt(2)
buffer_load_dwordx4 a[88:91], v233, s[16:19], s41 offen offset:0 sc1
v_exp_f32 v116, v116
v_cvt_pk_bf16_f32 v145, v114, v115
v_exp_f32 v117, v117
s_cmp_eq_u32 s35, 8
s_cbranch_scc1 Lrs12o
Lrs12:
v_mfma_f32_16x16x32_bf16 v[64:67], a[224:227], v[152:155], v[64:67]
v_exp_f32 v118, v118
v_cvt_pk_bf16_f32 v146, v116, v117
v_mfma_f32_16x16x32_bf16 v[68:71], a[228:231], v[152:155], v[68:71]
v_exp_f32 v119, v119
v_exp_f32 v120, v120
v_cvt_pk_bf16_f32 v147, v118, v119
v_mfma_f32_16x16x32_bf16 v[96:99], a[232:235], v[152:155], v[96:99]
buffer_load_dwordx4 a[92:95], v233, s[16:19], s41 offen offset:1024 sc1
v_exp_f32 v121, v121
v_exp_f32 v122, v122
v_mfma_f32_16x16x32_bf16 v[72:75], a[224:227], v[156:159], v[72:75]
v_cvt_pk_bf16_f32 v148, v120, v121
v_exp_f32 v123, v123
v_exp_f32 v124, v124
v_mfma_f32_16x16x32_bf16 v[76:79], a[228:231], v[156:159], v[76:79]
v_cvt_pk_bf16_f32 v149, v122, v123
v_exp_f32 v125, v125
v_exp_f32 v126, v126
v_mfma_f32_16x16x32_bf16 v[100:103], a[232:235], v[156:159], v[100:103]
v_cvt_pk_bf16_f32 v150, v124, v125
v_exp_f32 v127, v127
s_waitcnt lgkmcnt(0)
v_mfma_f32_16x16x32_bf16 v[80:83], a[224:227], v[144:147], v[80:83]
v_cvt_pk_bf16_f32 v151, v126, v127
v_exp_f32 v128, v128
v_exp_f32 v129, v129
v_exp_f32 v130, v130
v_mfma_f32_16x16x32_bf16 v[84:87], a[228:231], v[144:147], v[84:87]
v_cvt_pk_bf16_f32 v152, v128, v129
v_exp_f32 v131, v131
v_mov_b32 v154, 0
v_mfma_f32_16x16x32_bf16 v[104:107], a[232:235], v[144:147], v[104:107]
v_cvt_pk_bf16_f32 v153, v130, v131
v_mov_b32 v155, 0
v_exp_f32 v136, v136
v_exp_f32 v137, v137
v_mfma_f32_16x16x32_bf16 v[88:91], a[224:227], v[148:151], v[88:91]
v_exp_f32 v138, v138
v_cvt_pk_bf16_f32 v156, v136, v137
v_exp_f32 v139, v139
v_mfma_f32_16x16x32_bf16 v[92:95], a[228:231], v[148:151], v[92:95]
v_exp_f32 v140, v140
v_cvt_pk_bf16_f32 v157, v138, v139
v_exp_f32 v141, v141
v_mfma_f32_16x16x32_bf16 v[108:111], a[232:235], v[148:151], v[108:111]
v_exp_f32 v142, v142
v_cvt_pk_bf16_f32 v158, v140, v141
v_exp_f32 v143, v143
s_nop 0
v_cvt_pk_bf16_f32 v159, v142, v143
v_mfma_f32_16x16x32_bf16 v[80:83], a[208:211], v[152:155], v[80:83]
v_mfma_f32_16x16x32_bf16 v[84:87], a[212:215], v[152:155], v[84:87]
v_mfma_f32_16x16x32_bf16 v[104:107], a[232:235], v[152:155], v[104:107]
v_mfma_f32_16x16x32_bf16 v[88:91], a[208:211], v[156:159], v[88:91]
v_mfma_f32_16x16x32_bf16 v[92:95], a[212:215], v[156:159], v[92:95]
v_mfma_f32_16x16x32_bf16 v[108:111], a[232:235], v[156:159], v[108:111]
s_nop 4
v_min3_f32 v196, v96, v100, v104
v_add_f32 v198, v96, v100
s_nop 0
v_add_f32 v199, v104, v108
v_min_f32 v196, v196, v108
v_add_f32 v198, v198, v199
v_cmp_nlt_f32 vcc, 0x2b800000, v196
s_mov_b32 s46, 0x53800000
v_cmp_ngt_f32 s[42:43], s46, v198
s_nop 0
s_or_b64 vcc, vcc, s[42:43]
s_cbranch_vccnz Lfallback
Lattn_done:
v_rcp_f32 v196, v96
v_rcp_f32 v197, v100
v_rcp_f32 v198, v104
v_rcp_f32 v199, v108
v_pk_mul_f32 v[64:65], v[64:65], v[196:197] op_sel:[0,0] op_sel_hi:[1,0]
v_pk_mul_f32 v[66:67], v[66:67], v[196:197] op_sel:[0,0] op_sel_hi:[1,0]
v_pk_mul_f32 v[68:69], v[68:69], v[196:197] op_sel:[0,0] op_sel_hi:[1,0]
v_pk_mul_f32 v[70:71], v[70:71], v[196:197] op_sel:[0,0] op_sel_hi:[1,0]
v_cvt_pk_bf16_f32 v64, v64, v65
v_cvt_pk_bf16_f32 v65, v66, v67
v_cvt_pk_bf16_f32 v66, v68, v69
v_cvt_pk_bf16_f32 v67, v70, v71
buffer_store_dwordx4 v[64:67], v233, s[16:19], s66 offen offset:0 sc1
v_pk_mul_f32 v[72:73], v[72:73], v[196:197] op_sel:[0,1] op_sel_hi:[1,1]
v_pk_mul_f32 v[74:75], v[74:75], v[196:197] op_sel:[0,1] op_sel_hi:[1,1]
v_pk_mul_f32 v[76:77], v[76:77], v[196:197] op_sel:[0,1] op_sel_hi:[1,1]
v_pk_mul_f32 v[78:79], v[78:79], v[196:197] op_sel:[0,1] op_sel_hi:[1,1]
v_cvt_pk_bf16_f32 v72, v72, v73
v_cvt_pk_bf16_f32 v73, v74, v75
v_cvt_pk_bf16_f32 v74, v76, v77
v_cvt_pk_bf16_f32 v75, v78, v79
buffer_store_dwordx4 v[72:75], v233, s[16:19], s66 offen offset:1024 sc1
v_pk_mul_f32 v[80:81], v[80:81], v[198:199] op_sel:[0,0] op_sel_hi:[1,0]
v_pk_mul_f32 v[82:83], v[82:83], v[198:199] op_sel:[0,0] op_sel_hi:[1,0]
v_pk_mul_f32 v[84:85], v[84:85], v[198:199] op_sel:[0,0] op_sel_hi:[1,0]
v_pk_mul_f32 v[86:87], v[86:87], v[198:199] op_sel:[0,0] op_sel_hi:[1,0]
v_cvt_pk_bf16_f32 v80, v80, v81
v_cvt_pk_bf16_f32 v81, v82, v83
v_cvt_pk_bf16_f32 v82, v84, v85
v_cvt_pk_bf16_f32 v83, v86, v87
buffer_store_dwordx4 v[80:83], v233, s[16:19], s66 offen offset:2048 sc1
v_pk_mul_f32 v[88:89], v[88:89], v[198:199] op_sel:[0,1] op_sel_hi:[1,1]
v_pk_mul_f32 v[90:91], v[90:91], v[198:199] op_sel:[0,1] op_sel_hi:[1,1]
v_pk_mul_f32 v[92:93], v[92:93], v[198:199] op_sel:[0,1] op_sel_hi:[1,1]
v_pk_mul_f32 v[94:95], v[94:95], v[198:199] op_sel:[0,1] op_sel_hi:[1,1]
v_cvt_pk_bf16_f32 v88, v88, v89
v_cvt_pk_bf16_f32 v89, v90, v91
v_cvt_pk_bf16_f32 v90, v92, v93
v_cvt_pk_bf16_f32 v91, v94, v95
buffer_store_dwordx4 v[88:91], v233, s[16:19], s66 offen offset:3072 sc1
s_barrier
ds_read_b64_tr_b16 a[192:193], v208 offset:0
ds_read_b64_tr_b16 a[194:195], v208 offset:4096
ds_read_b64_tr_b16 a[196:197], v208 offset:8192
ds_read_b64_tr_b16 a[198:199], v208 offset:12288
ds_read_b64_tr_b16 a[200:201], v209 offset:0
ds_read_b64_tr_b16 a[202:203], v209 offset:4096
ds_read_b64_tr_b16 a[204:205], v209 offset:8192
ds_read_b64_tr_b16 a[206:207], v209 offset:12288
ds_read_b64_tr_b16 a[208:209], v210 offset:0
ds_read_b64_tr_b16 a[210:211], v210 offset:4096
ds_read_b64_tr_b16 a[212:213], v210 offset:8192
ds_read_b64_tr_b16 a[214:215], v210 offset:12288
ds_read_b64_tr_b16 a[216:217], v211 offset:0
ds_read_b64_tr_b16 a[218:219], v211 offset:4096
ds_read_b64_tr_b16 a[220:221], v211 offset:8192
ds_read_b64_tr_b16 a[222:223], v211 offset:12288
ds_read_b64_tr_b16 a[224:225], v212 offset:0
ds_read_b64_tr_b16 a[226:227], v212 offset:4096
ds_read_b64_tr_b16 a[228:229], v212 offset:8192
ds_read_b64_tr_b16 a[230:231], v212 offset:12288
ds_read_b64_tr_b16 a[232:233], v213 offset:0
ds_read_b64_tr_b16 a[234:235], v213 offset:4096
ds_read_b64_tr_b16 a[236:237], v213 offset:8192
ds_read_b64_tr_b16 a[238:239], v213 offset:12288
s_waitcnt vmcnt(21) lgkmcnt(8)
v_mfma_f32_16x16x32_bf16 v[0:3], a[192:195], a[0:3], 0
s_add_u32 s72, s72, 12288
buffer_load_dwordx4 a[96:99], v233, s[16:19], s72 offen offset:0 sc1
v_mfma_f32_16x16x32_bf16 v[0:3], a[196:199], a[16:19], v[0:3]
ds_read_b64_tr_b16 a[240:241], v214 offset:0
ds_read_b64_tr_b16 a[242:243], v214 offset:4096
v_mfma_f32_16x16x32_bf16 v[4:7], a[196:199], a[20:23], 0
v_and_b32 v252, 15, v234
v_lshrrev_b32 v253, 4, v234
v_mfma_f32_16x16x32_bf16 v[4:7], a[192:195], a[4:7], v[4:7]
ds_read_b64_tr_b16 a[244:245], v214 offset:8192
v_lshlrev_b32 v253, 2, v253
v_mfma_f32_16x16x32_bf16 v[8:11], a[192:195], a[8:11], 0
buffer_load_dwordx4 a[100:103], v233, s[16:19], s72 offen offset:1024 sc1
v_mfma_f32_16x16x32_bf16 v[8:11], a[196:199], a[24:27], v[8:11]
s_xor_b32 s41, s72, 2048
ds_read_b64_tr_b16 a[246:247], v214 offset:12288
v_sub_u32 v252, v252, v253
v_mfma_f32_16x16x32_bf16 v[12:15], a[196:199], a[28:31], 0
v_mov_b32 v253, 0x3f80
v_mov_b32 v254, 1.0
v_mfma_f32_16x16x32_bf16 v[12:15], a[192:195], a[12:15], v[12:15]
ds_read_b64_tr_b16 a[248:249], v215 offset:0
v_mfma_f32_16x16x32_bf16 v[16:19], a[200:203], a[0:3], 0
buffer_load_dwordx4 a[104:107], v233, s[16:19], s41 offen offset:0 sc1
v_mfma_f32_16x16x32_bf16 v[16:19], a[204:207], a[16:19], v[16:19]
ds_read_b64_tr_b16 a[250:251], v215 offset:4096
v_mov_b32 v128, 0
v_mfma_f32_16x16x32_bf16 v[20:23], a[204:207], a[20:23], 0
v_mov_b32 v129, 0
v_mov_b32 v130, 0
v_mfma_f32_16x16x32_bf16 v[20:23], a[200:203], a[4:7], v[20:23]
ds_read_b64_tr_b16 a[252:253], v215 offset:8192
v_mfma_f32_16x16x32_bf16 v[24:27], a[200:203], a[8:11], 0
buffer_load_dwordx4 a[108:111], v233, s[16:19], s41 offen offset:1024 sc1
v_mfma_f32_16x16x32_bf16 v[24:27], a[204:207], a[24:27], v[24:27]
s_add_u32 m0, s70, 65536
ds_read_b64_tr_b16 a[254:255], v215 offset:12288
v_mov_b32 v131, 0
v_mfma_f32_16x16x32_bf16 v[28:31], a[204:207], a[28:31], 0
s_bfe_u32 s71, s78, 0x40008
v_mov_b32 v132, 0
v_mov_b32 v133, 0
v_mfma_f32_16x16x32_bf16 v[28:31], a[200:203], a[12:15], v[28:31]
s_mul_i32 s71, s71, 458752
ds_read_b64_tr_b16 a[192:193], v208 offset:16384
v_mfma_f32_16x16x32_bf16 v[32:35], a[208:211], a[0:3], 0
s_add_u32 s71, s71, s79
v_cmp_eq_u32 s[42:43], 0, v252
v_mfma_f32_16x16x32_bf16 v[32:35], a[212:215], a[16:19], v[32:35]
buffer_load_dwordx4 v240, s[20:23], s71 offen lds
v_mfma_f32_16x16x32_bf16 v[36:39], a[212:215], a[20:23], 0
s_add_u32 s72, s72, 4096
ds_read_b64_tr_b16 a[194:195], v208 offset:20480
v_nop
v_mfma_f32_16x16x32_bf16 v[36:39], a[208:211], a[4:7], v[36:39]
ds_read_b64_tr_b16 a[196:197], v208 offset:24576
v_cndmask_b32_e64 v130, v130, v253, s[42:43]
v_mfma_f32_16x16x32_bf16 v[40:43], a[208:211], a[8:11], 0
v_cmp_eq_u32 s[42:43], 1, v252
v_mfma_f32_16x16x32_bf16 v[40:43], a[212:215], a[24:27], v[40:43]
buffer_load_dwordx4 a[112:115], v233, s[16:19], s72 offen offset:0 sc1
v_mfma_f32_16x16x32_bf16 v[44:47], a[212:215], a[28:31], 0
ds_read_b64_tr_b16 a[198:199], v208 offset:28672
v_nop
v_mfma_f32_16x16x32_bf16 v[44:47], a[208:211], a[12:15], v[44:47]
ds_read_b64_tr_b16 a[200:201], v209 offset:16384
v_cndmask_b32_e64 v130, v130, v254, s[42:43]
v_mfma_f32_16x16x32_bf16 v[48:51], a[216:219], a[0:3], 0
v_cmp_eq_u32 s[42:43], 2, v252
v_mfma_f32_16x16x32_bf16 v[48:51], a[220:223], a[16:19], v[48:51]
buffer_load_dwordx4 a[116:119], v233, s[16:19], s72 offen offset:1024 sc1
v_mfma_f32_16x16x32_bf16 v[52:55], a[220:223], a[20:23], 0
ds_read_b64_tr_b16 a[202:203], v209 offset:20480
v_nop
v_mfma_f32_16x16x32_bf16 v[52:55], a[216:219], a[4:7], v[52:55]
ds_read_b64_tr_b16 a[204:205], v209 offset:24576
v_cndmask_b32_e64 v131, v131, v253, s[42:43]
v_mfma_f32_16x16x32_bf16 v[56:59], a[216:219], a[8:11], 0
v_cmp_eq_u32 s[42:43], 3, v252
v_mfma_f32_16x16x32_bf16 v[56:59], a[220:223], a[24:27], v[56:59]
ds_read_b64_tr_b16 a[206:207], v209 offset:28672
v_nop
v_mfma_f32_16x16x32_bf16 v[60:63], a[220:223], a[28:31], 0
v_cndmask_b32_e64 v131, v131, v254, s[42:43]
v_mfma_f32_16x16x32_bf16 v[60:63], a[216:219], a[12:15], v[60:63]
s_waitcnt lgkmcnt(8)
v_mfma_f32_16x16x32_bf16 v[64:67], a[224:227], a[0:3], 0
buffer_load_dwordx4 v241, s[20:23], s71 offen offset:1024 lds
v_mfma_f32_16x16x32_bf16 v[64:67], a[228:231], a[16:19], v[64:67]
s_xor_b32 s41, s72, 2048
ds_read_b64_tr_b16 a[208:209], v210 offset:16384
ds_read_b64_tr_b16 a[210:211], v210 offset:20480
v_mfma_f32_16x16x32_bf16 v[68:71], a[228:231], a[20:23], 0
v_mfma_f32_16x16x32_bf16 v[68:71], a[224:227], a[4:7], v[68:71]
ds_read_b64_tr_b16 a[212:213], v210 offset:24576
Lpad8:
s_cbranch_execz Lpad12
v_mfma_f32_16x16x32_bf16 v[72:75], a[224:227], a[8:11], 0
buffer_load_dwordx4 a[120:123], v233, s[16:19], s41 offen offset:0 sc1
v_mfma_f32_16x16x32_bf16 v[72:75], a[228:231], a[24:27], v[72:75]
ds_read_b64_tr_b16 a[214:215], v210 offset:28672
v_mfma_f32_16x16x32_bf16 v[76:79], a[228:231], a[28:31], 0
v_mfma_f32_16x16x32_bf16 v[76:79], a[224:227], a[12:15], v[76:79]
ds_read_b64_tr_b16 a[216:217], v211 offset:16384
v_mfma_f32_16x16x32_bf16 v[80:83], a[232:235], a[0:3], 0
buffer_load_dwordx4 a[124:127], v233, s[16:19], s41 offen offset:1024 sc1
v_mfma_f32_16x16x32_bf16 v[80:83], a[236:239], a[16:19], v[80:83]
s_add_u32 m0, s70, 73728
ds_read_b64_tr_b16 a[218:219], v211 offset:20480
v_mfma_f32_16x16x32_bf16 v[84:87], a[236:239], a[20:23], 0
s_add_u32 s71, s71, 65536
v_mfma_f32_16x16x32_bf16 v[84:87], a[232:235], a[4:7], v[84:87]
ds_read_b64_tr_b16 a[220:221], v211 offset:24576
v_mfma_f32_16x16x32_bf16 v[88:91], a[232:235], a[8:11], 0
buffer_load_dwordx4 v240, s[20:23], s71 offen lds
v_mfma_f32_16x16x32_bf16 v[88:91], a[236:239], a[24:27], v[88:91]
s_bfe_u32 s72, s78, 0x40008
ds_read_b64_tr_b16 a[222:223], v211 offset:28672
v_mfma_f32_16x16x32_bf16 v[92:95], a[236:239], a[28:31], 0
s_mul_i32 s72, s72, 28672
v_mfma_f32_16x16x32_bf16 v[92:95], a[232:235], a[12:15], v[92:95]
s_add_u32 s72, s72, s57
ds_read_b64_tr_b16 a[224:225], v212 offset:16384
v_mfma_f32_16x16x32_bf16 v[96:99], a[240:243], a[0:3], 0
v_mfma_f32_16x16x32_bf16 v[96:99], a[244:247], a[16:19], v[96:99]
buffer_load_dwordx4 a[128:131], v233, s[16:19], s72 offen offset:0 sc1
v_mfma_f32_16x16x32_bf16 v[100:103], a[244:247], a[20:23], 0
ds_read_b64_tr_b16 a[226:227], v212 offset:20480
v_mfma_f32_16x16x32_bf16 v[100:103], a[240:243], a[4:7], v[100:103]
ds_read_b64_tr_b16 a[228:229], v212 offset:24576
v_mfma_f32_16x16x32_bf16 v[104:107], a[240:243], a[8:11], 0
v_mfma_f32_16x16x32_bf16 v[104:107], a[244:247], a[24:27], v[104:107]
buffer_load_dwordx4 a[132:135], v233, s[16:19], s72 offen offset:1024 sc1
v_mfma_f32_16x16x32_bf16 v[108:111], a[244:247], a[28:31], 0
ds_read_b64_tr_b16 a[230:231], v212 offset:28672
v_mfma_f32_16x16x32_bf16 v[108:111], a[240:243], a[12:15], v[108:111]
ds_read_b64_tr_b16 a[232:233], v213 offset:16384
v_mfma_f32_16x16x32_bf16 v[112:115], a[248:251], a[0:3], 0
v_mfma_f32_16x16x32_bf16 v[112:115], a[252:255], a[16:19], v[112:115]
buffer_load_dwordx4 v241, s[20:23], s71 offen offset:1024 lds
v_mfma_f32_16x16x32_bf16 v[116:119], a[252:255], a[20:23], 0
ds_read_b64_tr_b16 a[234:235], v213 offset:20480
v_mfma_f32_16x16x32_bf16 v[116:119], a[248:251], a[4:7], v[116:119]
ds_read_b64_tr_b16 a[236:237], v213 offset:24576
v_mfma_f32_16x16x32_bf16 v[120:123], a[248:251], a[8:11], 0
v_mfma_f32_16x16x32_bf16 v[120:123], a[252:255], a[24:27], v[120:123]
ds_read_b64_tr_b16 a[238:239], v213 offset:28672
v_mfma_f32_16x16x32_bf16 v[124:127], a[252:255], a[28:31], 0
v_mfma_f32_16x16x32_bf16 v[124:127], a[248:251], a[12:15], v[124:127]
s_waitcnt vmcnt(27) lgkmcnt(8)
s_barrier
v_mfma_f32_16x16x32_bf16 v[0:3], a[192:195], a[32:35], v[0:3]
s_waitcnt vmcnt(14)
s_add_u32 s50, s34, 393216
buffer_store_dwordx2 v[238:239], v237, s[16:19], s50 offen sc1
v_mfma_f32_16x16x32_bf16 v[0:3], a[196:199], a[48:51], v[0:3]
s_xor_b32 s41, s72, 2048
ds_read_b64_tr_b16 a[240:241], v214 offset:16384
ds_read_b64_tr_b16 a[242:243], v214 offset:20480
v_mfma_f32_16x16x32_bf16 v[4:7], a[196:199], a[52:55], v[4:7]
v_mfma_f32_16x16x32_bf16 v[4:7], a[192:195], a[36:39], v[4:7]
buffer_load_dwordx4 a[136:139], v233, s[16:19], s41 offen offset:0 sc1
v_mfma_f32_16x16x32_bf16 v[8:11], a[192:195], a[40:43], v[8:11]
ds_read_b64_tr_b16 a[244:245], v214 offset:24576
v_mfma_f32_16x16x32_bf16 v[8:11], a[196:199], a[56:59], v[8:11]
ds_read_b64_tr_b16 a[246:247], v214 offset:28672
v_mfma_f32_16x16x32_bf16 v[12:15], a[196:199], a[60:63], v[12:15]
v_mfma_f32_16x16x32_bf16 v[12:15], a[192:195], a[44:47], v[12:15]
buffer_load_dwordx4 a[140:143], v233, s[16:19], s41 offen offset:1024 sc1
v_mfma_f32_16x16x32_bf16 v[16:19], a[200:203], a[32:35], v[16:19]
s_add_u32 m0, s70, 81920
ds_read_b64_tr_b16 a[248:249], v215 offset:16384
v_mfma_f32_16x16x32_bf16 v[16:19], a[204:207], a[48:51], v[16:19]
s_add_u32 s71, s71, 196608
ds_read_b64_tr_b16 a[250:251], v215 offset:20480
v_mfma_f32_16x16x32_bf16 v[20:23], a[204:207], a[52:55], v[20:23]
v_mfma_f32_16x16x32_bf16 v[20:23], a[200:203], a[36:39], v[20:23]
buffer_load_dwordx4 v240, s[20:23], s71 offen lds
v_mfma_f32_16x16x32_bf16 v[24:27], a[200:203], a[40:43], v[24:27]
s_add_u32 s72, s72, 4096
ds_read_b64_tr_b16 a[252:253], v215 offset:24576
v_mfma_f32_16x16x32_bf16 v[24:27], a[204:207], a[56:59], v[24:27]
ds_read_b64_tr_b16 a[254:255], v215 offset:28672
v_mfma_f32_16x16x32_bf16 v[28:31], a[204:207], a[60:63], v[28:31]
v_mfma_f32_16x16x32_bf16 v[28:31], a[200:203], a[44:47], v[28:31]
buffer_load_dwordx4 a[144:147], v233, s[16:19], s72 offen offset:0 sc1
v_mfma_f32_16x16x32_bf16 v[32:35], a[208:211], a[32:35], v[32:35]
ds_read_b64_tr_b16 a[192:193], v208 offset:32768
v_mfma_f32_16x16x32_bf16 v[32:35], a[212:215], a[48:51], v[32:35]
ds_read_b64_tr_b16 a[194:195], v208 offset:36864
v_mfma_f32_16x16x32_bf16 v[36:39], a[212:215], a[52:55], v[36:39]
buffer_load_dwordx4 a[148:151], v233, s[16:19], s72 offen offset:1024 sc1
v_mfma_f32_16x16x32_bf16 v[36:39], a[208:211], a[36:39], v[36:39]
ds_read_b64_tr_b16 a[196:197], v208 offset:40960
v_mfma_f32_16x16x32_bf16 v[40:43], a[208:211], a[40:43], v[40:43]
v_mfma_f32_16x16x32_bf16 v[40:43], a[212:215], a[56:59], v[40:43]
ds_read_b64_tr_b16 a[198:199], v208 offset:45056
v_mfma_f32_16x16x32_bf16 v[44:47], a[212:215], a[60:63], v[44:47]
buffer_load_dwordx4 v241, s[20:23], s71 offen offset:1024 lds
v_mfma_f32_16x16x32_bf16 v[44:47], a[208:211], a[44:47], v[44:47]
s_xor_b32 s41, s72, 2048
ds_read_b64_tr_b16 a[200:201], v209 offset:32768
v_mfma_f32_16x16x32_bf16 v[48:51], a[216:219], a[32:35], v[48:51]
v_mfma_f32_16x16x32_bf16 v[48:51], a[220:223], a[48:51], v[48:51]
ds_read_b64_tr_b16 a[202:203], v209 offset:36864
v_mfma_f32_16x16x32_bf16 v[52:55], a[220:223], a[52:55], v[52:55]
buffer_load_dwordx4 a[152:155], v233, s[16:19], s41 offen offset:0 sc1
v_mfma_f32_16x16x32_bf16 v[52:55], a[216:219], a[36:39], v[52:55]
ds_read_b64_tr_b16 a[204:205], v209 offset:40960
v_mfma_f32_16x16x32_bf16 v[56:59], a[216:219], a[40:43], v[56:59]
v_mfma_f32_16x16x32_bf16 v[56:59], a[220:223], a[56:59], v[56:59]
ds_read_b64_tr_b16 a[206:207], v209 offset:45056
v_mfma_f32_16x16x32_bf16 v[60:63], a[220:223], a[60:63], v[60:63]
v_mfma_f32_16x16x32_bf16 v[60:63], a[216:219], a[44:47], v[60:63]
s_waitcnt lgkmcnt(8)
v_mfma_f32_16x16x32_bf16 v[64:67], a[224:227], a[32:35], v[64:67]
buffer_load_dwordx4 a[156:159], v233, s[16:19], s41 offen offset:1024 sc1
v_mfma_f32_16x16x32_bf16 v[64:67], a[228:231], a[48:51], v[64:67]
s_add_u32 m0, s70, 90112
ds_read_b64_tr_b16 a[208:209], v210 offset:32768
ds_read_b64_tr_b16 a[210:211], v210 offset:36864
v_mfma_f32_16x16x32_bf16 v[68:71], a[228:231], a[52:55], v[68:71]
s_add_u32 s71, s71, 65536
v_mfma_f32_16x16x32_bf16 v[68:71], a[224:227], a[36:39], v[68:71]
ds_read_b64_tr_b16 a[212:213], v210 offset:40960
v_mfma_f32_16x16x32_bf16 v[72:75], a[224:227], a[40:43], v[72:75]
buffer_load_dwordx4 v240, s[20:23], s71 offen lds
v_mfma_f32_16x16x32_bf16 v[72:75], a[228:231], a[56:59], v[72:75]
s_add_u32 s72, s72, 12288
ds_read_b64_tr_b16 a[214:215], v210 offset:45056
v_mfma_f32_16x16x32_bf16 v[76:79], a[228:231], a[60:63], v[76:79]
v_mfma_f32_16x16x32_bf16 v[76:79], a[224:227], a[44:47], v[76:79]
ds_read_b64_tr_b16 a[216:217], v211 offset:32768
v_mfma_f32_16x16x32_bf16 v[80:83], a[232:235], a[32:35], v[80:83]
buffer_load_dwordx4 a[160:163], v233, s[16:19], s72 offen offset:0 sc1
v_mfma_f32_16x16x32_bf16 v[80:83], a[236:239], a[48:51], v[80:83]
ds_read_b64_tr_b16 a[218:219], v211 offset:36864
v_mfma_f32_16x16x32_bf16 v[84:87], a[236:239], a[52:55], v[84:87]
v_mfma_f32_16x16x32_bf16 v[84:87], a[232:235], a[36:39], v[84:87]
ds_read_b64_tr_b16 a[220:221], v211 offset:40960
v_mfma_f32_16x16x32_bf16 v[88:91], a[232:235], a[40:43], v[88:91]
buffer_load_dwordx4 a[164:167], v233, s[16:19], s72 offen offset:1024 sc1
v_mfma_f32_16x16x32_bf16 v[88:91], a[236:239], a[56:59], v[88:91]
ds_read_b64_tr_b16 a[222:223], v211 offset:45056
v_mfma_f32_16x16x32_bf16 v[92:95], a[236:239], a[60:63], v[92:95]
v_mfma_f32_16x16x32_bf16 v[92:95], a[232:235], a[44:47], v[92:95]
ds_read_b64_tr_b16 a[224:225], v212 offset:32768
v_mfma_f32_16x16x32_bf16 v[96:99], a[240:243], a[32:35], v[96:99]
v_mfma_f32_16x16x32_bf16 v[96:99], a[244:247], a[48:51], v[96:99]
buffer_load_dwordx4 v241, s[20:23], s71 offen offset:1024 lds
v_mfma_f32_16x16x32_bf16 v[100:103], a[244:247], a[52:55], v[100:103]
s_xor_b32 s41, s72, 2048
ds_read_b64_tr_b16 a[226:227], v212 offset:36864
v_mfma_f32_16x16x32_bf16 v[100:103], a[240:243], a[36:39], v[100:103]
ds_read_b64_tr_b16 a[228:229], v212 offset:40960
v_mfma_f32_16x16x32_bf16 v[104:107], a[240:243], a[40:43], v[104:107]
v_mfma_f32_16x16x32_bf16 v[104:107], a[244:247], a[56:59], v[104:107]
buffer_load_dwordx4 a[168:171], v233, s[16:19], s41 offen offset:0 sc1
v_mfma_f32_16x16x32_bf16 v[108:111], a[244:247], a[60:63], v[108:111]
ds_read_b64_tr_b16 a[230:231], v212 offset:45056
v_mfma_f32_16x16x32_bf16 v[108:111], a[240:243], a[44:47], v[108:111]
ds_read_b64_tr_b16 a[232:233], v213 offset:32768
v_mfma_f32_16x16x32_bf16 v[112:115], a[248:251], a[32:35], v[112:115]
v_mfma_f32_16x16x32_bf16 v[112:115], a[252:255], a[48:51], v[112:115]
buffer_load_dwordx4 a[172:175], v233, s[16:19], s41 offen offset:1024 sc1
v_mfma_f32_16x16x32_bf16 v[116:119], a[252:255], a[52:55], v[116:119]
ds_read_b64_tr_b16 a[234:235], v213 offset:36864
v_mfma_f32_16x16x32_bf16 v[116:119], a[248:251], a[36:39], v[116:119]
ds_read_b64_tr_b16 a[236:237], v213 offset:40960
v_mfma_f32_16x16x32_bf16 v[120:123], a[248:251], a[40:43], v[120:123]
v_mfma_f32_16x16x32_bf16 v[120:123], a[252:255], a[56:59], v[120:123]
ds_read_b64_tr_b16 a[238:239], v213 offset:45056
v_mfma_f32_16x16x32_bf16 v[124:127], a[252:255], a[60:63], v[124:127]
v_mfma_f32_16x16x32_bf16 v[124:127], a[248:251], a[44:47], v[124:127]
s_waitcnt lgkmcnt(8)
s_barrier
v_mfma_f32_16x16x32_bf16 v[0:3], a[192:195], a[64:67], v[0:3]
s_add_u32 m0, s70, 0
ds_read_b64_tr_b16 a[240:241], v214 offset:32768
v_mfma_f32_16x16x32_bf16 v[0:3], a[196:199], a[80:83], v[0:3]
s_bfe_u32 s71, s78, 0x4000c
ds_read_b64_tr_b16 a[242:243], v214 offset:36864
v_mfma_f32_16x16x32_bf16 v[4:7], a[196:199], a[84:87], v[4:7]
s_mul_i32 s71, s71, 458752
v_mfma_f32_16x16x32_bf16 v[4:7], a[192:195], a[68:71], v[4:7]
s_add_u32 s71, s71, s79
buffer_load_dwordx4 v240, s[20:23], s71 offen lds
v_mfma_f32_16x16x32_bf16 v[8:11], a[192:195], a[72:75], v[8:11]
s_add_u32 s72, s72, 4096
buffer_load_dwordx4 a[176:179], v233, s[16:19], s72 offen offset:0 sc1
v_mfma_f32_16x16x32_bf16 v[8:11], a[196:199], a[88:91], v[8:11]
ds_read_b64_tr_b16 a[244:245], v214 offset:40960
ds_read_b64_tr_b16 a[246:247], v214 offset:45056
v_mfma_f32_16x16x32_bf16 v[12:15], a[196:199], a[92:95], v[12:15]
v_mfma_f32_16x16x32_bf16 v[12:15], a[192:195], a[76:79], v[12:15]
buffer_load_dwordx4 a[180:183], v233, s[16:19], s72 offen offset:1024 sc1
v_mfma_f32_16x16x32_bf16 v[16:19], a[200:203], a[64:67], v[16:19]
ds_read_b64_tr_b16 a[248:249], v215 offset:32768
v_mfma_f32_16x16x32_bf16 v[16:19], a[204:207], a[80:83], v[16:19]
ds_read_b64_tr_b16 a[250:251], v215 offset:36864
v_mfma_f32_16x16x32_bf16 v[20:23], a[204:207], a[84:87], v[20:23]
v_mfma_f32_16x16x32_bf16 v[20:23], a[200:203], a[68:71], v[20:23]
buffer_load_dwordx4 v241, s[20:23], s71 offen offset:1024 lds
v_mfma_f32_16x16x32_bf16 v[24:27], a[200:203], a[72:75], v[24:27]
s_xor_b32 s41, s72, 2048
ds_read_b64_tr_b16 a[252:253], v215 offset:40960
v_mfma_f32_16x16x32_bf16 v[24:27], a[204:207], a[88:91], v[24:27]
ds_read_b64_tr_b16 a[254:255], v215 offset:45056
v_mfma_f32_16x16x32_bf16 v[28:31], a[204:207], a[92:95], v[28:31]
v_mfma_f32_16x16x32_bf16 v[28:31], a[200:203], a[76:79], v[28:31]
buffer_load_dwordx4 a[184:187], v233, s[16:19], s41 offen offset:0 sc1
v_mfma_f32_16x16x32_bf16 v[32:35], a[208:211], a[64:67], v[32:35]
ds_read_b64_tr_b16 a[192:193], v216 offset:0
v_mfma_f32_16x16x32_bf16 v[32:35], a[212:215], a[80:83], v[32:35]
ds_read_b64_tr_b16 a[194:195], v216 offset:4096
v_mfma_f32_16x16x32_bf16 v[36:39], a[212:215], a[84:87], v[36:39]
buffer_load_dwordx4 a[188:191], v233, s[16:19], s41 offen offset:1024 sc1
v_mfma_f32_16x16x32_bf16 v[36:39], a[208:211], a[68:71], v[36:39]
s_add_u32 m0, s70, 8192
ds_read_b64_tr_b16 a[196:197], v216 offset:8192
v_mfma_f32_16x16x32_bf16 v[40:43], a[208:211], a[72:75], v[40:43]
s_add_u32 s71, s71, 65536
v_mfma_f32_16x16x32_bf16 v[40:43], a[212:215], a[88:91], v[40:43]
ds_read_b64_tr_b16 a[198:199], v216 offset:12288
v_mfma_f32_16x16x32_bf16 v[44:47], a[212:215], a[92:95], v[44:47]
buffer_load_dwordx4 v240, s[20:23], s71 offen lds
v_mfma_f32_16x16x32_bf16 v[44:47], a[208:211], a[76:79], v[44:47]
s_bfe_u32 s72, s78, 0x4000c
ds_read_b64_tr_b16 a[200:201], v217 offset:0
v_mfma_f32_16x16x32_bf16 v[48:51], a[216:219], a[64:67], v[48:51]
s_mul_i32 s72, s72, 28672
v_mfma_f32_16x16x32_bf16 v[48:51], a[220:223], a[80:83], v[48:51]
s_add_u32 s72, s72, s57
ds_read_b64_tr_b16 a[202:203], v217 offset:4096
v_mfma_f32_16x16x32_bf16 v[52:55], a[220:223], a[84:87], v[52:55]
buffer_load_dwordx4 a[0:3], v233, s[16:19], s72 offen offset:0 sc1
v_mfma_f32_16x16x32_bf16 v[52:55], a[216:219], a[68:71], v[52:55]
ds_read_b64_tr_b16 a[204:205], v217 offset:8192
v_mfma_f32_16x16x32_bf16 v[56:59], a[216:219], a[72:75], v[56:59]
v_mfma_f32_16x16x32_bf16 v[56:59], a[220:223], a[88:91], v[56:59]
ds_read_b64_tr_b16 a[206:207], v217 offset:12288
v_mfma_f32_16x16x32_bf16 v[60:63], a[220:223], a[92:95], v[60:63]
v_mfma_f32_16x16x32_bf16 v[60:63], a[216:219], a[76:79], v[60:63]
s_waitcnt lgkmcnt(8)
v_mfma_f32_16x16x32_bf16 v[64:67], a[224:227], a[64:67], v[64:67]
s_add_u32 s51, s73, 524288
s_mov_b64 exec, 0xff
buffer_load_dwordx2 v[246:247], v235, s[16:19], s51 offen sc1
s_mov_b64 exec, -1
v_mfma_f32_16x16x32_bf16 v[64:67], a[228:231], a[80:83], v[64:67]
ds_read_b64_tr_b16 a[208:209], v218 offset:0
ds_read_b64_tr_b16 a[210:211], v218 offset:4096
v_mfma_f32_16x16x32_bf16 v[68:71], a[228:231], a[84:87], v[68:71]
v_mfma_f32_16x16x32_bf16 v[68:71], a[224:227], a[68:71], v[68:71]
buffer_load_dwordx4 a[4:7], v233, s[16:19], s72 offen offset:1024 sc1
v_mfma_f32_16x16x32_bf16 v[72:75], a[224:227], a[72:75], v[72:75]
ds_read_b64_tr_b16 a[212:213], v218 offset:8192
v_mfma_f32_16x16x32_bf16 v[72:75], a[228:231], a[88:91], v[72:75]
ds_read_b64_tr_b16 a[214:215], v218 offset:12288
v_mfma_f32_16x16x32_bf16 v[76:79], a[228:231], a[92:95], v[76:79]
v_mfma_f32_16x16x32_bf16 v[76:79], a[224:227], a[76:79], v[76:79]
buffer_load_dwordx4 v241, s[20:23], s71 offen offset:1024 lds
v_mfma_f32_16x16x32_bf16 v[80:83], a[232:235], a[64:67], v[80:83]
s_xor_b32 s41, s72, 2048
ds_read_b64_tr_b16 a[216:217], v219 offset:0
v_mfma_f32_16x16x32_bf16 v[80:83], a[236:239], a[80:83], v[80:83]
ds_read_b64_tr_b16 a[218:219], v219 offset:4096
v_mfma_f32_16x16x32_bf16 v[84:87], a[236:239], a[84:87], v[84:87]
v_mfma_f32_16x16x32_bf16 v[84:87], a[232:235], a[68:71], v[84:87]
buffer_load_dwordx4 a[8:11], v233, s[16:19], s41 offen offset:0 sc1
v_mfma_f32_16x16x32_bf16 v[88:91], a[232:235], a[72:75], v[88:91]
ds_read_b64_tr_b16 a[220:221], v219 offset:8192
v_mfma_f32_16x16x32_bf16 v[88:91], a[236:239], a[88:91], v[88:91]
ds_read_b64_tr_b16 a[222:223], v219 offset:12288
v_mfma_f32_16x16x32_bf16 v[92:95], a[236:239], a[92:95], v[92:95]
v_mfma_f32_16x16x32_bf16 v[92:95], a[232:235], a[76:79], v[92:95]
buffer_load_dwordx4 a[12:15], v233, s[16:19], s41 offen offset:1024 sc1
v_mfma_f32_16x16x32_bf16 v[96:99], a[240:243], a[64:67], v[96:99]
s_add_u32 m0, s70, 16384
ds_read_b64_tr_b16 a[224:225], v220 offset:0
v_mfma_f32_16x16x32_bf16 v[96:99], a[244:247], a[80:83], v[96:99]
s_add_u32 s71, s71, 196608
ds_read_b64_tr_b16 a[226:227], v220 offset:4096
v_mfma_f32_16x16x32_bf16 v[100:103], a[244:247], a[84:87], v[100:103]
buffer_load_dwordx4 v240, s[20:23], s71 offen lds
v_mfma_f32_16x16x32_bf16 v[100:103], a[240:243], a[68:71], v[100:103]
s_add_u32 s72, s72, 4096
ds_read_b64_tr_b16 a[228:229], v220 offset:8192
v_mfma_f32_16x16x32_bf16 v[104:107], a[240:243], a[72:75], v[104:107]
v_mfma_f32_16x16x32_bf16 v[104:107], a[244:247], a[88:91], v[104:107]
ds_read_b64_tr_b16 a[230:231], v220 offset:12288
v_mfma_f32_16x16x32_bf16 v[108:111], a[244:247], a[92:95], v[108:111]
buffer_load_dwordx4 a[16:19], v233, s[16:19], s72 offen offset:0 sc1
v_mfma_f32_16x16x32_bf16 v[108:111], a[240:243], a[76:79], v[108:111]
ds_read_b64_tr_b16 a[232:233], v221 offset:0
v_mfma_f32_16x16x32_bf16 v[112:115], a[248:251], a[64:67], v[112:115]
v_mfma_f32_16x16x32_bf16 v[112:115], a[252:255], a[80:83], v[112:115]
ds_read_b64_tr_b16 a[234:235], v221 offset:4096
v_mfma_f32_16x16x32_bf16 v[116:119], a[252:255], a[84:87], v[116:119]
buffer_load_dwordx4 a[20:23], v233, s[16:19], s72 offen offset:1024 sc1
v_mfma_f32_16x16x32_bf16 v[116:119], a[248:251], a[68:71], v[116:119]
ds_read_b64_tr_b16 a[236:237], v221 offset:8192
v_mfma_f32_16x16x32_bf16 v[120:123], a[248:251], a[72:75], v[120:123]
v_mfma_f32_16x16x32_bf16 v[120:123], a[252:255], a[88:91], v[120:123]
ds_read_b64_tr_b16 a[238:239], v221 offset:12288
v_mfma_f32_16x16x32_bf16 v[124:127], a[252:255], a[92:95], v[124:127]
v_mfma_f32_16x16x32_bf16 v[124:127], a[248:251], a[76:79], v[124:127]
s_waitcnt vmcnt(31) lgkmcnt(8)
s_barrier
v_mfma_f32_16x16x32_bf16 v[0:3], a[192:195], a[96:99], v[0:3]
buffer_load_dwordx4 v241, s[20:23], s71 offen offset:1024 lds
v_mfma_f32_16x16x32_bf16 v[0:3], a[196:199], a[112:115], v[0:3]
s_xor_b32 s41, s72, 2048
ds_read_b64_tr_b16 a[240:241], v222 offset:0
ds_read_b64_tr_b16 a[242:243], v222 offset:4096
v_mfma_f32_16x16x32_bf16 v[4:7], a[196:199], a[116:119], v[4:7]
v_lshrrev_b32 v205, 1, v234
v_mfma_f32_16x16x32_bf16 v[4:7], a[192:195], a[100:103], v[4:7]
ds_read_b64_tr_b16 a[244:245], v222 offset:8192
v_mfma_f32_16x16x32_bf16 v[8:11], a[192:195], a[104:107], v[8:11]
buffer_load_dwordx4 a[24:27], v233, s[16:19], s41 offen offset:0 sc1
v_mfma_f32_16x16x32_bf16 v[8:11], a[196:199], a[120:123], v[8:11]
ds_read_b64_tr_b16 a[246:247], v222 offset:12288
v_mfma_f32_16x16x32_bf16 v[12:15], a[196:199], a[124:127], v[12:15]
v_lshlrev_b32 v205, 11, v205
v_mfma_f32_16x16x32_bf16 v[12:15], a[192:195], a[108:111], v[12:15]
ds_read_b64_tr_b16 a[248:249], v223 offset:0
v_mfma_f32_16x16x32_bf16 v[16:19], a[200:203], a[96:99], v[16:19]
buffer_load_dwordx4 a[28:31], v233, s[16:19], s41 offen offset:1024 sc1
v_mfma_f32_16x16x32_bf16 v[16:19], a[204:207], a[112:115], v[16:19]
s_add_u32 m0, s70, 24576
ds_read_b64_tr_b16 a[250:251], v223 offset:4096
v_mfma_f32_16x16x32_bf16 v[20:23], a[204:207], a[116:119], v[20:23]
s_add_u32 s71, s71, 65536
v_mfma_f32_16x16x32_bf16 v[20:23], a[200:203], a[100:103], v[20:23]
ds_read_b64_tr_b16 a[252:253], v223 offset:8192
v_mfma_f32_16x16x32_bf16 v[24:27], a[200:203], a[104:107], v[24:27]
buffer_load_dwordx4 v240, s[20:23], s71 offen lds
v_mfma_f32_16x16x32_bf16 v[24:27], a[204:207], a[120:123], v[24:27]
s_add_u32 s72, s72, 12288
ds_read_b64_tr_b16 a[254:255], v223 offset:12288
v_and_b32 v206, 1, v234
v_mfma_f32_16x16x32_bf16 v[28:31], a[204:207], a[124:127], v[28:31]
v_mfma_f32_16x16x32_bf16 v[28:31], a[200:203], a[108:111], v[28:31]
ds_read_b64_tr_b16 a[192:193], v216 offset:16384
v_mfma_f32_16x16x32_bf16 v[32:35], a[208:211], a[96:99], v[32:35]
v_mfma_f32_16x16x32_bf16 v[32:35], a[212:215], a[112:115], v[32:35]
buffer_load_dwordx4 a[32:35], v233, s[16:19], s72 offen offset:0 sc1
v_mfma_f32_16x16x32_bf16 v[36:39], a[212:215], a[116:119], v[36:39]
ds_read_b64_tr_b16 a[194:195], v216 offset:20480
v_mfma_f32_16x16x32_bf16 v[36:39], a[208:211], a[100:103], v[36:39]
ds_read_b64_tr_b16 a[196:197], v216 offset:24576
v_lshl_add_u32 v205, v206, 10, v205
v_mfma_f32_16x16x32_bf16 v[40:43], a[208:211], a[104:107], v[40:43]
s_lshl_b32 s54, s52, 14
v_mfma_f32_16x16x32_bf16 v[40:43], a[212:215], a[120:123], v[40:43]
s_lshl_b32 s55, s40, 7
buffer_load_dwordx4 a[36:39], v233, s[16:19], s72 offen offset:1024 sc1
v_mfma_f32_16x16x32_bf16 v[44:47], a[212:215], a[124:127], v[44:47]
s_add_u32 s54, s54, s55
ds_read_b64_tr_b16 a[198:199], v216 offset:28672
v_mfma_f32_16x16x32_bf16 v[44:47], a[208:211], a[108:111], v[44:47]
ds_read_b64_tr_b16 a[200:201], v217 offset:16384
v_mfma_f32_16x16x32_bf16 v[48:51], a[216:219], a[96:99], v[48:51]
v_mfma_f32_16x16x32_bf16 v[48:51], a[220:223], a[112:115], v[48:51]
buffer_load_dwordx4 v241, s[20:23], s71 offen offset:1024 lds
v_mfma_f32_16x16x32_bf16 v[52:55], a[220:223], a[116:119], v[52:55]
ds_read_b64_tr_b16 a[202:203], v217 offset:20480
v_mfma_f32_16x16x32_bf16 v[52:55], a[216:219], a[100:103], v[52:55]
ds_read_b64_tr_b16 a[204:205], v217 offset:24576
v_mfma_f32_16x16x32_bf16 v[56:59], a[216:219], a[104:107], v[56:59]
s_mov_b64 exec, 0xffff
buffer_load_dword v207, v205, s[24:27], s54 offen offset:256
s_mov_b64 exec, -1
v_mfma_f32_16x16x32_bf16 v[56:59], a[220:223], a[120:123], v[56:59]
ds_read_b64_tr_b16 a[206:207], v217 offset:28672
v_mfma_f32_16x16x32_bf16 v[60:63], a[220:223], a[124:127], v[60:63]
v_mfma_f32_16x16x32_bf16 v[60:63], a[216:219], a[108:111], v[60:63]
s_waitcnt lgkmcnt(8)
v_mfma_f32_16x16x32_bf16 v[64:67], a[224:227], a[96:99], v[64:67]
s_xor_b32 s41, s72, 2048
buffer_load_dwordx4 a[40:43], v233, s[16:19], s41 offen offset:0 sc1
v_mfma_f32_16x16x32_bf16 v[64:67], a[228:231], a[112:115], v[64:67]
ds_read_b64_tr_b16 a[208:209], v218 offset:16384
ds_read_b64_tr_b16 a[210:211], v218 offset:20480
v_mfma_f32_16x16x32_bf16 v[68:71], a[228:231], a[116:119], v[68:71]
v_mfma_f32_16x16x32_bf16 v[68:71], a[224:227], a[100:103], v[68:71]
ds_read_b64_tr_b16 a[212:213], v218 offset:24576
v_mfma_f32_16x16x32_bf16 v[72:75], a[224:227], a[104:107], v[72:75]
buffer_load_dwordx4 a[44:47], v233, s[16:19], s41 offen offset:1024 sc1
v_mfma_f32_16x16x32_bf16 v[72:75], a[228:231], a[120:123], v[72:75]
s_add_u32 m0, s70, 32768
ds_read_b64_tr_b16 a[214:215], v218 offset:28672
v_mfma_f32_16x16x32_bf16 v[76:79], a[228:231], a[124:127], v[76:79]
s_bfe_u32 s71, s78, 0x40000
v_mfma_f32_16x16x32_bf16 v[76:79], a[224:227], a[108:111], v[76:79]
s_mul_i32 s71, s71, 458752
ds_read_b64_tr_b16 a[216:217], v219 offset:16384
v_mfma_f32_16x16x32_bf16 v[80:83], a[232:235], a[96:99], v[80:83]
s_add_u32 s71, s71, s79
v_mfma_f32_16x16x32_bf16 v[80:83], a[236:239], a[112:115], v[80:83]
s_add_u32 s71, s71, 131072
buffer_load_dwordx4 v240, s[20:23], s71 offen lds
v_mfma_f32_16x16x32_bf16 v[84:87], a[236:239], a[116:119], v[84:87]
s_add_u32 s72, s72, 4096
ds_read_b64_tr_b16 a[218:219], v219 offset:20480
v_mfma_f32_16x16x32_bf16 v[84:87], a[232:235], a[100:103], v[84:87]
ds_read_b64_tr_b16 a[220:221], v219 offset:24576
v_mfma_f32_16x16x32_bf16 v[88:91], a[232:235], a[104:107], v[88:91]
buffer_load_dwordx4 a[48:51], v233, s[16:19], s72 offen offset:0 sc1
v_mfma_f32_16x16x32_bf16 v[88:91], a[236:239], a[120:123], v[88:91]
ds_read_b64_tr_b16 a[222:223], v219 offset:28672
v_mfma_f32_16x16x32_bf16 v[92:95], a[236:239], a[124:127], v[92:95]
v_mfma_f32_16x16x32_bf16 v[92:95], a[232:235], a[108:111], v[92:95]
ds_read_b64_tr_b16 a[224:225], v220 offset:16384
v_mfma_f32_16x16x32_bf16 v[96:99], a[240:243], a[96:99], v[96:99]
v_mfma_f32_16x16x32_bf16 v[96:99], a[244:247], a[112:115], v[96:99]
buffer_load_dwordx4 a[52:55], v233, s[16:19], s72 offen offset:1024 sc1
v_mfma_f32_16x16x32_bf16 v[100:103], a[244:247], a[116:119], v[100:103]
ds_read_b64_tr_b16 a[226:227], v220 offset:20480
v_mfma_f32_16x16x32_bf16 v[100:103], a[240:243], a[100:103], v[100:103]
ds_read_b64_tr_b16 a[228:229], v220 offset:24576
v_mfma_f32_16x16x32_bf16 v[104:107], a[240:243], a[104:107], v[104:107]
v_mfma_f32_16x16x32_bf16 v[104:107], a[244:247], a[120:123], v[104:107]
buffer_load_dwordx4 v241, s[20:23], s71 offen offset:1024 lds
v_mfma_f32_16x16x32_bf16 v[108:111], a[244:247], a[124:127], v[108:111]
s_xor_b32 s41, s72, 2048
ds_read_b64_tr_b16 a[230:231], v220 offset:28672
v_mfma_f32_16x16x32_bf16 v[108:111], a[240:243], a[108:111], v[108:111]
ds_read_b64_tr_b16 a[232:233], v221 offset:16384
v_mfma_f32_16x16x32_bf16 v[112:115], a[248:251], a[96:99], v[112:115]
v_mfma_f32_16x16x32_bf16 v[112:115], a[252:255], a[112:115], v[112:115]
buffer_load_dwordx4 a[56:59], v233, s[16:19], s41 offen offset:0 sc1
v_mfma_f32_16x16x32_bf16 v[116:119], a[252:255], a[116:119], v[116:119]
ds_read_b64_tr_b16 a[234:235], v221 offset:20480
v_mfma_f32_16x16x32_bf16 v[116:119], a[248:251], a[100:103], v[116:119]
ds_read_b64_tr_b16 a[236:237], v221 offset:24576
v_mfma_f32_16x16x32_bf16 v[120:123], a[248:251], a[104:107], v[120:123]
v_mfma_f32_16x16x32_bf16 v[120:123], a[252:255], a[120:123], v[120:123]
ds_read_b64_tr_b16 a[238:239], v221 offset:28672
v_mfma_f32_16x16x32_bf16 v[124:127], a[252:255], a[124:127], v[124:127]
v_mfma_f32_16x16x32_bf16 v[124:127], a[248:251], a[108:111], v[124:127]
s_waitcnt vmcnt(33) lgkmcnt(8)
s_barrier
s_waitcnt vmcnt(22)
v_cmp_ne_u64 vcc, s[36:37], v[246:247]
s_mov_b32 s49, 262144
s_cbranch_vccnz Lsp14
Lok13:
v_mfma_f32_16x16x32_bf16 v[0:3], a[192:195], a[128:131], v[0:3]
buffer_load_dwordx4 a[60:63], v233, s[16:19], s41 offen offset:1024 sc1
v_mfma_f32_16x16x32_bf16 v[0:3], a[196:199], a[144:147], v[0:3]
s_add_u32 m0, s70, 40960
ds_read_b64_tr_b16 a[240:241], v222 offset:16384
ds_read_b64_tr_b16 a[242:243], v222 offset:20480
v_mfma_f32_16x16x32_bf16 v[4:7], a[196:199], a[148:151], v[4:7]
s_add_u32 s71, s71, 65536
v_mfma_f32_16x16x32_bf16 v[4:7], a[192:195], a[132:135], v[4:7]
ds_read_b64_tr_b16 a[244:245], v222 offset:24576
v_mfma_f32_16x16x32_bf16 v[8:11], a[192:195], a[136:139], v[8:11]
buffer_load_dwordx4 v242, s[20:23], s71 offen lds
v_mfma_f32_16x16x32_bf16 v[8:11], a[196:199], a[152:155], v[8:11]
s_bfe_u32 s72, s78, 0x40000
ds_read_b64_tr_b16 a[246:247], v222 offset:28672
v_mfma_f32_16x16x32_bf16 v[12:15], a[196:199], a[156:159], v[12:15]
s_mul_i32 s72, s72, 28672
v_mfma_f32_16x16x32_bf16 v[12:15], a[192:195], a[140:143], v[12:15]
s_add_u32 s72, s72, s57
ds_read_b64_tr_b16 a[248:249], v223 offset:16384
v_mfma_f32_16x16x32_bf16 v[16:19], a[200:203], a[128:131], v[16:19]
s_add_u32 s72, s72, 8192
buffer_load_dwordx4 a[64:67], v233, s[16:19], s72 offen offset:0 sc1
v_mfma_f32_16x16x32_bf16 v[16:19], a[204:207], a[144:147], v[16:19]
ds_read_b64_tr_b16 a[250:251], v223 offset:20480
v_mfma_f32_16x16x32_bf16 v[20:23], a[204:207], a[148:151], v[20:23]
v_mfma_f32_16x16x32_bf16 v[20:23], a[200:203], a[132:135], v[20:23]
ds_read_b64_tr_b16 a[252:253], v223 offset:24576
v_mfma_f32_16x16x32_bf16 v[24:27], a[200:203], a[136:139], v[24:27]
buffer_load_dwordx4 a[68:71], v233, s[16:19], s72 offen offset:1024 sc1
v_mfma_f32_16x16x32_bf16 v[24:27], a[204:207], a[152:155], v[24:27]
ds_read_b64_tr_b16 a[254:255], v223 offset:28672
v_mfma_f32_16x16x32_bf16 v[28:31], a[204:207], a[156:159], v[28:31]
v_mfma_f32_16x16x32_bf16 v[28:31], a[200:203], a[140:143], v[28:31]
ds_read_b64_tr_b16 a[192:193], v216 offset:32768
v_mfma_f32_16x16x32_bf16 v[32:35], a[208:211], a[128:131], v[32:35]
v_mfma_f32_16x16x32_bf16 v[32:35], a[212:215], a[144:147], v[32:35]
buffer_load_dwordx4 v243, s[20:23], s71 offen offset:1024 lds
v_mfma_f32_16x16x32_bf16 v[36:39], a[212:215], a[148:151], v[36:39]
s_xor_b32 s41, s72, 2048
ds_read_b64_tr_b16 a[194:195], v216 offset:36864
v_mfma_f32_16x16x32_bf16 v[36:39], a[208:211], a[132:135], v[36:39]
ds_read_b64_tr_b16 a[196:197], v216 offset:40960
v_mfma_f32_16x16x32_bf16 v[40:43], a[208:211], a[136:139], v[40:43]
v_mfma_f32_16x16x32_bf16 v[40:43], a[212:215], a[152:155], v[40:43]
buffer_load_dwordx4 a[72:75], v233, s[16:19], s41 offen offset:0 sc1
v_mfma_f32_16x16x32_bf16 v[44:47], a[212:215], a[156:159], v[44:47]
ds_read_b64_tr_b16 a[198:199], v216 offset:45056
v_mfma_f32_16x16x32_bf16 v[44:47], a[208:211], a[140:143], v[44:47]
ds_read_b64_tr_b16 a[200:201], v217 offset:32768
v_mfma_f32_16x16x32_bf16 v[48:51], a[216:219], a[128:131], v[48:51]
v_mfma_f32_16x16x32_bf16 v[48:51], a[220:223], a[144:147], v[48:51]
buffer_load_dwordx4 a[76:79], v233, s[16:19], s41 offen offset:1024 sc1
v_mfma_f32_16x16x32_bf16 v[52:55], a[220:223], a[148:151], v[52:55]
ds_read_b64_tr_b16 a[202:203], v217 offset:36864
v_mfma_f32_16x16x32_bf16 v[52:55], a[216:219], a[132:135], v[52:55]
ds_read_b64_tr_b16 a[204:205], v217 offset:40960
v_mfma_f32_16x16x32_bf16 v[56:59], a[216:219], a[136:139], v[56:59]
v_mfma_f32_16x16x32_bf16 v[56:59], a[220:223], a[152:155], v[56:59]
ds_read_b64_tr_b16 a[206:207], v217 offset:45056
v_mfma_f32_16x16x32_bf16 v[60:63], a[220:223], a[156:159], v[60:63]
v_mfma_f32_16x16x32_bf16 v[60:63], a[216:219], a[140:143], v[60:63]
s_waitcnt lgkmcnt(8)
v_mfma_f32_16x16x32_bf16 v[64:67], a[224:227], a[128:131], v[64:67]
s_add_u32 m0, s70, 49152
ds_read_b64_tr_b16 a[208:209], v218 offset:32768
v_and_b32 v252, 15, v234
v_mfma_f32_16x16x32_bf16 v[64:67], a[228:231], a[144:147], v[64:67]
s_add_u32 s71, s71, 196608
buffer_load_dwordx4 v240, s[20:23], s71 offen lds
v_mfma_f32_16x16x32_bf16 v[68:71], a[228:231], a[148:151], v[68:71]
s_add_u32 s72, s72, 4096
ds_read_b64_tr_b16 a[210:211], v218 offset:36864
v_lshrrev_b32 v253, 5, v234
v_mfma_f32_16x16x32_bf16 v[68:71], a[224:227], a[132:135], v[68:71]
buffer_load_dwordx4 a[80:83], v233, s[16:19], s72 offen offset:0 sc1
Lpad9:
s_cbranch_execz Lwarm_done
v_mfma_f32_16x16x32_bf16 v[72:75], a[224:227], a[136:139], v[72:75]
ds_read_b64_tr_b16 a[212:213], v218 offset:40960
v_and_b32 v254, 7, v234
v_mfma_f32_16x16x32_bf16 v[72:75], a[228:231], a[152:155], v[72:75]
ds_read_b64_tr_b16 a[214:215], v218 offset:45056
v_mfma_f32_16x16x32_bf16 v[76:79], a[228:231], a[156:159], v[76:79]
buffer_load_dwordx4 a[84:87], v233, s[16:19], s72 offen offset:1024 sc1
v_mfma_f32_16x16x32_bf16 v[76:79], a[224:227], a[140:143], v[76:79]
ds_read_b64_tr_b16 a[216:217], v219 offset:32768
v_xor_b32 v253, v253, v254
v_mfma_f32_16x16x32_bf16 v[80:83], a[232:235], a[128:131], v[80:83]
v_mfma_f32_16x16x32_bf16 v[80:83], a[236:239], a[144:147], v[80:83]
buffer_load_dwordx4 v241, s[20:23], s71 offen offset:1024 lds
v_mfma_f32_16x16x32_bf16 v[84:87], a[236:239], a[148:151], v[84:87]
s_xor_b32 s41, s72, 2048
ds_read_b64_tr_b16 a[218:219], v219 offset:36864
v_lshlrev_b32 v253, 4, v253
v_mfma_f32_16x16x32_bf16 v[84:87], a[232:235], a[132:135], v[84:87]
ds_read_b64_tr_b16 a[220:221], v219 offset:40960
v_mfma_f32_16x16x32_bf16 v[88:91], a[232:235], a[136:139], v[88:91]
buffer_load_dwordx4 a[88:91], v233, s[16:19], s41 offen offset:0 sc1
v_mfma_f32_16x16x32_bf16 v[88:91], a[236:239], a[152:155], v[88:91]
ds_read_b64_tr_b16 a[222:223], v219 offset:45056
v_lshl_add_u32 v200, v252, 7, v253
v_mfma_f32_16x16x32_bf16 v[92:95], a[236:239], a[156:159], v[92:95]
v_bfe_u32 v253, v234, 4, 1
v_mfma_f32_16x16x32_bf16 v[92:95], a[232:235], a[140:143], v[92:95]
buffer_load_dwordx4 a[92:95], v233, s[16:19], s41 offen offset:1024 sc1
v_mfma_f32_16x16x32_bf16 v[96:99], a[240:243], a[128:131], v[96:99]
s_add_u32 m0, s70, 57344
ds_read_b64_tr_b16 a[224:225], v220 offset:32768
v_mfma_f32_16x16x32_bf16 v[96:99], a[244:247], a[144:147], v[96:99]
s_bfe_u32 s71, s78, 0x40004
ds_read_b64_tr_b16 a[226:227], v220 offset:36864
v_lshl_add_u32 v200, v253, 3, v200
v_mfma_f32_16x16x32_bf16 v[100:103], a[244:247], a[148:151], v[100:103]
s_mul_i32 s71, s71, 458752
v_mfma_f32_16x16x32_bf16 v[100:103], a[240:243], a[132:135], v[100:103]
s_add_u32 s71, s71, s79
ds_read_b64_tr_b16 a[228:229], v220 offset:40960
v_mfma_f32_16x16x32_bf16 v[104:107], a[240:243], a[136:139], v[104:107]
s_add_u32 s71, s71, 131072
buffer_load_dwordx4 v240, s[20:23], s71 offen lds
v_mfma_f32_16x16x32_bf16 v[104:107], a[244:247], a[152:155], v[104:107]
s_add_u32 s72, s72, 12288
buffer_load_dwordx4 a[96:99], v233, s[16:19], s72 offen offset:0 sc1
v_mfma_f32_16x16x32_bf16 v[108:111], a[244:247], a[156:159], v[108:111]
s_lshl_b32 s47, s3, 12
ds_read_b64_tr_b16 a[230:231], v220 offset:45056
v_mfma_f32_16x16x32_bf16 v[108:111], a[240:243], a[140:143], v[108:111]
s_add_u32 s47, s47, 131072
ds_read_b64_tr_b16 a[232:233], v221 offset:32768
v_add_u32 v200, s47, v200
v_mfma_f32_16x16x32_bf16 v[112:115], a[248:251], a[128:131], v[112:115]
buffer_load_dwordx4 v241, s[20:23], s71 offen offset:1024 lds
v_mfma_f32_16x16x32_bf16 v[112:115], a[252:255], a[144:147], v[112:115]
s_lshl_b32 s46, s3, 12
ds_read_b64_tr_b16 a[234:235], v221 offset:36864
v_add_u32 v204, s47, v233
v_mfma_f32_16x16x32_bf16 v[116:119], a[252:255], a[148:151], v[116:119]
s_add_u32 m0, s46, 131072
v_xor_b32 v201, 32, v200
v_mfma_f32_16x16x32_bf16 v[116:119], a[248:251], a[132:135], v[116:119]
s_add_u32 s46, s77, 0
buffer_load_dwordx4 v251, s[4:7], s46 offen lds
v_mfma_f32_16x16x32_bf16 v[120:123], a[248:251], a[136:139], v[120:123]
ds_read_b64_tr_b16 a[236:237], v221 offset:40960
v_xor_b32 v202, 64, v200
v_mfma_f32_16x16x32_bf16 v[120:123], a[252:255], a[152:155], v[120:123]
ds_read_b64_tr_b16 a[238:239], v221 offset:45056
v_xor_b32 v203, 96, v200
v_mfma_f32_16x16x32_bf16 v[124:127], a[252:255], a[156:159], v[124:127]
v_mfma_f32_16x16x32_bf16 v[124:127], a[248:251], a[140:143], v[124:127]
s_waitcnt vmcnt(37) lgkmcnt(8)
s_barrier
v_mfma_f32_16x16x32_bf16 v[0:3], a[192:195], a[160:163], v[0:3]
buffer_load_dwordx4 a[100:103], v233, s[16:19], s72 offen offset:1024 sc1
v_mfma_f32_16x16x32_bf16 v[0:3], a[196:199], a[176:179], v[0:3]
s_xor_b32 s41, s72, 2048
ds_read_b64_tr_b16 a[240:241], v222 offset:32768
ds_read_b64_tr_b16 a[242:243], v222 offset:36864
v_mfma_f32_16x16x32_bf16 v[4:7], a[196:199], a[180:183], v[4:7]
v_mfma_f32_16x16x32_bf16 v[4:7], a[192:195], a[164:167], v[4:7]
ds_read_b64_tr_b16 a[244:245], v222 offset:40960
v_mfma_f32_16x16x32_bf16 v[8:11], a[192:195], a[168:171], v[8:11]
buffer_load_dwordx4 a[104:107], v233, s[16:19], s41 offen offset:0 sc1
v_mfma_f32_16x16x32_bf16 v[8:11], a[196:199], a[184:187], v[8:11]
ds_read_b64_tr_b16 a[246:247], v222 offset:45056
v_mfma_f32_16x16x32_bf16 v[12:15], a[196:199], a[188:191], v[12:15]
v_mfma_f32_16x16x32_bf16 v[12:15], a[192:195], a[172:175], v[12:15]
ds_read_b64_tr_b16 a[248:249], v223 offset:32768
v_mfma_f32_16x16x32_bf16 v[16:19], a[200:203], a[160:163], v[16:19]
buffer_load_dwordx4 a[108:111], v233, s[16:19], s41 offen offset:1024 sc1
v_mfma_f32_16x16x32_bf16 v[16:19], a[204:207], a[176:179], v[16:19]
s_add_u32 m0, s70, 65536
ds_read_b64_tr_b16 a[250:251], v223 offset:36864
v_mfma_f32_16x16x32_bf16 v[20:23], a[204:207], a[180:183], v[20:23]
s_add_u32 s71, s71, 65536
v_mfma_f32_16x16x32_bf16 v[20:23], a[200:203], a[164:167], v[20:23]
ds_read_b64_tr_b16 a[252:253], v223 offset:40960
v_mfma_f32_16x16x32_bf16 v[24:27], a[200:203], a[168:171], v[24:27]
buffer_load_dwordx4 v242, s[20:23], s71 offen lds
v_mfma_f32_16x16x32_bf16 v[24:27], a[204:207], a[184:187], v[24:27]
s_bfe_u32 s72, s78, 0x40004
ds_read_b64_tr_b16 a[254:255], v223 offset:45056
v_mfma_f32_16x16x32_bf16 v[28:31], a[204:207], a[188:191], v[28:31]
s_mul_i32 s72, s72, 28672
v_mfma_f32_16x16x32_bf16 v[28:31], a[200:203], a[172:175], v[28:31]
s_add_u32 s72, s72, s57
ds_read_b64_tr_b16 a[192:193], v208 offset:0
v_mfma_f32_16x16x32_bf16 v[32:35], a[208:211], a[160:163], v[32:35]
s_add_u32 s72, s72, 8192
v_mfma_f32_16x16x32_bf16 v[32:35], a[212:215], a[176:179], v[32:35]
buffer_load_dwordx4 a[112:115], v233, s[16:19], s72 offen offset:0 sc1
v_mfma_f32_16x16x32_bf16 v[36:39], a[212:215], a[180:183], v[36:39]
ds_read_b64_tr_b16 a[194:195], v208 offset:4096
v_mfma_f32_16x16x32_bf16 v[36:39], a[208:211], a[164:167], v[36:39]
ds_read_b64_tr_b16 a[196:197], v208 offset:8192
v_mfma_f32_16x16x32_bf16 v[40:43], a[208:211], a[168:171], v[40:43]
v_mfma_f32_16x16x32_bf16 v[40:43], a[212:215], a[184:187], v[40:43]
buffer_load_dwordx4 v243, s[20:23], s71 offen offset:1024 lds
v_mfma_f32_16x16x32_bf16 v[44:47], a[212:215], a[188:191], v[44:47]
s_lshl_b32 s46, s3, 12
ds_read_b64_tr_b16 a[198:199], v208 offset:12288
v_mfma_f32_16x16x32_bf16 v[44:47], a[208:211], a[172:175], v[44:47]
s_add_u32 m0, s46, 132096
ds_read_b64_tr_b16 a[200:201], v209 offset:0
v_mfma_f32_16x16x32_bf16 v[48:51], a[216:219], a[160:163], v[48:51]
s_add_u32 s46, s77, 16384
v_mfma_f32_16x16x32_bf16 v[48:51], a[220:223], a[176:179], v[48:51]
buffer_load_dwordx4 v251, s[4:7], s46 offen lds
v_mfma_f32_16x16x32_bf16 v[52:55], a[220:223], a[180:183], v[52:55]
ds_read_b64_tr_b16 a[202:203], v209 offset:4096
v_mfma_f32_16x16x32_bf16 v[52:55], a[216:219], a[164:167], v[52:55]
ds_read_b64_tr_b16 a[204:205], v209 offset:8192
v_mfma_f32_16x16x32_bf16 v[56:59], a[216:219], a[168:171], v[56:59]
v_mfma_f32_16x16x32_bf16 v[56:59], a[220:223], a[184:187], v[56:59]
ds_read_b64_tr_b16 a[206:207], v209 offset:12288
v_mfma_f32_16x16x32_bf16 v[60:63], a[220:223], a[188:191], v[60:63]
v_mfma_f32_16x16x32_bf16 v[60:63], a[216:219], a[172:175], v[60:63]
s_waitcnt lgkmcnt(8)
v_mfma_f32_16x16x32_bf16 v[64:67], a[224:227], a[160:163], v[64:67]
buffer_load_dwordx4 a[116:119], v233, s[16:19], s72 offen offset:1024 sc1
v_mfma_f32_16x16x32_bf16 v[64:67], a[228:231], a[176:179], v[64:67]
s_xor_b32 s41, s72, 2048
ds_read_b64_tr_b16 a[208:209], v210 offset:0
ds_read_b64_tr_b16 a[210:211], v210 offset:4096
v_mfma_f32_16x16x32_bf16 v[68:71], a[228:231], a[180:183], v[68:71]
v_mfma_f32_16x16x32_bf16 v[68:71], a[224:227], a[164:167], v[68:71]
ds_read_b64_tr_b16 a[212:213], v210 offset:8192
v_mfma_f32_16x16x32_bf16 v[72:75], a[224:227], a[168:171], v[72:75]
buffer_load_dwordx4 a[120:123], v233, s[16:19], s41 offen offset:0 sc1
v_mfma_f32_16x16x32_bf16 v[72:75], a[228:231], a[184:187], v[72:75]
ds_read_b64_tr_b16 a[214:215], v210 offset:12288
v_mfma_f32_16x16x32_bf16 v[76:79], a[228:231], a[188:191], v[76:79]
v_mfma_f32_16x16x32_bf16 v[76:79], a[224:227], a[172:175], v[76:79]
ds_read_b64_tr_b16 a[216:217], v211 offset:0
v_mfma_f32_16x16x32_bf16 v[80:83], a[232:235], a[160:163], v[80:83]
buffer_load_dwordx4 a[124:127], v233, s[16:19], s41 offen offset:1024 sc1
v_mfma_f32_16x16x32_bf16 v[80:83], a[236:239], a[176:179], v[80:83]
s_add_u32 m0, s70, 73728
ds_read_b64_tr_b16 a[218:219], v211 offset:4096
v_mfma_f32_16x16x32_bf16 v[84:87], a[236:239], a[180:183], v[84:87]
s_add_u32 s71, s71, 196608
v_mfma_f32_16x16x32_bf16 v[84:87], a[232:235], a[164:167], v[84:87]
ds_read_b64_tr_b16 a[220:221], v211 offset:8192
v_mfma_f32_16x16x32_bf16 v[88:91], a[232:235], a[168:171], v[88:91]
buffer_load_dwordx4 v240, s[20:23], s71 offen lds
v_mfma_f32_16x16x32_bf16 v[88:91], a[236:239], a[184:187], v[88:91]
s_add_u32 s72, s72, 4096
ds_read_b64_tr_b16 a[222:223], v211 offset:12288
v_mfma_f32_16x16x32_bf16 v[92:95], a[236:239], a[188:191], v[92:95]
v_mfma_f32_16x16x32_bf16 v[92:95], a[232:235], a[172:175], v[92:95]
ds_read_b64_tr_b16 a[224:225], v212 offset:0
v_mfma_f32_16x16x32_bf16 v[96:99], a[240:243], a[160:163], v[96:99]
v_mfma_f32_16x16x32_bf16 v[96:99], a[244:247], a[176:179], v[96:99]
buffer_load_dwordx4 a[128:131], v233, s[16:19], s72 offen offset:0 sc1
v_mfma_f32_16x16x32_bf16 v[100:103], a[244:247], a[180:183], v[100:103]
ds_read_b64_tr_b16 a[226:227], v212 offset:4096
v_mfma_f32_16x16x32_bf16 v[100:103], a[240:243], a[164:167], v[100:103]
ds_read_b64_tr_b16 a[228:229], v212 offset:8192
v_mfma_f32_16x16x32_bf16 v[104:107], a[240:243], a[168:171], v[104:107]
v_mfma_f32_16x16x32_bf16 v[104:107], a[244:247], a[184:187], v[104:107]
buffer_load_dwordx4 v241, s[20:23], s71 offen offset:1024 lds
v_mfma_f32_16x16x32_bf16 v[108:111], a[244:247], a[188:191], v[108:111]
s_lshl_b32 s46, s3, 12
ds_read_b64_tr_b16 a[230:231], v212 offset:12288
v_mfma_f32_16x16x32_bf16 v[108:111], a[240:243], a[172:175], v[108:111]
s_add_u32 m0, s46, 133120
ds_read_b64_tr_b16 a[232:233], v213 offset:0
v_mfma_f32_16x16x32_bf16 v[112:115], a[248:251], a[160:163], v[112:115]
s_add_u32 s46, s77, 32768
v_mfma_f32_16x16x32_bf16 v[112:115], a[252:255], a[176:179], v[112:115]
buffer_load_dwordx4 v251, s[4:7], s46 offen lds
v_mfma_f32_16x16x32_bf16 v[116:119], a[252:255], a[180:183], v[116:119]
ds_read_b64_tr_b16 a[234:235], v213 offset:4096
v_mfma_f32_16x16x32_bf16 v[116:119], a[248:251], a[164:167], v[116:119]
ds_read_b64_tr_b16 a[236:237], v213 offset:8192
v_mfma_f32_16x16x32_bf16 v[120:123], a[248:251], a[168:171], v[120:123]
v_mfma_f32_16x16x32_bf16 v[120:123], a[252:255], a[184:187], v[120:123]
ds_read_b64_tr_b16 a[238:239], v213 offset:12288
v_mfma_f32_16x16x32_bf16 v[124:127], a[252:255], a[188:191], v[124:127]
v_mfma_f32_16x16x32_bf16 v[124:127], a[248:251], a[172:175], v[124:127]
s_waitcnt vmcnt(39) lgkmcnt(8)
s_barrier
v_mfma_f32_16x16x32_bf16 v[0:3], a[192:195], a[0:3], v[0:3]
buffer_load_dwordx4 a[132:135], v233, s[16:19], s72 offen offset:1024 sc1
v_mfma_f32_16x16x32_bf16 v[0:3], a[196:199], a[16:19], v[0:3]
s_xor_b32 s41, s72, 2048
ds_read_b64_tr_b16 a[240:241], v214 offset:0
ds_read_b64_tr_b16 a[242:243], v214 offset:4096
v_mfma_f32_16x16x32_bf16 v[4:7], a[196:199], a[20:23], v[4:7]
v_mfma_f32_16x16x32_bf16 v[4:7], a[192:195], a[4:7], v[4:7]
ds_read_b64_tr_b16 a[244:245], v214 offset:8192
v_mfma_f32_16x16x32_bf16 v[8:11], a[192:195], a[8:11], v[8:11]
buffer_load_dwordx4 a[136:139], v233, s[16:19], s41 offen offset:0 sc1
v_mfma_f32_16x16x32_bf16 v[8:11], a[196:199], a[24:27], v[8:11]
ds_read_b64_tr_b16 a[246:247], v214 offset:12288
v_mfma_f32_16x16x32_bf16 v[12:15], a[196:199], a[28:31], v[12:15]
v_mfma_f32_16x16x32_bf16 v[12:15], a[192:195], a[12:15], v[12:15]
ds_read_b64_tr_b16 a[248:249], v215 offset:0
v_mfma_f32_16x16x32_bf16 v[16:19], a[200:203], a[0:3], v[16:19]
buffer_load_dwordx4 a[140:143], v233, s[16:19], s41 offen offset:1024 sc1
v_mfma_f32_16x16x32_bf16 v[16:19], a[204:207], a[16:19], v[16:19]
s_add_u32 m0, s70, 81920
ds_read_b64_tr_b16 a[250:251], v215 offset:4096
v_mfma_f32_16x16x32_bf16 v[20:23], a[204:207], a[20:23], v[20:23]
s_bfe_u32 s71, s78, 0x40008
v_mfma_f32_16x16x32_bf16 v[20:23], a[200:203], a[4:7], v[20:23]
s_mul_i32 s71, s71, 458752
ds_read_b64_tr_b16 a[252:253], v215 offset:8192
v_mfma_f32_16x16x32_bf16 v[24:27], a[200:203], a[8:11], v[24:27]
s_add_u32 s71, s71, s79
v_mfma_f32_16x16x32_bf16 v[24:27], a[204:207], a[24:27], v[24:27]
s_add_u32 s71, s71, 131072
buffer_load_dwordx4 v240, s[20:23], s71 offen lds
v_mfma_f32_16x16x32_bf16 v[28:31], a[204:207], a[28:31], v[28:31]
s_add_u32 s72, s72, 12288
ds_read_b64_tr_b16 a[254:255], v215 offset:12288
v_mfma_f32_16x16x32_bf16 v[28:31], a[200:203], a[12:15], v[28:31]
ds_read_b64_tr_b16 a[192:193], v208 offset:16384
v_mfma_f32_16x16x32_bf16 v[32:35], a[208:211], a[0:3], v[32:35]
v_mfma_f32_16x16x32_bf16 v[32:35], a[212:215], a[16:19], v[32:35]
buffer_load_dwordx4 a[144:147], v233, s[16:19], s72 offen offset:0 sc1
v_mfma_f32_16x16x32_bf16 v[36:39], a[212:215], a[20:23], v[36:39]
ds_read_b64_tr_b16 a[194:195], v208 offset:20480
v_mfma_f32_16x16x32_bf16 v[36:39], a[208:211], a[4:7], v[36:39]
ds_read_b64_tr_b16 a[196:197], v208 offset:24576
v_mfma_f32_16x16x32_bf16 v[40:43], a[208:211], a[8:11], v[40:43]
v_mfma_f32_16x16x32_bf16 v[40:43], a[212:215], a[24:27], v[40:43]
buffer_load_dwordx4 v241, s[20:23], s71 offen offset:1024 lds
v_mfma_f32_16x16x32_bf16 v[44:47], a[212:215], a[28:31], v[44:47]
s_lshl_b32 s46, s3, 12
ds_read_b64_tr_b16 a[198:199], v208 offset:28672
v_mfma_f32_16x16x32_bf16 v[44:47], a[208:211], a[12:15], v[44:47]
s_add_u32 m0, s46, 134144
ds_read_b64_tr_b16 a[200:201], v209 offset:16384
v_mfma_f32_16x16x32_bf16 v[48:51], a[216:219], a[0:3], v[48:51]
s_add_u32 s46, s77, 49152
v_mfma_f32_16x16x32_bf16 v[48:51], a[220:223], a[16:19], v[48:51]
buffer_load_dwordx4 v251, s[4:7], s46 offen lds
v_mfma_f32_16x16x32_bf16 v[52:55], a[220:223], a[20:23], v[52:55]
ds_read_b64_tr_b16 a[202:203], v209 offset:20480
v_mfma_f32_16x16x32_bf16 v[52:55], a[216:219], a[4:7], v[52:55]
ds_read_b64_tr_b16 a[204:205], v209 offset:24576
v_mfma_f32_16x16x32_bf16 v[56:59], a[216:219], a[8:11], v[56:59]
v_mfma_f32_16x16x32_bf16 v[56:59], a[220:223], a[24:27], v[56:59]
ds_read_b64_tr_b16 a[206:207], v209 offset:28672
v_mfma_f32_16x16x32_bf16 v[60:63], a[220:223], a[28:31], v[60:63]
v_mfma_f32_16x16x32_bf16 v[60:63], a[216:219], a[12:15], v[60:63]
s_waitcnt lgkmcnt(8)
v_mfma_f32_16x16x32_bf16 v[64:67], a[224:227], a[0:3], v[64:67]
s_add_u32 s51, s73, 393216
s_mov_b64 exec, 0xffffffff
buffer_load_dwordx2 v[246:247], v236, s[16:19], s51 offen sc1
s_mov_b64 exec, -1
v_mfma_f32_16x16x32_bf16 v[64:67], a[228:231], a[16:19], v[64:67]
ds_read_b64_tr_b16 a[208:209], v210 offset:16384
ds_read_b64_tr_b16 a[210:211], v210 offset:20480
v_mfma_f32_16x16x32_bf16 v[68:71], a[228:231], a[20:23], v[68:71]
v_mfma_f32_16x16x32_bf16 v[68:71], a[224:227], a[4:7], v[68:71]
ds_read_b64_tr_b16 a[212:213], v210 offset:24576
v_mfma_f32_16x16x32_bf16 v[72:75], a[224:227], a[8:11], v[72:75]
v_mfma_f32_16x16x32_bf16 v[72:75], a[228:231], a[24:27], v[72:75]
buffer_load_dwordx4 a[148:151], v233, s[16:19], s72 offen offset:1024 sc1
v_mfma_f32_16x16x32_bf16 v[76:79], a[228:231], a[28:31], v[76:79]
s_xor_b32 s41, s72, 2048
ds_read_b64_tr_b16 a[214:215], v210 offset:28672
v_mfma_f32_16x16x32_bf16 v[76:79], a[224:227], a[12:15], v[76:79]
ds_read_b64_tr_b16 a[216:217], v211 offset:16384
v_mfma_f32_16x16x32_bf16 v[80:83], a[232:235], a[0:3], v[80:83]
v_mfma_f32_16x16x32_bf16 v[80:83], a[236:239], a[16:19], v[80:83]
ds_read_b64_tr_b16 a[218:219], v211 offset:20480
v_mfma_f32_16x16x32_bf16 v[84:87], a[236:239], a[20:23], v[84:87]
buffer_load_dwordx4 a[152:155], v233, s[16:19], s41 offen offset:0 sc1
v_mfma_f32_16x16x32_bf16 v[84:87], a[232:235], a[4:7], v[84:87]
ds_read_b64_tr_b16 a[220:221], v211 offset:24576
v_mfma_f32_16x16x32_bf16 v[88:91], a[232:235], a[8:11], v[88:91]
v_mfma_f32_16x16x32_bf16 v[88:91], a[236:239], a[24:27], v[88:91]
ds_read_b64_tr_b16 a[222:223], v211 offset:28672
v_mfma_f32_16x16x32_bf16 v[92:95], a[236:239], a[28:31], v[92:95]
v_mfma_f32_16x16x32_bf16 v[92:95], a[232:235], a[12:15], v[92:95]
buffer_load_dwordx4 a[156:159], v233, s[16:19], s41 offen offset:1024 sc1
v_mfma_f32_16x16x32_bf16 v[96:99], a[240:243], a[0:3], v[96:99]
s_add_u32 m0, s70, 90112
ds_read_b64_tr_b16 a[224:225], v212 offset:16384
v_mfma_f32_16x16x32_bf16 v[96:99], a[244:247], a[16:19], v[96:99]
s_add_u32 s71, s71, 65536
ds_read_b64_tr_b16 a[226:227], v212 offset:20480
v_mfma_f32_16x16x32_bf16 v[100:103], a[244:247], a[20:23], v[100:103]
v_mfma_f32_16x16x32_bf16 v[100:103], a[240:243], a[4:7], v[100:103]
ds_read_b64_tr_b16 a[228:229], v212 offset:24576
v_mfma_f32_16x16x32_bf16 v[104:107], a[240:243], a[8:11], v[104:107]
buffer_load_dwordx4 v242, s[20:23], s71 offen lds
v_mfma_f32_16x16x32_bf16 v[104:107], a[244:247], a[24:27], v[104:107]
s_bfe_u32 s72, s78, 0x40008
ds_read_b64_tr_b16 a[230:231], v212 offset:28672
v_mfma_f32_16x16x32_bf16 v[108:111], a[244:247], a[28:31], v[108:111]
s_mul_i32 s72, s72, 28672
v_mfma_f32_16x16x32_bf16 v[108:111], a[240:243], a[12:15], v[108:111]
s_add_u32 s72, s72, s57
ds_read_b64_tr_b16 a[232:233], v213 offset:16384
v_mfma_f32_16x16x32_bf16 v[112:115], a[248:251], a[0:3], v[112:115]
s_add_u32 s72, s72, 8192
v_mfma_f32_16x16x32_bf16 v[112:115], a[252:255], a[16:19], v[112:115]
buffer_load_dwordx4 a[160:163], v233, s[16:19], s72 offen offset:0 sc1
v_mfma_f32_16x16x32_bf16 v[116:119], a[252:255], a[20:23], v[116:119]
ds_read_b64_tr_b16 a[234:235], v213 offset:20480
v_mfma_f32_16x16x32_bf16 v[116:119], a[248:251], a[4:7], v[116:119]
ds_read_b64_tr_b16 a[236:237], v213 offset:24576
v_mfma_f32_16x16x32_bf16 v[120:123], a[248:251], a[8:11], v[120:123]
v_mfma_f32_16x16x32_bf16 v[120:123], a[252:255], a[24:27], v[120:123]
ds_read_b64_tr_b16 a[238:239], v213 offset:28672
v_mfma_f32_16x16x32_bf16 v[124:127], a[252:255], a[28:31], v[124:127]
v_mfma_f32_16x16x32_bf16 v[124:127], a[248:251], a[12:15], v[124:127]
s_waitcnt vmcnt(39) lgkmcnt(8)
s_barrier
v_mfma_f32_16x16x32_bf16 v[0:3], a[192:195], a[32:35], v[0:3]
buffer_load_dwordx4 a[164:167], v233, s[16:19], s72 offen offset:1024 sc1
v_mfma_f32_16x16x32_bf16 v[0:3], a[196:199], a[48:51], v[0:3]
ds_read_b64_tr_b16 a[240:241], v214 offset:16384
ds_read_b64_tr_b16 a[242:243], v214 offset:20480
v_mfma_f32_16x16x32_bf16 v[4:7], a[196:199], a[52:55], v[4:7]
v_mfma_f32_16x16x32_bf16 v[4:7], a[192:195], a[36:39], v[4:7]
buffer_load_dwordx4 v243, s[20:23], s71 offen offset:1024 lds
v_mfma_f32_16x16x32_bf16 v[8:11], a[192:195], a[40:43], v[8:11]
s_xor_b32 s41, s72, 2048
ds_read_b64_tr_b16 a[244:245], v214 offset:24576
v_mfma_f32_16x16x32_bf16 v[8:11], a[196:199], a[56:59], v[8:11]
ds_read_b64_tr_b16 a[246:247], v214 offset:28672
v_mfma_f32_16x16x32_bf16 v[12:15], a[196:199], a[60:63], v[12:15]
v_mfma_f32_16x16x32_bf16 v[12:15], a[192:195], a[44:47], v[12:15]
buffer_load_dwordx4 a[168:171], v233, s[16:19], s41 offen offset:0 sc1
v_mfma_f32_16x16x32_bf16 v[16:19], a[200:203], a[32:35], v[16:19]
ds_read_b64_tr_b16 a[248:249], v215 offset:16384
v_mfma_f32_16x16x32_bf16 v[16:19], a[204:207], a[48:51], v[16:19]
ds_read_b64_tr_b16 a[250:251], v215 offset:20480
v_mfma_f32_16x16x32_bf16 v[20:23], a[204:207], a[52:55], v[20:23]
v_mfma_f32_16x16x32_bf16 v[20:23], a[200:203], a[36:39], v[20:23]
buffer_load_dwordx4 a[172:175], v233, s[16:19], s41 offen offset:1024 sc1
v_mfma_f32_16x16x32_bf16 v[24:27], a[200:203], a[40:43], v[24:27]
s_add_u32 m0, s70, 0
ds_read_b64_tr_b16 a[252:253], v215 offset:24576
v_mfma_f32_16x16x32_bf16 v[24:27], a[204:207], a[56:59], v[24:27]
s_add_u32 s71, s71, 196608
ds_read_b64_tr_b16 a[254:255], v215 offset:28672
v_mfma_f32_16x16x32_bf16 v[28:31], a[204:207], a[60:63], v[28:31]
v_mfma_f32_16x16x32_bf16 v[28:31], a[200:203], a[44:47], v[28:31]
buffer_load_dwordx4 v240, s[20:23], s71 offen lds
v_mfma_f32_16x16x32_bf16 v[32:35], a[208:211], a[32:35], v[32:35]
s_add_u32 s72, s72, 4096
ds_read_b64_tr_b16 a[192:193], v208 offset:32768
v_mfma_f32_16x16x32_bf16 v[32:35], a[212:215], a[48:51], v[32:35]
ds_read_b64_tr_b16 a[194:195], v208 offset:36864
v_mfma_f32_16x16x32_bf16 v[36:39], a[212:215], a[52:55], v[36:39]
buffer_load_dwordx4 a[176:179], v233, s[16:19], s72 offen offset:0 sc1
v_mfma_f32_16x16x32_bf16 v[36:39], a[208:211], a[36:39], v[36:39]
ds_read_b64_tr_b16 a[196:197], v208 offset:40960
v_mfma_f32_16x16x32_bf16 v[40:43], a[208:211], a[40:43], v[40:43]
v_mfma_f32_16x16x32_bf16 v[40:43], a[212:215], a[56:59], v[40:43]
ds_read_b64_tr_b16 a[198:199], v208 offset:45056
v_mfma_f32_16x16x32_bf16 v[44:47], a[212:215], a[60:63], v[44:47]
buffer_load_dwordx4 a[180:183], v233, s[16:19], s72 offen offset:1024 sc1
v_mfma_f32_16x16x32_bf16 v[44:47], a[208:211], a[44:47], v[44:47]
ds_read_b64_tr_b16 a[200:201], v209 offset:32768
v_mfma_f32_16x16x32_bf16 v[48:51], a[216:219], a[32:35], v[48:51]
v_mfma_f32_16x16x32_bf16 v[48:51], a[220:223], a[48:51], v[48:51]
ds_read_b64_tr_b16 a[202:203], v209 offset:36864
v_mfma_f32_16x16x32_bf16 v[52:55], a[220:223], a[52:55], v[52:55]
buffer_load_dwordx4 v241, s[20:23], s71 offen offset:1024 lds
v_mfma_f32_16x16x32_bf16 v[52:55], a[216:219], a[36:39], v[52:55]
ds_read_b64_tr_b16 a[204:205], v209 offset:40960
v_mfma_f32_16x16x32_bf16 v[56:59], a[216:219], a[40:43], v[56:59]
v_mfma_f32_16x16x32_bf16 v[56:59], a[220:223], a[56:59], v[56:59]
ds_read_b64_tr_b16 a[206:207], v209 offset:45056
v_mfma_f32_16x16x32_bf16 v[60:63], a[220:223], a[60:63], v[60:63]
v_mfma_f32_16x16x32_bf16 v[60:63], a[216:219], a[44:47], v[60:63]
s_waitcnt lgkmcnt(8)
v_mfma_f32_16x16x32_bf16 v[64:67], a[224:227], a[32:35], v[64:67]
s_xor_b32 s41, s72, 2048
buffer_load_dwordx4 a[184:187], v233, s[16:19], s41 offen offset:0 sc1
v_mfma_f32_16x16x32_bf16 v[64:67], a[228:231], a[48:51], v[64:67]
ds_read_b64_tr_b16 a[208:209], v210 offset:32768
ds_read_b64_tr_b16 a[210:211], v210 offset:36864
v_mfma_f32_16x16x32_bf16 v[68:71], a[228:231], a[52:55], v[68:71]
v_mfma_f32_16x16x32_bf16 v[68:71], a[224:227], a[36:39], v[68:71]
ds_read_b64_tr_b16 a[212:213], v210 offset:40960
v_mfma_f32_16x16x32_bf16 v[72:75], a[224:227], a[40:43], v[72:75]
buffer_load_dwordx4 a[188:191], v233, s[16:19], s41 offen offset:1024 sc1
v_mfma_f32_16x16x32_bf16 v[72:75], a[228:231], a[56:59], v[72:75]
s_add_u32 m0, s70, 8192
ds_read_b64_tr_b16 a[214:215], v210 offset:45056
v_mfma_f32_16x16x32_bf16 v[76:79], a[228:231], a[60:63], v[76:79]
s_bfe_u32 s71, s78, 0x4000c
v_mfma_f32_16x16x32_bf16 v[76:79], a[224:227], a[44:47], v[76:79]
s_mul_i32 s71, s71, 458752
ds_read_b64_tr_b16 a[216:217], v211 offset:32768
v_mfma_f32_16x16x32_bf16 v[80:83], a[232:235], a[32:35], v[80:83]
s_add_u32 s71, s71, s79
v_mfma_f32_16x16x32_bf16 v[80:83], a[236:239], a[48:51], v[80:83]
s_add_u32 s71, s71, 131072
buffer_load_dwordx4 v240, s[20:23], s71 offen lds
v_mfma_f32_16x16x32_bf16 v[84:87], a[236:239], a[52:55], v[84:87]
s_add_u32 s72, s72, 12288
ds_read_b64_tr_b16 a[218:219], v211 offset:36864
v_mfma_f32_16x16x32_bf16 v[84:87], a[232:235], a[36:39], v[84:87]
ds_read_b64_tr_b16 a[220:221], v211 offset:40960
v_mfma_f32_16x16x32_bf16 v[88:91], a[232:235], a[40:43], v[88:91]
buffer_load_dwordx4 a[0:3], v233, s[16:19], s72 offen offset:0 sc1
v_mfma_f32_16x16x32_bf16 v[88:91], a[236:239], a[56:59], v[88:91]
ds_read_b64_tr_b16 a[222:223], v211 offset:45056
v_mfma_f32_16x16x32_bf16 v[92:95], a[236:239], a[60:63], v[92:95]
v_mfma_f32_16x16x32_bf16 v[92:95], a[232:235], a[44:47], v[92:95]
ds_read_b64_tr_b16 a[224:225], v212 offset:32768
s_waitcnt vmcnt(18)
v_mfma_f32_16x16x32_bf16 v[96:99], a[240:243], a[32:35], v[96:99]
ds_read_b64 v[136:137], v200 offset:0
v_mfma_f32_16x16x32_bf16 v[96:99], a[244:247], a[48:51], v[96:99]
buffer_load_dwordx4 a[4:7], v233, s[16:19], s72 offen offset:1024 sc1
ds_read_b64 v[138:139], v201 offset:0
v_mfma_f32_16x16x32_bf16 v[100:103], a[244:247], a[52:55], v[100:103]
ds_read_b64_tr_b16 a[226:227], v212 offset:36864
ds_read_b64 v[140:141], v202 offset:0
v_mfma_f32_16x16x32_bf16 v[100:103], a[240:243], a[36:39], v[100:103]
ds_read_b64_tr_b16 a[228:229], v212 offset:40960
ds_read_b64 v[142:143], v203 offset:0
v_mfma_f32_16x16x32_bf16 v[104:107], a[240:243], a[40:43], v[104:107]
ds_read_b64 v[144:145], v200 offset:2048
v_mfma_f32_16x16x32_bf16 v[104:107], a[244:247], a[56:59], v[104:107]
buffer_load_dwordx4 v241, s[20:23], s71 offen offset:1024 lds
ds_read_b64 v[146:147], v201 offset:2048
v_mfma_f32_16x16x32_bf16 v[108:111], a[244:247], a[60:63], v[108:111]
s_xor_b32 s41, s72, 2048
ds_read_b64_tr_b16 a[230:231], v212 offset:45056
ds_read_b64 v[148:149], v202 offset:2048
v_mfma_f32_16x16x32_bf16 v[108:111], a[240:243], a[44:47], v[108:111]
ds_read_b64_tr_b16 a[232:233], v213 offset:32768
ds_read_b64 v[150:151], v203 offset:2048
v_mfma_f32_16x16x32_bf16 v[112:115], a[248:251], a[32:35], v[112:115]
v_mfma_f32_16x16x32_bf16 v[112:115], a[252:255], a[48:51], v[112:115]
buffer_load_dwordx4 a[8:11], v233, s[16:19], s41 offen offset:0 sc1
v_mfma_f32_16x16x32_bf16 v[116:119], a[252:255], a[52:55], v[116:119]
ds_read_b64_tr_b16 a[234:235], v213 offset:36864
v_mfma_f32_16x16x32_bf16 v[116:119], a[248:251], a[36:39], v[116:119]
ds_read_b64_tr_b16 a[236:237], v213 offset:40960
v_mfma_f32_16x16x32_bf16 v[120:123], a[248:251], a[40:43], v[120:123]
v_mfma_f32_16x16x32_bf16 v[120:123], a[252:255], a[56:59], v[120:123]
ds_read_b64_tr_b16 a[238:239], v213 offset:45056
v_mfma_f32_16x16x32_bf16 v[124:127], a[252:255], a[60:63], v[124:127]
v_mfma_f32_16x16x32_bf16 v[124:127], a[248:251], a[44:47], v[124:127]
s_waitcnt lgkmcnt(15)
s_barrier
s_waitcnt vmcnt(20)
v_cmp_ne_u64 vcc, s[36:37], v[246:247]
s_mov_b32 s49, 262144
s_cbranch_vccnz Lsp16
Lok15:
v_mfma_f32_16x16x32_bf16 v[0:3], a[192:195], a[64:67], v[0:3]
buffer_load_dwordx4 a[12:15], v233, s[16:19], s41 offen offset:1024 sc1
v_mfma_f32_16x16x32_bf16 v[0:3], a[196:199], a[80:83], v[0:3]
s_add_u32 m0, s70, 16384
ds_read_b64_tr_b16 a[240:241], v214 offset:32768
v_mfma_f32_16x16x32_bf16 v[4:7], a[196:199], a[84:87], v[4:7]
s_add_u32 s71, s71, 65536
ds_read_b64_tr_b16 a[242:243], v214 offset:36864
v_mfma_f32_16x16x32_bf16 v[4:7], a[192:195], a[68:71], v[4:7]
v_mfma_f32_16x16x32_bf16 v[8:11], a[192:195], a[72:75], v[8:11]
ds_read_b64_tr_b16 a[244:245], v214 offset:40960
v_mfma_f32_16x16x32_bf16 v[8:11], a[196:199], a[88:91], v[8:11]
buffer_load_dwordx4 v242, s[20:23], s71 offen lds
v_mfma_f32_16x16x32_bf16 v[12:15], a[196:199], a[92:95], v[12:15]
s_bfe_u32 s72, s78, 0x4000c
v_mfma_f32_16x16x32_bf16 v[12:15], a[192:195], a[76:79], v[12:15]
s_mul_i32 s72, s72, 28672
ds_read_b64_tr_b16 a[246:247], v214 offset:45056
v_mfma_f32_16x16x32_bf16 v[16:19], a[200:203], a[64:67], v[16:19]
s_add_u32 s72, s72, s57
v_mfma_f32_16x16x32_bf16 v[16:19], a[204:207], a[80:83], v[16:19]
s_add_u32 s72, s72, 8192
ds_read_b64_tr_b16 a[248:249], v215 offset:32768
v_mfma_f32_16x16x32_bf16 v[20:23], a[204:207], a[84:87], v[20:23]
buffer_load_dwordx4 a[16:19], v233, s[16:19], s72 offen offset:0 sc1
v_mfma_f32_16x16x32_bf16 v[20:23], a[200:203], a[68:71], v[20:23]
v_mfma_f32_16x16x32_bf16 v[24:27], a[200:203], a[72:75], v[24:27]
ds_read_b64_tr_b16 a[250:251], v215 offset:36864
v_mfma_f32_16x16x32_bf16 v[24:27], a[204:207], a[88:91], v[24:27]
v_mfma_f32_16x16x32_bf16 v[28:31], a[204:207], a[92:95], v[28:31]
ds_read_b64_tr_b16 a[252:253], v215 offset:40960
s_waitcnt lgkmcnt(10)
v_mfma_f32_16x16x32_bf16 v[28:31], a[200:203], a[76:79], v[28:31]
v_mfma_f32_16x16x32_bf16 v[0:3], v[130:133], v[136:139], v[0:3]
buffer_load_dwordx4 a[20:23], v233, s[16:19], s72 offen offset:1024 sc1
v_mfma_f32_16x16x32_bf16 v[16:19], v[128:131], v[136:139], v[16:19]
ds_read_b64_tr_b16 a[254:255], v215 offset:45056
v_mfma_f32_16x16x32_bf16 v[32:35], v[130:133], v[140:143], v[32:35]
v_mfma_f32_16x16x32_bf16 v[48:51], v[128:131], v[140:143], v[48:51]
ds_read_b64_tr_b16 a[192:193], v216 offset:0
v_mfma_f32_16x16x32_bf16 v[4:7], v[130:133], v[144:147], v[4:7]
v_mfma_f32_16x16x32_bf16 v[20:23], v[128:131], v[144:147], v[20:23]
buffer_load_dwordx4 v243, s[20:23], s71 offen offset:1024 lds
v_mfma_f32_16x16x32_bf16 v[36:39], v[130:133], v[148:151], v[36:39]
s_xor_b32 s41, s72, 2048
ds_read_b64_tr_b16 a[194:195], v216 offset:4096
v_mfma_f32_16x16x32_bf16 v[52:55], v[128:131], v[148:151], v[52:55]
v_mfma_f32_16x16x32_bf16 v[32:35], a[208:211], a[64:67], v[32:35]
ds_read_b64_tr_b16 a[196:197], v216 offset:8192
v_mfma_f32_16x16x32_bf16 v[32:35], a[212:215], a[80:83], v[32:35]
v_mfma_f32_16x16x32_bf16 v[36:39], a[212:215], a[84:87], v[36:39]
ds_read_b64_tr_b16 a[198:199], v216 offset:12288
v_mfma_f32_16x16x32_bf16 v[36:39], a[208:211], a[68:71], v[36:39]
buffer_load_dwordx4 a[24:27], v233, s[16:19], s41 offen offset:0 sc1
Lpad10:
s_cbranch_execz Lwarm_done
v_mfma_f32_16x16x32_bf16 v[40:43], a[208:211], a[72:75], v[40:43]
v_mfma_f32_16x16x32_bf16 v[40:43], a[212:215], a[88:91], v[40:43]
ds_read_b64_tr_b16 a[200:201], v217 offset:0
v_mfma_f32_16x16x32_bf16 v[44:47], a[212:215], a[92:95], v[44:47]
v_mfma_f32_16x16x32_bf16 v[44:47], a[208:211], a[76:79], v[44:47]
ds_read_b64_tr_b16 a[202:203], v217 offset:4096
v_mfma_f32_16x16x32_bf16 v[48:51], a[216:219], a[64:67], v[48:51]
buffer_load_dwordx4 a[28:31], v233, s[16:19], s41 offen offset:1024 sc1
v_mfma_f32_16x16x32_bf16 v[48:51], a[220:223], a[80:83], v[48:51]
v_mfma_f32_16x16x32_bf16 v[52:55], a[220:223], a[84:87], v[52:55]
ds_read_b64_tr_b16 a[204:205], v217 offset:8192
v_mfma_f32_16x16x32_bf16 v[52:55], a[216:219], a[68:71], v[52:55]
v_mfma_f32_16x16x32_bf16 v[56:59], a[216:219], a[72:75], v[56:59]
ds_read_b64_tr_b16 a[206:207], v217 offset:12288
v_mfma_f32_16x16x32_bf16 v[56:59], a[220:223], a[88:91], v[56:59]
v_mfma_f32_16x16x32_bf16 v[60:63], a[220:223], a[92:95], v[60:63]
v_mfma_f32_16x16x32_bf16 v[60:63], a[216:219], a[76:79], v[60:63]
s_waitcnt lgkmcnt(8)
v_mfma_f32_16x16x32_bf16 v[64:67], a[224:227], a[64:67], v[64:67]
s_add_u32 m0, s70, 24576
ds_read_b64_tr_b16 a[208:209], v218 offset:0
v_mfma_f32_16x16x32_bf16 v[64:67], a[228:231], a[80:83], v[64:67]
s_add_u32 s71, s71, 196608
buffer_load_dwordx4 v240, s[20:23], s71 offen lds
v_mfma_f32_16x16x32_bf16 v[68:71], a[228:231], a[84:87], v[68:71]
s_add_u32 s72, s72, 4096
ds_read_b64_tr_b16 a[210:211], v218 offset:4096
v_mfma_f32_16x16x32_bf16 v[68:71], a[224:227], a[68:71], v[68:71]
ds_read_b64_tr_b16 a[212:213], v218 offset:8192
v_mfma_f32_16x16x32_bf16 v[72:75], a[224:227], a[72:75], v[72:75]
buffer_load_dwordx4 a[32:35], v233, s[16:19], s72 offen offset:0 sc1
v_mfma_f32_16x16x32_bf16 v[72:75], a[228:231], a[88:91], v[72:75]
ds_read_b64_tr_b16 a[214:215], v218 offset:12288
v_mfma_f32_16x16x32_bf16 v[76:79], a[228:231], a[92:95], v[76:79]
v_mfma_f32_16x16x32_bf16 v[76:79], a[224:227], a[76:79], v[76:79]
ds_read_b64_tr_b16 a[216:217], v219 offset:0
v_mfma_f32_16x16x32_bf16 v[80:83], a[232:235], a[64:67], v[80:83]
buffer_load_dwordx4 a[36:39], v233, s[16:19], s72 offen offset:1024 sc1
v_mfma_f32_16x16x32_bf16 v[80:83], a[236:239], a[80:83], v[80:83]
ds_read_b64_tr_b16 a[218:219], v219 offset:4096
v_mfma_f32_16x16x32_bf16 v[84:87], a[236:239], a[84:87], v[84:87]
v_mfma_f32_16x16x32_bf16 v[84:87], a[232:235], a[68:71], v[84:87]
ds_read_b64_tr_b16 a[220:221], v219 offset:8192
v_mfma_f32_16x16x32_bf16 v[88:91], a[232:235], a[72:75], v[88:91]
buffer_load_dwordx4 v241, s[20:23], s71 offen offset:1024 lds
v_mfma_f32_16x16x32_bf16 v[88:91], a[236:239], a[88:91], v[88:91]
s_xor_b32 s41, s72, 2048
ds_read_b64_tr_b16 a[222:223], v219 offset:12288
v_mfma_f32_16x16x32_bf16 v[92:95], a[236:239], a[92:95], v[92:95]
v_mfma_f32_16x16x32_bf16 v[92:95], a[232:235], a[76:79], v[92:95]
ds_read_b64_tr_b16 a[224:225], v220 offset:0
v_mfma_f32_16x16x32_bf16 v[96:99], a[240:243], a[64:67], v[96:99]
v_mfma_f32_16x16x32_bf16 v[96:99], a[244:247], a[80:83], v[96:99]
buffer_load_dwordx4 a[40:43], v233, s[16:19], s41 offen offset:0 sc1
v_mfma_f32_16x16x32_bf16 v[100:103], a[244:247], a[84:87], v[100:103]
ds_read_b64_tr_b16 a[226:227], v220 offset:4096
v_mfma_f32_16x16x32_bf16 v[100:103], a[240:243], a[68:71], v[100:103]
ds_read_b64_tr_b16 a[228:229], v220 offset:8192
v_mfma_f32_16x16x32_bf16 v[104:107], a[240:243], a[72:75], v[104:107]
v_mfma_f32_16x16x32_bf16 v[104:107], a[244:247], a[88:91], v[104:107]
buffer_load_dwordx4 a[44:47], v233, s[16:19], s41 offen offset:1024 sc1
v_mfma_f32_16x16x32_bf16 v[108:111], a[244:247], a[92:95], v[108:111]
s_add_u32 s72, s72, 12288
ds_read_b64_tr_b16 a[230:231], v220 offset:12288
v_mfma_f32_16x16x32_bf16 v[108:111], a[240:243], a[76:79], v[108:111]
ds_read_b64_tr_b16 a[232:233], v221 offset:0
v_mfma_f32_16x16x32_bf16 v[112:115], a[248:251], a[64:67], v[112:115]
v_mfma_f32_16x16x32_bf16 v[112:115], a[252:255], a[80:83], v[112:115]
buffer_load_dwordx4 a[48:51], v233, s[16:19], s72 offen offset:0 sc1
v_mfma_f32_16x16x32_bf16 v[116:119], a[252:255], a[84:87], v[116:119]
ds_read_b64_tr_b16 a[234:235], v221 offset:4096
v_mfma_f32_16x16x32_bf16 v[116:119], a[248:251], a[68:71], v[116:119]
ds_read_b64_tr_b16 a[236:237], v221 offset:8192
v_mfma_f32_16x16x32_bf16 v[120:123], a[248:251], a[72:75], v[120:123]
v_mfma_f32_16x16x32_bf16 v[120:123], a[252:255], a[88:91], v[120:123]
ds_read_b64_tr_b16 a[238:239], v221 offset:12288
v_mfma_f32_16x16x32_bf16 v[124:127], a[252:255], a[92:95], v[124:127]
v_mfma_f32_16x16x32_bf16 v[124:127], a[248:251], a[76:79], v[124:127]
s_waitcnt lgkmcnt(8)
s_barrier
v_mfma_f32_16x16x32_bf16 v[0:3], a[192:195], a[96:99], v[0:3]
s_add_u32 m0, s70, 32768
ds_read_b64_tr_b16 a[240:241], v222 offset:0
v_mfma_f32_16x16x32_bf16 v[0:3], a[196:199], a[112:115], v[0:3]
s_mul_i32 s71, s38, 393216
buffer_load_dwordx4 v240, s[24:27], s71 offen lds
v_mfma_f32_16x16x32_bf16 v[4:7], a[196:199], a[116:119], v[4:7]
ds_read_b64_tr_b16 a[242:243], v222 offset:4096
v_mfma_f32_16x16x32_bf16 v[4:7], a[192:195], a[100:103], v[4:7]
ds_read_b64_tr_b16 a[244:245], v222 offset:8192
v_mfma_f32_16x16x32_bf16 v[8:11], a[192:195], a[104:107], v[8:11]
buffer_load_dwordx4 a[52:55], v233, s[16:19], s72 offen offset:1024 sc1
v_mfma_f32_16x16x32_bf16 v[8:11], a[196:199], a[120:123], v[8:11]
ds_read_b64_tr_b16 a[246:247], v222 offset:12288
v_mfma_f32_16x16x32_bf16 v[12:15], a[196:199], a[124:127], v[12:15]
v_mfma_f32_16x16x32_bf16 v[12:15], a[192:195], a[108:111], v[12:15]
ds_read_b64_tr_b16 a[248:249], v223 offset:0
v_mfma_f32_16x16x32_bf16 v[16:19], a[200:203], a[96:99], v[16:19]
buffer_load_dwordx4 v241, s[24:27], s71 offen offset:1024 lds
v_mfma_f32_16x16x32_bf16 v[16:19], a[204:207], a[112:115], v[16:19]
s_xor_b32 s41, s72, 2048
ds_read_b64_tr_b16 a[250:251], v223 offset:4096
v_mfma_f32_16x16x32_bf16 v[20:23], a[204:207], a[116:119], v[20:23]
v_mfma_f32_16x16x32_bf16 v[20:23], a[200:203], a[100:103], v[20:23]
ds_read_b64_tr_b16 a[252:253], v223 offset:8192
v_mfma_f32_16x16x32_bf16 v[24:27], a[200:203], a[104:107], v[24:27]
buffer_load_dwordx4 a[56:59], v233, s[16:19], s41 offen offset:0 sc1
v_mfma_f32_16x16x32_bf16 v[24:27], a[204:207], a[120:123], v[24:27]
ds_read_b64_tr_b16 a[254:255], v223 offset:12288
v_mfma_f32_16x16x32_bf16 v[28:31], a[204:207], a[124:127], v[28:31]
v_mfma_f32_16x16x32_bf16 v[28:31], a[200:203], a[108:111], v[28:31]
ds_read_b64_tr_b16 a[192:193], v216 offset:16384
v_mfma_f32_16x16x32_bf16 v[32:35], a[208:211], a[96:99], v[32:35]
v_mfma_f32_16x16x32_bf16 v[32:35], a[212:215], a[112:115], v[32:35]
buffer_load_dwordx4 a[60:63], v233, s[16:19], s41 offen offset:1024 sc1
v_mfma_f32_16x16x32_bf16 v[36:39], a[212:215], a[116:119], v[36:39]
s_add_u32 m0, s70, 40960
ds_read_b64_tr_b16 a[194:195], v216 offset:20480
v_mfma_f32_16x16x32_bf16 v[36:39], a[208:211], a[100:103], v[36:39]
s_add_u32 s71, s71, 65536
ds_read_b64_tr_b16 a[196:197], v216 offset:24576
v_mfma_f32_16x16x32_bf16 v[40:43], a[208:211], a[104:107], v[40:43]
v_mfma_f32_16x16x32_bf16 v[40:43], a[212:215], a[120:123], v[40:43]
buffer_load_dwordx4 v240, s[24:27], s71 offen lds
v_mfma_f32_16x16x32_bf16 v[44:47], a[212:215], a[124:127], v[44:47]
s_mul_i32 s72, s38, 24576
ds_read_b64_tr_b16 a[198:199], v216 offset:28672
v_mfma_f32_16x16x32_bf16 v[44:47], a[208:211], a[108:111], v[44:47]
s_add_u32 s72, s72, s80
ds_read_b64_tr_b16 a[200:201], v217 offset:16384
v_mfma_f32_16x16x32_bf16 v[48:51], a[216:219], a[96:99], v[48:51]
s_add_u32 s72, s72, 458752
v_mfma_f32_16x16x32_bf16 v[48:51], a[220:223], a[112:115], v[48:51]
buffer_load_dwordx4 a[64:67], v233, s[16:19], s72 offen offset:0 sc1
v_mfma_f32_16x16x32_bf16 v[52:55], a[220:223], a[116:119], v[52:55]
ds_read_b64_tr_b16 a[202:203], v217 offset:20480
v_mfma_f32_16x16x32_bf16 v[52:55], a[216:219], a[100:103], v[52:55]
ds_read_b64_tr_b16 a[204:205], v217 offset:24576
v_mfma_f32_16x16x32_bf16 v[56:59], a[216:219], a[104:107], v[56:59]
v_mfma_f32_16x16x32_bf16 v[56:59], a[220:223], a[120:123], v[56:59]
ds_read_b64_tr_b16 a[206:207], v217 offset:28672
v_mfma_f32_16x16x32_bf16 v[60:63], a[220:223], a[124:127], v[60:63]
v_mfma_f32_16x16x32_bf16 v[60:63], a[216:219], a[108:111], v[60:63]
s_waitcnt lgkmcnt(8)
v_mfma_f32_16x16x32_bf16 v[64:67], a[224:227], a[96:99], v[64:67]
buffer_load_dwordx4 a[68:71], v233, s[16:19], s72 offen offset:1024 sc1
v_mfma_f32_16x16x32_bf16 v[64:67], a[228:231], a[112:115], v[64:67]
ds_read_b64_tr_b16 a[208:209], v218 offset:16384
ds_read_b64_tr_b16 a[210:211], v218 offset:20480
v_mfma_f32_16x16x32_bf16 v[68:71], a[228:231], a[116:119], v[68:71]
v_mfma_f32_16x16x32_bf16 v[68:71], a[224:227], a[100:103], v[68:71]
buffer_load_dwordx4 v241, s[24:27], s71 offen offset:1024 lds
v_mfma_f32_16x16x32_bf16 v[72:75], a[224:227], a[104:107], v[72:75]
s_xor_b32 s41, s72, 2048
ds_read_b64_tr_b16 a[212:213], v218 offset:24576
v_mfma_f32_16x16x32_bf16 v[72:75], a[228:231], a[120:123], v[72:75]
ds_read_b64_tr_b16 a[214:215], v218 offset:28672
v_mfma_f32_16x16x32_bf16 v[76:79], a[228:231], a[124:127], v[76:79]
v_mfma_f32_16x16x32_bf16 v[76:79], a[224:227], a[108:111], v[76:79]
buffer_load_dwordx4 a[72:75], v233, s[16:19], s41 offen offset:0 sc1
v_mfma_f32_16x16x32_bf16 v[80:83], a[232:235], a[96:99], v[80:83]
ds_read_b64_tr_b16 a[216:217], v219 offset:16384
v_mfma_f32_16x16x32_bf16 v[80:83], a[236:239], a[112:115], v[80:83]
ds_read_b64_tr_b16 a[218:219], v219 offset:20480
v_mfma_f32_16x16x32_bf16 v[84:87], a[236:239], a[116:119], v[84:87]
v_mfma_f32_16x16x32_bf16 v[84:87], a[232:235], a[100:103], v[84:87]
buffer_load_dwordx4 a[76:79], v233, s[16:19], s41 offen offset:1024 sc1
v_mfma_f32_16x16x32_bf16 v[88:91], a[232:235], a[104:107], v[88:91]
s_add_u32 s72, s72, 4096
ds_read_b64_tr_b16 a[220:221], v219 offset:24576
v_mfma_f32_16x16x32_bf16 v[88:91], a[236:239], a[120:123], v[88:91]
ds_read_b64_tr_b16 a[222:223], v219 offset:28672
v_mfma_f32_16x16x32_bf16 v[92:95], a[236:239], a[124:127], v[92:95]
v_mfma_f32_16x16x32_bf16 v[92:95], a[232:235], a[108:111], v[92:95]
buffer_load_dwordx4 a[80:83], v233, s[16:19], s72 offen offset:0 sc1
v_mfma_f32_16x16x32_bf16 v[96:99], a[240:243], a[96:99], v[96:99]
ds_read_b64_tr_b16 a[224:225], v220 offset:16384
v_mfma_f32_16x16x32_bf16 v[96:99], a[244:247], a[112:115], v[96:99]
ds_read_b64_tr_b16 a[226:227], v220 offset:20480
v_mfma_f32_16x16x32_bf16 v[100:103], a[244:247], a[116:119], v[100:103]
buffer_load_dwordx4 a[84:87], v233, s[16:19], s72 offen offset:1024 sc1
v_mfma_f32_16x16x32_bf16 v[100:103], a[240:243], a[100:103], v[100:103]
s_xor_b32 s41, s72, 2048
ds_read_b64_tr_b16 a[228:229], v220 offset:24576
v_mfma_f32_16x16x32_bf16 v[104:107], a[240:243], a[104:107], v[104:107]
v_mfma_f32_16x16x32_bf16 v[104:107], a[244:247], a[120:123], v[104:107]
ds_read_b64_tr_b16 a[230:231], v220 offset:28672
v_mfma_f32_16x16x32_bf16 v[108:111], a[244:247], a[124:127], v[108:111]
buffer_load_dwordx4 a[88:91], v233, s[16:19], s41 offen offset:0 sc1
v_mfma_f32_16x16x32_bf16 v[108:111], a[240:243], a[108:111], v[108:111]
ds_read_b64_tr_b16 a[232:233], v221 offset:16384
v_mfma_f32_16x16x32_bf16 v[112:115], a[248:251], a[96:99], v[112:115]
v_mfma_f32_16x16x32_bf16 v[112:115], a[252:255], a[112:115], v[112:115]
ds_read_b64_tr_b16 a[234:235], v221 offset:20480
v_mfma_f32_16x16x32_bf16 v[116:119], a[252:255], a[116:119], v[116:119]
buffer_load_dwordx4 a[92:95], v233, s[16:19], s41 offen offset:1024 sc1
v_mfma_f32_16x16x32_bf16 v[116:119], a[248:251], a[100:103], v[116:119]
ds_read_b64_tr_b16 a[236:237], v221 offset:24576
v_mfma_f32_16x16x32_bf16 v[120:123], a[248:251], a[104:107], v[120:123]
v_mfma_f32_16x16x32_bf16 v[120:123], a[252:255], a[120:123], v[120:123]
ds_read_b64_tr_b16 a[238:239], v221 offset:28672
v_mfma_f32_16x16x32_bf16 v[124:127], a[252:255], a[124:127], v[124:127]
v_mfma_f32_16x16x32_bf16 v[124:127], a[248:251], a[108:111], v[124:127]
s_waitcnt vmcnt(42) lgkmcnt(8)
s_barrier
v_mfma_f32_16x16x32_bf16 v[0:3], a[192:195], a[128:131], v[0:3]
s_add_u32 m0, s70, 49152
ds_read_b64_tr_b16 a[240:241], v222 offset:16384
v_mfma_f32_16x16x32_bf16 v[0:3], a[196:199], a[144:147], v[0:3]
s_add_u32 s71, s71, 65536
buffer_load_dwordx4 v240, s[24:27], s71 offen lds
v_mfma_f32_16x16x32_bf16 v[4:7], a[196:199], a[148:151], v[4:7]
ds_read_b64_tr_b16 a[242:243], v222 offset:20480
v_mfma_f32_16x16x32_bf16 v[4:7], a[192:195], a[132:135], v[4:7]
ds_read_b64_tr_b16 a[244:245], v222 offset:24576
v_mfma_f32_16x16x32_bf16 v[8:11], a[192:195], a[136:139], v[8:11]
buffer_load_dwordx4 v241, s[24:27], s71 offen offset:1024 lds
v_mfma_f32_16x16x32_bf16 v[8:11], a[196:199], a[152:155], v[8:11]
s_add_u32 m0, s70, 57344
ds_read_b64_tr_b16 a[246:247], v222 offset:28672
v_mfma_f32_16x16x32_bf16 v[12:15], a[196:199], a[156:159], v[12:15]
s_add_u32 s71, s71, 65536
v_mfma_f32_16x16x32_bf16 v[12:15], a[192:195], a[140:143], v[12:15]
ds_read_b64_tr_b16 a[248:249], v223 offset:16384
v_mfma_f32_16x16x32_bf16 v[16:19], a[200:203], a[128:131], v[16:19]
buffer_load_dwordx4 v240, s[24:27], s71 offen lds
v_mfma_f32_16x16x32_bf16 v[16:19], a[204:207], a[144:147], v[16:19]
s_add_u32 s72, s72, 4096
ds_read_b64_tr_b16 a[250:251], v223 offset:20480
v_mfma_f32_16x16x32_bf16 v[20:23], a[204:207], a[148:151], v[20:23]
v_mfma_f32_16x16x32_bf16 v[20:23], a[200:203], a[132:135], v[20:23]
ds_read_b64_tr_b16 a[252:253], v223 offset:24576
v_mfma_f32_16x16x32_bf16 v[24:27], a[200:203], a[136:139], v[24:27]
buffer_load_dwordx4 a[96:99], v233, s[16:19], s72 offen offset:0 sc1
v_mfma_f32_16x16x32_bf16 v[24:27], a[204:207], a[152:155], v[24:27]
ds_read_b64_tr_b16 a[254:255], v223 offset:28672
v_mfma_f32_16x16x32_bf16 v[28:31], a[204:207], a[156:159], v[28:31]
v_mfma_f32_16x16x32_bf16 v[28:31], a[200:203], a[140:143], v[28:31]
ds_read_b64_tr_b16 a[192:193], v216 offset:32768
v_mfma_f32_16x16x32_bf16 v[32:35], a[208:211], a[128:131], v[32:35]
v_mfma_f32_16x16x32_bf16 v[32:35], a[212:215], a[144:147], v[32:35]
buffer_load_dwordx4 a[100:103], v233, s[16:19], s72 offen offset:1024 sc1
v_mfma_f32_16x16x32_bf16 v[36:39], a[212:215], a[148:151], v[36:39]
ds_read_b64_tr_b16 a[194:195], v216 offset:36864
v_mfma_f32_16x16x32_bf16 v[36:39], a[208:211], a[132:135], v[36:39]
ds_read_b64_tr_b16 a[196:197], v216 offset:40960
v_mfma_f32_16x16x32_bf16 v[40:43], a[208:211], a[136:139], v[40:43]
v_mfma_f32_16x16x32_bf16 v[40:43], a[212:215], a[152:155], v[40:43]
buffer_load_dwordx4 v241, s[24:27], s71 offen offset:1024 lds
v_mfma_f32_16x16x32_bf16 v[44:47], a[212:215], a[156:159], v[44:47]
s_xor_b32 s41, s72, 2048
ds_read_b64_tr_b16 a[198:199], v216 offset:45056
v_mfma_f32_16x16x32_bf16 v[44:47], a[208:211], a[140:143], v[44:47]
ds_read_b64_tr_b16 a[200:201], v217 offset:32768
v_mfma_f32_16x16x32_bf16 v[48:51], a[216:219], a[128:131], v[48:51]
v_mfma_f32_16x16x32_bf16 v[48:51], a[220:223], a[144:147], v[48:51]
buffer_load_dwordx4 a[104:107], v233, s[16:19], s41 offen offset:0 sc1
v_mfma_f32_16x16x32_bf16 v[52:55], a[220:223], a[148:151], v[52:55]
ds_read_b64_tr_b16 a[202:203], v217 offset:36864
v_mfma_f32_16x16x32_bf16 v[52:55], a[216:219], a[132:135], v[52:55]
ds_read_b64_tr_b16 a[204:205], v217 offset:40960
v_mfma_f32_16x16x32_bf16 v[56:59], a[216:219], a[136:139], v[56:59]
v_mfma_f32_16x16x32_bf16 v[56:59], a[220:223], a[152:155], v[56:59]
ds_read_b64_tr_b16 a[206:207], v217 offset:45056
v_mfma_f32_16x16x32_bf16 v[60:63], a[220:223], a[156:159], v[60:63]
v_mfma_f32_16x16x32_bf16 v[60:63], a[216:219], a[140:143], v[60:63]
s_waitcnt lgkmcnt(8)
v_mfma_f32_16x16x32_bf16 v[64:67], a[224:227], a[128:131], v[64:67]
buffer_load_dwordx4 a[108:111], v233, s[16:19], s41 offen offset:1024 sc1
v_mfma_f32_16x16x32_bf16 v[64:67], a[228:231], a[144:147], v[64:67]
s_add_u32 s72, s72, 4096
ds_read_b64_tr_b16 a[208:209], v218 offset:32768
ds_read_b64_tr_b16 a[210:211], v218 offset:36864
v_mfma_f32_16x16x32_bf16 v[68:71], a[228:231], a[148:151], v[68:71]
v_mfma_f32_16x16x32_bf16 v[68:71], a[224:227], a[132:135], v[68:71]
ds_read_b64_tr_b16 a[212:213], v218 offset:40960
v_mfma_f32_16x16x32_bf16 v[72:75], a[224:227], a[136:139], v[72:75]
v_mfma_f32_16x16x32_bf16 v[72:75], a[228:231], a[152:155], v[72:75]
ds_read_b64_tr_b16 a[214:215], v218 offset:45056
v_mfma_f32_16x16x32_bf16 v[76:79], a[228:231], a[156:159], v[76:79]
buffer_load_dwordx4 a[112:115], v233, s[16:19], s72 offen offset:0 sc1
v_mfma_f32_16x16x32_bf16 v[76:79], a[224:227], a[140:143], v[76:79]
ds_read_b64_tr_b16 a[216:217], v219 offset:32768
v_mfma_f32_16x16x32_bf16 v[80:83], a[232:235], a[128:131], v[80:83]
v_mfma_f32_16x16x32_bf16 v[80:83], a[236:239], a[144:147], v[80:83]
ds_read_b64_tr_b16 a[218:219], v219 offset:36864
v_mfma_f32_16x16x32_bf16 v[84:87], a[236:239], a[148:151], v[84:87]
v_mfma_f32_16x16x32_bf16 v[84:87], a[232:235], a[132:135], v[84:87]
ds_read_b64_tr_b16 a[220:221], v219 offset:40960
v_mfma_f32_16x16x32_bf16 v[88:91], a[232:235], a[136:139], v[88:91]
buffer_load_dwordx4 a[116:119], v233, s[16:19], s72 offen offset:1024 sc1
v_mfma_f32_16x16x32_bf16 v[88:91], a[236:239], a[152:155], v[88:91]
s_xor_b32 s41, s72, 2048
ds_read_b64_tr_b16 a[222:223], v219 offset:45056
v_mfma_f32_16x16x32_bf16 v[92:95], a[236:239], a[156:159], v[92:95]
v_mfma_f32_16x16x32_bf16 v[92:95], a[232:235], a[140:143], v[92:95]
ds_read_b64_tr_b16 a[224:225], v220 offset:32768
v_mfma_f32_16x16x32_bf16 v[96:99], a[240:243], a[128:131], v[96:99]
v_mfma_f32_16x16x32_bf16 v[96:99], a[244:247], a[144:147], v[96:99]
ds_read_b64_tr_b16 a[226:227], v220 offset:36864
v_mfma_f32_16x16x32_bf16 v[100:103], a[244:247], a[148:151], v[100:103]
buffer_load_dwordx4 a[120:123], v233, s[16:19], s41 offen offset:0 sc1
v_mfma_f32_16x16x32_bf16 v[100:103], a[240:243], a[132:135], v[100:103]
ds_read_b64_tr_b16 a[228:229], v220 offset:40960
v_mfma_f32_16x16x32_bf16 v[104:107], a[240:243], a[136:139], v[104:107]
v_mfma_f32_16x16x32_bf16 v[104:107], a[244:247], a[152:155], v[104:107]
ds_read_b64_tr_b16 a[230:231], v220 offset:45056
v_mfma_f32_16x16x32_bf16 v[108:111], a[244:247], a[156:159], v[108:111]
v_mfma_f32_16x16x32_bf16 v[108:111], a[240:243], a[140:143], v[108:111]
ds_read_b64_tr_b16 a[232:233], v221 offset:32768
v_mfma_f32_16x16x32_bf16 v[112:115], a[248:251], a[128:131], v[112:115]
buffer_load_dwordx4 a[124:127], v233, s[16:19], s41 offen offset:1024 sc1
v_mfma_f32_16x16x32_bf16 v[112:115], a[252:255], a[144:147], v[112:115]
ds_read_b64_tr_b16 a[234:235], v221 offset:36864
v_mfma_f32_16x16x32_bf16 v[116:119], a[252:255], a[148:151], v[116:119]
v_mfma_f32_16x16x32_bf16 v[116:119], a[248:251], a[132:135], v[116:119]
ds_read_b64_tr_b16 a[236:237], v221 offset:40960
v_mfma_f32_16x16x32_bf16 v[120:123], a[248:251], a[136:139], v[120:123]
v_mfma_f32_16x16x32_bf16 v[120:123], a[252:255], a[152:155], v[120:123]
ds_read_b64_tr_b16 a[238:239], v221 offset:45056
v_mfma_f32_16x16x32_bf16 v[124:127], a[252:255], a[156:159], v[124:127]
v_mfma_f32_16x16x32_bf16 v[124:127], a[248:251], a[140:143], v[124:127]
s_waitcnt vmcnt(42) lgkmcnt(8)
s_barrier
v_mfma_f32_16x16x32_bf16 v[0:3], a[192:195], a[160:163], v[0:3]
s_add_u32 m0, s70, 65536
ds_read_b64_tr_b16 a[240:241], v222 offset:32768
v_mfma_f32_16x16x32_bf16 v[0:3], a[196:199], a[176:179], v[0:3]
s_add_u32 s71, s71, 65536
buffer_load_dwordx4 v240, s[24:27], s71 offen lds
v_mfma_f32_16x16x32_bf16 v[4:7], a[196:199], a[180:183], v[4:7]
ds_read_b64_tr_b16 a[242:243], v222 offset:36864
v_mfma_f32_16x16x32_bf16 v[4:7], a[192:195], a[164:167], v[4:7]
buffer_load_dwordx4 v241, s[24:27], s71 offen offset:1024 lds
v_mfma_f32_16x16x32_bf16 v[8:11], a[192:195], a[168:171], v[8:11]
s_add_u32 m0, s70, 73728
ds_read_b64_tr_b16 a[244:245], v222 offset:40960
v_mfma_f32_16x16x32_bf16 v[8:11], a[196:199], a[184:187], v[8:11]
s_add_u32 s71, s71, 65536
ds_read_b64_tr_b16 a[246:247], v222 offset:45056
v_mfma_f32_16x16x32_bf16 v[12:15], a[196:199], a[188:191], v[12:15]
v_mfma_f32_16x16x32_bf16 v[12:15], a[192:195], a[172:175], v[12:15]
buffer_load_dwordx4 v240, s[24:27], s71 offen lds
v_mfma_f32_16x16x32_bf16 v[16:19], a[200:203], a[160:163], v[16:19]
s_add_u32 s72, s72, 4096
ds_read_b64_tr_b16 a[248:249], v223 offset:32768
v_mfma_f32_16x16x32_bf16 v[16:19], a[204:207], a[176:179], v[16:19]
ds_read_b64_tr_b16 a[250:251], v223 offset:36864
v_mfma_f32_16x16x32_bf16 v[20:23], a[204:207], a[180:183], v[20:23]
v_mfma_f32_16x16x32_bf16 v[20:23], a[200:203], a[164:167], v[20:23]
buffer_load_dwordx4 a[128:131], v233, s[16:19], s72 offen offset:0 sc1
v_mfma_f32_16x16x32_bf16 v[24:27], a[200:203], a[168:171], v[24:27]
ds_read_b64_tr_b16 a[252:253], v223 offset:40960
v_mfma_f32_16x16x32_bf16 v[24:27], a[204:207], a[184:187], v[24:27]
ds_read_b64_tr_b16 a[254:255], v223 offset:45056
v_mfma_f32_16x16x32_bf16 v[28:31], a[204:207], a[188:191], v[28:31]
v_mfma_f32_16x16x32_bf16 v[28:31], a[200:203], a[172:175], v[28:31]
buffer_load_dwordx4 a[132:135], v233, s[16:19], s72 offen offset:1024 sc1
v_mfma_f32_16x16x32_bf16 v[32:35], a[208:211], a[160:163], v[32:35]
ds_read_b64_tr_b16 a[192:193], v208 offset:0
v_mfma_f32_16x16x32_bf16 v[32:35], a[212:215], a[176:179], v[32:35]
ds_read_b64_tr_b16 a[194:195], v208 offset:4096
v_mfma_f32_16x16x32_bf16 v[36:39], a[212:215], a[180:183], v[36:39]
buffer_load_dwordx4 v241, s[24:27], s71 offen offset:1024 lds
v_mfma_f32_16x16x32_bf16 v[36:39], a[208:211], a[164:167], v[36:39]
s_xor_b32 s41, s72, 2048
ds_read_b64_tr_b16 a[196:197], v208 offset:8192
v_mfma_f32_16x16x32_bf16 v[40:43], a[208:211], a[168:171], v[40:43]
v_mfma_f32_16x16x32_bf16 v[40:43], a[212:215], a[184:187], v[40:43]
ds_read_b64_tr_b16 a[198:199], v208 offset:12288
v_mfma_f32_16x16x32_bf16 v[44:47], a[212:215], a[188:191], v[44:47]
buffer_load_dwordx4 a[136:139], v233, s[16:19], s41 offen offset:0 sc1
v_mfma_f32_16x16x32_bf16 v[44:47], a[208:211], a[172:175], v[44:47]
ds_read_b64_tr_b16 a[200:201], v209 offset:0
v_mfma_f32_16x16x32_bf16 v[48:51], a[216:219], a[160:163], v[48:51]
v_mfma_f32_16x16x32_bf16 v[48:51], a[220:223], a[176:179], v[48:51]
ds_read_b64_tr_b16 a[202:203], v209 offset:4096
v_mfma_f32_16x16x32_bf16 v[52:55], a[220:223], a[180:183], v[52:55]
buffer_load_dwordx4 a[140:143], v233, s[16:19], s41 offen offset:1024 sc1
v_mfma_f32_16x16x32_bf16 v[52:55], a[216:219], a[164:167], v[52:55]
ds_read_b64_tr_b16 a[204:205], v209 offset:8192
v_mfma_f32_16x16x32_bf16 v[56:59], a[216:219], a[168:171], v[56:59]
v_mfma_f32_16x16x32_bf16 v[56:59], a[220:223], a[184:187], v[56:59]
ds_read_b64_tr_b16 a[206:207], v209 offset:12288
v_mfma_f32_16x16x32_bf16 v[60:63], a[220:223], a[188:191], v[60:63]
v_mfma_f32_16x16x32_bf16 v[60:63], a[216:219], a[172:175], v[60:63]
s_waitcnt lgkmcnt(8)
v_mfma_f32_16x16x32_bf16 v[64:67], a[224:227], a[160:163], v[64:67]
s_add_u32 s72, s72, 4096
buffer_load_dwordx4 a[144:147], v233, s[16:19], s72 offen offset:0 sc1
v_mfma_f32_16x16x32_bf16 v[64:67], a[228:231], a[176:179], v[64:67]
ds_read_b64_tr_b16 a[208:209], v210 offset:0
ds_read_b64_tr_b16 a[210:211], v210 offset:4096
v_mfma_f32_16x16x32_bf16 v[68:71], a[228:231], a[180:183], v[68:71]
v_mfma_f32_16x16x32_bf16 v[68:71], a[224:227], a[164:167], v[68:71]
ds_read_b64_tr_b16 a[212:213], v210 offset:8192
v_mfma_f32_16x16x32_bf16 v[72:75], a[224:227], a[168:171], v[72:75]
v_mfma_f32_16x16x32_bf16 v[72:75], a[228:231], a[184:187], v[72:75]
ds_read_b64_tr_b16 a[214:215], v210 offset:12288
v_mfma_f32_16x16x32_bf16 v[76:79], a[228:231], a[188:191], v[76:79]
v_mfma_f32_16x16x32_bf16 v[76:79], a[224:227], a[172:175], v[76:79]
buffer_load_dwordx4 a[148:151], v233, s[16:19], s72 offen offset:1024 sc1
v_mfma_f32_16x16x32_bf16 v[80:83], a[232:235], a[160:163], v[80:83]
s_xor_b32 s41, s72, 2048
ds_read_b64_tr_b16 a[216:217], v211 offset:0
v_mfma_f32_16x16x32_bf16 v[80:83], a[236:239], a[176:179], v[80:83]
ds_read_b64_tr_b16 a[218:219], v211 offset:4096
v_mfma_f32_16x16x32_bf16 v[84:87], a[236:239], a[180:183], v[84:87]
v_mfma_f32_16x16x32_bf16 v[84:87], a[232:235], a[164:167], v[84:87]
ds_read_b64_tr_b16 a[220:221], v211 offset:8192
v_mfma_f32_16x16x32_bf16 v[88:91], a[232:235], a[168:171], v[88:91]
v_mfma_f32_16x16x32_bf16 v[88:91], a[236:239], a[184:187], v[88:91]
ds_read_b64_tr_b16 a[222:223], v211 offset:12288
v_mfma_f32_16x16x32_bf16 v[92:95], a[236:239], a[188:191], v[92:95]
v_mfma_f32_16x16x32_bf16 v[92:95], a[232:235], a[172:175], v[92:95]
buffer_load_dwordx4 a[152:155], v233, s[16:19], s41 offen offset:0 sc1
v_mfma_f32_16x16x32_bf16 v[96:99], a[240:243], a[160:163], v[96:99]
ds_read_b64_tr_b16 a[224:225], v212 offset:0
v_mfma_f32_16x16x32_bf16 v[96:99], a[244:247], a[176:179], v[96:99]
ds_read_b64_tr_b16 a[226:227], v212 offset:4096
v_mfma_f32_16x16x32_bf16 v[100:103], a[244:247], a[180:183], v[100:103]
v_mfma_f32_16x16x32_bf16 v[100:103], a[240:243], a[164:167], v[100:103]
ds_read_b64_tr_b16 a[228:229], v212 offset:8192
v_mfma_f32_16x16x32_bf16 v[104:107], a[240:243], a[168:171], v[104:107]
v_mfma_f32_16x16x32_bf16 v[104:107], a[244:247], a[184:187], v[104:107]
ds_read_b64_tr_b16 a[230:231], v212 offset:12288
v_mfma_f32_16x16x32_bf16 v[108:111], a[244:247], a[188:191], v[108:111]
buffer_load_dwordx4 a[156:159], v233, s[16:19], s41 offen offset:1024 sc1
v_mfma_f32_16x16x32_bf16 v[108:111], a[240:243], a[172:175], v[108:111]
ds_read_b64_tr_b16 a[232:233], v213 offset:0
v_mfma_f32_16x16x32_bf16 v[112:115], a[248:251], a[160:163], v[112:115]
v_mfma_f32_16x16x32_bf16 v[112:115], a[252:255], a[176:179], v[112:115]
ds_read_b64_tr_b16 a[234:235], v213 offset:4096
v_mfma_f32_16x16x32_bf16 v[116:119], a[252:255], a[180:183], v[116:119]
v_mfma_f32_16x16x32_bf16 v[116:119], a[248:251], a[164:167], v[116:119]
ds_read_b64_tr_b16 a[236:237], v213 offset:8192
v_mfma_f32_16x16x32_bf16 v[120:123], a[248:251], a[168:171], v[120:123]
v_mfma_f32_16x16x32_bf16 v[120:123], a[252:255], a[184:187], v[120:123]
ds_read_b64_tr_b16 a[238:239], v213 offset:12288
v_mfma_f32_16x16x32_bf16 v[124:127], a[252:255], a[188:191], v[124:127]
v_mfma_f32_16x16x32_bf16 v[124:127], a[248:251], a[172:175], v[124:127]
s_waitcnt vmcnt(6) lgkmcnt(8)
s_barrier
v_mfma_f32_16x16x32_bf16 v[0:3], a[192:195], a[0:3], v[0:3]
s_lshl_b32 s70, s3, 10
ds_read_b64_tr_b16 a[240:241], v214 offset:0
v_mfma_f32_16x16x32_bf16 v[0:3], a[196:199], a[16:19], v[0:3]
s_add_u32 s70, s70, 32768
ds_read_b64_tr_b16 a[242:243], v214 offset:4096
v_mfma_f32_16x16x32_bf16 v[4:7], a[196:199], a[20:23], v[4:7]
s_add_u32 m0, s70, 81920
v_mfma_f32_16x16x32_bf16 v[4:7], a[192:195], a[4:7], v[4:7]
s_bfe_u32 s71, s78, 0x40010
ds_read_b64_tr_b16 a[244:245], v214 offset:8192
v_mfma_f32_16x16x32_bf16 v[8:11], a[192:195], a[8:11], v[8:11]
s_mul_i32 s71, s71, 131072
v_mfma_f32_16x16x32_bf16 v[8:11], a[196:199], a[24:27], v[8:11]
s_add_u32 s71, s71, 1572864
buffer_load_dwordx4 v244, s[24:27], s71 offen lds
v_mfma_f32_16x16x32_bf16 v[12:15], a[196:199], a[28:31], v[12:15]
s_add_u32 m0, s70, 86016
ds_read_b64_tr_b16 a[246:247], v214 offset:12288
v_mfma_f32_16x16x32_bf16 v[12:15], a[192:195], a[12:15], v[12:15]
s_add_u32 s71, s71, 65536
buffer_load_dwordx4 v244, s[24:27], s71 offen lds
v_mfma_f32_16x16x32_bf16 v[16:19], a[200:203], a[0:3], v[16:19]
s_add_u32 m0, s70, 90112
ds_read_b64_tr_b16 a[248:249], v215 offset:0
v_mfma_f32_16x16x32_bf16 v[16:19], a[204:207], a[16:19], v[16:19]
s_bfe_u32 s71, s78, 0x40014
ds_read_b64_tr_b16 a[250:251], v215 offset:4096
v_mfma_f32_16x16x32_bf16 v[20:23], a[204:207], a[20:23], v[20:23]
s_mul_i32 s71, s71, 131072
v_mfma_f32_16x16x32_bf16 v[20:23], a[200:203], a[4:7], v[20:23]
s_add_u32 s71, s71, 1572864
buffer_load_dwordx4 v244, s[24:27], s71 offen lds
v_mfma_f32_16x16x32_bf16 v[24:27], a[200:203], a[8:11], v[24:27]
s_bfe_u32 s72, s78, 0x40010
ds_read_b64_tr_b16 a[252:253], v215 offset:8192
v_mfma_f32_16x16x32_bf16 v[24:27], a[204:207], a[24:27], v[24:27]
s_mul_i32 s72, s72, 8192
ds_read_b64_tr_b16 a[254:255], v215 offset:12288
v_mfma_f32_16x16x32_bf16 v[28:31], a[204:207], a[28:31], v[28:31]
s_add_u32 s72, s72, s80
v_mfma_f32_16x16x32_bf16 v[28:31], a[200:203], a[12:15], v[28:31]
s_add_u32 s72, s72, 557056
buffer_load_dwordx4 a[160:163], v233, s[16:19], s72 offen offset:0 sc1
v_mfma_f32_16x16x32_bf16 v[32:35], a[208:211], a[0:3], v[32:35]
buffer_load_dwordx4 a[164:167], v233, s[16:19], s72 offen offset:1024 sc1
v_mfma_f32_16x16x32_bf16 v[32:35], a[212:215], a[16:19], v[32:35]
s_add_u32 m0, s70, 94208
ds_read_b64_tr_b16 a[192:193], v212 offset:16384
ds_read_b64_tr_b16 a[194:195], v212 offset:20480
v_mfma_f32_16x16x32_bf16 v[36:39], a[212:215], a[20:23], v[36:39]
s_add_u32 s71, s71, 65536
buffer_load_dwordx4 v244, s[24:27], s71 offen lds
v_mfma_f32_16x16x32_bf16 v[36:39], a[208:211], a[4:7], v[36:39]
s_add_u32 s72, s72, 4096
ds_read_b64_tr_b16 a[196:197], v212 offset:24576
v_mfma_f32_16x16x32_bf16 v[40:43], a[208:211], a[8:11], v[40:43]
v_mfma_f32_16x16x32_bf16 v[40:43], a[212:215], a[24:27], v[40:43]
ds_read_b64_tr_b16 a[198:199], v212 offset:28672
v_mfma_f32_16x16x32_bf16 v[44:47], a[212:215], a[28:31], v[44:47]
buffer_load_dwordx4 a[168:171], v233, s[16:19], s72 offen offset:0 sc1
v_mfma_f32_16x16x32_bf16 v[44:47], a[208:211], a[12:15], v[44:47]
ds_read_b64_tr_b16 a[200:201], v212 offset:32768
v_mfma_f32_16x16x32_bf16 v[48:51], a[216:219], a[0:3], v[48:51]
v_mfma_f32_16x16x32_bf16 v[48:51], a[220:223], a[16:19], v[48:51]
ds_read_b64_tr_b16 a[202:203], v212 offset:36864
v_mfma_f32_16x16x32_bf16 v[52:55], a[220:223], a[20:23], v[52:55]
buffer_load_dwordx4 a[172:175], v233, s[16:19], s72 offen offset:1024 sc1
v_mfma_f32_16x16x32_bf16 v[52:55], a[216:219], a[4:7], v[52:55]
ds_read_b64_tr_b16 a[204:205], v212 offset:40960
v_mfma_f32_16x16x32_bf16 v[56:59], a[216:219], a[8:11], v[56:59]
v_mfma_f32_16x16x32_bf16 v[56:59], a[220:223], a[24:27], v[56:59]
ds_read_b64_tr_b16 a[206:207], v212 offset:45056
v_mfma_f32_16x16x32_bf16 v[60:63], a[220:223], a[28:31], v[60:63]
v_mfma_f32_16x16x32_bf16 v[60:63], a[216:219], a[12:15], v[60:63]
s_waitcnt lgkmcnt(8)
v_mfma_f32_16x16x32_bf16 v[64:67], a[224:227], a[0:3], v[64:67]
Lpad11:
s_cbranch_execz Lwarm_done
s_bfe_u32 s72, s78, 0x40014
ds_read_b64_tr_b16 a[208:209], v213 offset:16384
v_mfma_f32_16x16x32_bf16 v[64:67], a[228:231], a[16:19], v[64:67]
s_mul_i32 s72, s72, 8192
ds_read_b64_tr_b16 a[210:211], v213 offset:20480
v_mfma_f32_16x16x32_bf16 v[68:71], a[228:231], a[20:23], v[68:71]
s_add_u32 s72, s72, s80
v_mfma_f32_16x16x32_bf16 v[68:71], a[224:227], a[4:7], v[68:71]
s_add_u32 s72, s72, 557056
buffer_load_dwordx4 a[176:179], v233, s[16:19], s72 offen offset:0 sc1
v_mfma_f32_16x16x32_bf16 v[72:75], a[224:227], a[8:11], v[72:75]
ds_read_b64_tr_b16 a[212:213], v213 offset:24576
v_mfma_f32_16x16x32_bf16 v[72:75], a[228:231], a[24:27], v[72:75]
ds_read_b64_tr_b16 a[214:215], v213 offset:28672
v_mfma_f32_16x16x32_bf16 v[76:79], a[228:231], a[28:31], v[76:79]
v_mfma_f32_16x16x32_bf16 v[76:79], a[224:227], a[12:15], v[76:79]
buffer_load_dwordx4 a[180:183], v233, s[16:19], s72 offen offset:1024 sc1
v_mfma_f32_16x16x32_bf16 v[80:83], a[232:235], a[0:3], v[80:83]
s_add_u32 s72, s72, 4096
ds_read_b64_tr_b16 a[216:217], v213 offset:32768
v_mfma_f32_16x16x32_bf16 v[80:83], a[236:239], a[16:19], v[80:83]
ds_read_b64_tr_b16 a[218:219], v213 offset:36864
v_mfma_f32_16x16x32_bf16 v[84:87], a[236:239], a[20:23], v[84:87]
v_mfma_f32_16x16x32_bf16 v[84:87], a[232:235], a[4:7], v[84:87]
ds_read_b64_tr_b16 a[220:221], v213 offset:40960
v_mfma_f32_16x16x32_bf16 v[88:91], a[232:235], a[8:11], v[88:91]
v_mfma_f32_16x16x32_bf16 v[88:91], a[236:239], a[24:27], v[88:91]
ds_read_b64_tr_b16 a[222:223], v213 offset:45056
v_mfma_f32_16x16x32_bf16 v[92:95], a[236:239], a[28:31], v[92:95]
v_mfma_f32_16x16x32_bf16 v[92:95], a[232:235], a[12:15], v[92:95]
buffer_load_dwordx4 a[184:187], v233, s[16:19], s72 offen offset:0 sc1
v_mfma_f32_16x16x32_bf16 v[96:99], a[240:243], a[0:3], v[96:99]
ds_read_b64_tr_b16 a[224:225], v220 offset:0
v_mfma_f32_16x16x32_bf16 v[96:99], a[244:247], a[16:19], v[96:99]
ds_read_b64_tr_b16 a[226:227], v220 offset:4096
v_mfma_f32_16x16x32_bf16 v[100:103], a[244:247], a[20:23], v[100:103]
v_mfma_f32_16x16x32_bf16 v[100:103], a[240:243], a[4:7], v[100:103]
ds_read_b64_tr_b16 a[228:229], v220 offset:8192
v_mfma_f32_16x16x32_bf16 v[104:107], a[240:243], a[8:11], v[104:107]
v_mfma_f32_16x16x32_bf16 v[104:107], a[244:247], a[24:27], v[104:107]
ds_read_b64_tr_b16 a[230:231], v220 offset:12288
v_mfma_f32_16x16x32_bf16 v[108:111], a[244:247], a[28:31], v[108:111]
buffer_load_dwordx4 a[188:191], v233, s[16:19], s72 offen offset:1024 sc1
v_mfma_f32_16x16x32_bf16 v[108:111], a[240:243], a[12:15], v[108:111]
ds_read_b64_tr_b16 a[232:233], v220 offset:16384
v_mfma_f32_16x16x32_bf16 v[112:115], a[248:251], a[0:3], v[112:115]
v_mfma_f32_16x16x32_bf16 v[112:115], a[252:255], a[16:19], v[112:115]
ds_read_b64_tr_b16 a[234:235], v220 offset:20480
v_mfma_f32_16x16x32_bf16 v[116:119], a[252:255], a[20:23], v[116:119]
v_mfma_f32_16x16x32_bf16 v[116:119], a[248:251], a[4:7], v[116:119]
ds_read_b64_tr_b16 a[236:237], v220 offset:24576
v_mfma_f32_16x16x32_bf16 v[120:123], a[248:251], a[8:11], v[120:123]
v_mfma_f32_16x16x32_bf16 v[120:123], a[252:255], a[24:27], v[120:123]
ds_read_b64_tr_b16 a[238:239], v220 offset:28672
v_mfma_f32_16x16x32_bf16 v[124:127], a[252:255], a[28:31], v[124:127]
v_mfma_f32_16x16x32_bf16 v[124:127], a[248:251], a[12:15], v[124:127]
s_waitcnt lgkmcnt(8)
s_barrier
v_mfma_f32_16x16x32_bf16 v[64:67], a[192:195], a[32:35], v[64:67]
s_add_u32 m0, s70, 0
ds_read_b64_tr_b16 a[240:241], v221 offset:0
v_mfma_f32_16x16x32_bf16 v[64:67], a[196:199], a[48:51], v[64:67]
s_bfe_u32 s71, s78, 0x40018
ds_read_b64_tr_b16 a[242:243], v221 offset:4096
v_mfma_f32_16x16x32_bf16 v[64:67], a[200:203], a[64:67], v[64:67]
s_mul_i32 s71, s71, 131072
v_mfma_f32_16x16x32_bf16 v[64:67], a[204:207], a[80:83], v[64:67]
s_add_u32 s71, s71, 1572864
buffer_load_dwordx4 v244, s[24:27], s71 offen lds
v_mfma_f32_16x16x32_bf16 v[68:71], a[204:207], a[84:87], v[68:71]
s_add_u32 m0, s70, 4096
ds_read_b64_tr_b16 a[244:245], v221 offset:8192
v_mfma_f32_16x16x32_bf16 v[68:71], a[200:203], a[68:71], v[68:71]
s_add_u32 s71, s71, 65536
buffer_load_dwordx4 v244, s[24:27], s71 offen lds
v_mfma_f32_16x16x32_bf16 v[68:71], a[196:199], a[52:55], v[68:71]
s_add_u32 m0, s70, 8192
ds_read_b64_tr_b16 a[246:247], v221 offset:12288
v_mfma_f32_16x16x32_bf16 v[68:71], a[192:195], a[36:39], v[68:71]
s_bfe_u32 s71, s78, 0x4001c
ds_read_b64_tr_b16 a[248:249], v221 offset:16384
v_mfma_f32_16x16x32_bf16 v[72:75], a[192:195], a[40:43], v[72:75]
s_mul_i32 s71, s71, 131072
v_mfma_f32_16x16x32_bf16 v[72:75], a[196:199], a[56:59], v[72:75]
s_add_u32 s71, s71, 1572864
buffer_load_dwordx4 v244, s[24:27], s71 offen lds
v_mfma_f32_16x16x32_bf16 v[72:75], a[200:203], a[72:75], v[72:75]
s_bfe_u32 s72, s78, 0x40018
ds_read_b64_tr_b16 a[250:251], v221 offset:20480
v_mfma_f32_16x16x32_bf16 v[72:75], a[204:207], a[88:91], v[72:75]
s_mul_i32 s72, s72, 8192
ds_read_b64_tr_b16 a[252:253], v221 offset:24576
v_mfma_f32_16x16x32_bf16 v[76:79], a[204:207], a[92:95], v[76:79]
s_add_u32 s72, s72, s80
v_mfma_f32_16x16x32_bf16 v[76:79], a[200:203], a[76:79], v[76:79]
s_add_u32 s72, s72, 557056
buffer_load_dwordx4 a[0:3], v233, s[16:19], s72 offen offset:0 sc1
v_mfma_f32_16x16x32_bf16 v[76:79], a[196:199], a[60:63], v[76:79]
ds_read_b64_tr_b16 a[254:255], v221 offset:28672
v_mfma_f32_16x16x32_bf16 v[76:79], a[192:195], a[44:47], v[76:79]
buffer_load_dwordx4 a[4:7], v233, s[16:19], s72 offen offset:1024 sc1
v_mfma_f32_16x16x32_bf16 v[80:83], a[208:211], a[32:35], v[80:83]
s_add_u32 m0, s70, 12288
ds_read_b64_tr_b16 a[192:193], v214 offset:16384
v_mfma_f32_16x16x32_bf16 v[80:83], a[212:215], a[48:51], v[80:83]
s_add_u32 s71, s71, 65536
ds_read_b64_tr_b16 a[194:195], v214 offset:20480
v_mfma_f32_16x16x32_bf16 v[80:83], a[216:219], a[64:67], v[80:83]
buffer_load_dwordx4 v244, s[24:27], s71 offen lds
v_mfma_f32_16x16x32_bf16 v[80:83], a[220:223], a[80:83], v[80:83]
s_add_u32 s72, s72, 4096
ds_read_b64_tr_b16 a[196:197], v214 offset:24576
v_mfma_f32_16x16x32_bf16 v[84:87], a[220:223], a[84:87], v[84:87]
v_mfma_f32_16x16x32_bf16 v[84:87], a[216:219], a[68:71], v[84:87]
ds_read_b64_tr_b16 a[198:199], v214 offset:28672
v_mfma_f32_16x16x32_bf16 v[84:87], a[212:215], a[52:55], v[84:87]
buffer_load_dwordx4 a[8:11], v233, s[16:19], s72 offen offset:0 sc1
v_mfma_f32_16x16x32_bf16 v[84:87], a[208:211], a[36:39], v[84:87]
ds_read_b64_tr_b16 a[200:201], v214 offset:32768
v_mfma_f32_16x16x32_bf16 v[88:91], a[208:211], a[40:43], v[88:91]
v_mfma_f32_16x16x32_bf16 v[88:91], a[212:215], a[56:59], v[88:91]
ds_read_b64_tr_b16 a[202:203], v214 offset:36864
v_mfma_f32_16x16x32_bf16 v[88:91], a[216:219], a[72:75], v[88:91]
buffer_load_dwordx4 a[12:15], v233, s[16:19], s72 offen offset:1024 sc1
v_mfma_f32_16x16x32_bf16 v[88:91], a[220:223], a[88:91], v[88:91]
ds_read_b64_tr_b16 a[204:205], v214 offset:40960
v_mfma_f32_16x16x32_bf16 v[92:95], a[220:223], a[92:95], v[92:95]
v_mfma_f32_16x16x32_bf16 v[92:95], a[216:219], a[76:79], v[92:95]
ds_read_b64_tr_b16 a[206:207], v214 offset:45056
v_mfma_f32_16x16x32_bf16 v[92:95], a[212:215], a[60:63], v[92:95]
v_mfma_f32_16x16x32_bf16 v[92:95], a[208:211], a[44:47], v[92:95]
s_waitcnt vmcnt(20) lgkmcnt(8)
v_mfma_f32_16x16x32_bf16 v[64:67], a[224:227], a[96:99], v[64:67]
s_bfe_u32 s72, s78, 0x4001c
ds_read_b64_tr_b16 a[208:209], v215 offset:16384
v_mfma_f32_16x16x32_bf16 v[64:67], a[228:231], a[112:115], v[64:67]
s_mul_i32 s72, s72, 8192
ds_read_b64_tr_b16 a[210:211], v215 offset:20480
v_mfma_f32_16x16x32_bf16 v[64:67], a[232:235], a[128:131], v[64:67]
s_add_u32 s72, s72, s80
v_mfma_f32_16x16x32_bf16 v[64:67], a[236:239], a[144:147], v[64:67]
s_add_u32 s72, s72, 557056
buffer_load_dwordx4 a[16:19], v233, s[16:19], s72 offen offset:0 sc1
v_mfma_f32_16x16x32_bf16 v[68:71], a[236:239], a[148:151], v[68:71]
ds_read_b64_tr_b16 a[212:213], v215 offset:24576
v_mfma_f32_16x16x32_bf16 v[68:71], a[232:235], a[132:135], v[68:71]
ds_read_b64_tr_b16 a[214:215], v215 offset:28672
v_mfma_f32_16x16x32_bf16 v[68:71], a[228:231], a[116:119], v[68:71]
v_mfma_f32_16x16x32_bf16 v[68:71], a[224:227], a[100:103], v[68:71]
buffer_load_dwordx4 a[20:23], v233, s[16:19], s72 offen offset:1024 sc1
v_mfma_f32_16x16x32_bf16 v[72:75], a[224:227], a[104:107], v[72:75]
s_add_u32 s72, s72, 4096
ds_read_b64_tr_b16 a[216:217], v215 offset:32768
v_mfma_f32_16x16x32_bf16 v[72:75], a[228:231], a[120:123], v[72:75]
ds_read_b64_tr_b16 a[218:219], v215 offset:36864
v_mfma_f32_16x16x32_bf16 v[72:75], a[232:235], a[136:139], v[72:75]
v_mfma_f32_16x16x32_bf16 v[72:75], a[236:239], a[152:155], v[72:75]
ds_read_b64_tr_b16 a[220:221], v215 offset:40960
v_mfma_f32_16x16x32_bf16 v[76:79], a[236:239], a[156:159], v[76:79]
v_mfma_f32_16x16x32_bf16 v[76:79], a[232:235], a[140:143], v[76:79]
ds_read_b64_tr_b16 a[222:223], v215 offset:45056
v_mfma_f32_16x16x32_bf16 v[76:79], a[228:231], a[124:127], v[76:79]
v_mfma_f32_16x16x32_bf16 v[76:79], a[224:227], a[108:111], v[76:79]
buffer_load_dwordx4 a[24:27], v233, s[16:19], s72 offen offset:0 sc1
v_mfma_f32_16x16x32_bf16 v[80:83], a[240:243], a[96:99], v[80:83]
ds_read_b64_tr_b16 a[224:225], v222 offset:0
v_mfma_f32_16x16x32_bf16 v[80:83], a[244:247], a[112:115], v[80:83]
ds_read_b64_tr_b16 a[226:227], v222 offset:4096
v_mfma_f32_16x16x32_bf16 v[80:83], a[248:251], a[128:131], v[80:83]
v_mfma_f32_16x16x32_bf16 v[80:83], a[252:255], a[144:147], v[80:83]
ds_read_b64_tr_b16 a[228:229], v222 offset:8192
v_mfma_f32_16x16x32_bf16 v[84:87], a[252:255], a[148:151], v[84:87]
v_mfma_f32_16x16x32_bf16 v[84:87], a[248:251], a[132:135], v[84:87]
ds_read_b64_tr_b16 a[230:231], v222 offset:12288
v_mfma_f32_16x16x32_bf16 v[84:87], a[244:247], a[116:119], v[84:87]
buffer_load_dwordx4 a[28:31], v233, s[16:19], s72 offen offset:1024 sc1
v_mfma_f32_16x16x32_bf16 v[84:87], a[240:243], a[100:103], v[84:87]
ds_read_b64_tr_b16 a[232:233], v222 offset:16384
v_mfma_f32_16x16x32_bf16 v[88:91], a[240:243], a[104:107], v[88:91]
v_mfma_f32_16x16x32_bf16 v[88:91], a[244:247], a[120:123], v[88:91]
ds_read_b64_tr_b16 a[234:235], v222 offset:20480
v_mfma_f32_16x16x32_bf16 v[88:91], a[248:251], a[136:139], v[88:91]
v_mfma_f32_16x16x32_bf16 v[88:91], a[252:255], a[152:155], v[88:91]
ds_read_b64_tr_b16 a[236:237], v222 offset:24576
v_mfma_f32_16x16x32_bf16 v[92:95], a[252:255], a[156:159], v[92:95]
v_mfma_f32_16x16x32_bf16 v[92:95], a[248:251], a[140:143], v[92:95]
ds_read_b64_tr_b16 a[238:239], v222 offset:28672
v_mfma_f32_16x16x32_bf16 v[92:95], a[244:247], a[124:127], v[92:95]
v_mfma_f32_16x16x32_bf16 v[92:95], a[240:243], a[108:111], v[92:95]
s_waitcnt lgkmcnt(8)
s_barrier
v_mfma_f32_16x16x32_bf16 v[96:99], a[192:195], a[32:35], v[96:99]
ds_read_b64_tr_b16 a[240:241], v223 offset:0
v_mfma_f32_16x16x32_bf16 v[96:99], a[196:199], a[48:51], v[96:99]
ds_read_b64_tr_b16 a[242:243], v223 offset:4096
v_mfma_f32_16x16x32_bf16 v[96:99], a[200:203], a[64:67], v[96:99]
v_mfma_f32_16x16x32_bf16 v[96:99], a[204:207], a[80:83], v[96:99]
ds_read_b64_tr_b16 a[244:245], v223 offset:8192
v_mfma_f32_16x16x32_bf16 v[100:103], a[204:207], a[84:87], v[100:103]
v_cvt_pk_bf16_f32 v72, v72, v73
v_mfma_f32_16x16x32_bf16 v[100:103], a[200:203], a[68:71], v[100:103]
ds_read_b64_tr_b16 a[246:247], v223 offset:12288
v_mfma_f32_16x16x32_bf16 v[100:103], a[196:199], a[52:55], v[100:103]
v_cvt_pk_bf16_f32 v73, v74, v75
v_mfma_f32_16x16x32_bf16 v[100:103], a[192:195], a[36:39], v[100:103]
ds_read_b64_tr_b16 a[248:249], v223 offset:16384
v_mfma_f32_16x16x32_bf16 v[104:107], a[192:195], a[40:43], v[104:107]
v_mfma_f32_16x16x32_bf16 v[104:107], a[196:199], a[56:59], v[104:107]
v_cvt_pk_bf16_f32 v74, v88, v89
ds_read_b64_tr_b16 a[250:251], v223 offset:20480
v_mfma_f32_16x16x32_bf16 v[104:107], a[200:203], a[72:75], v[104:107]
v_mfma_f32_16x16x32_bf16 v[104:107], a[204:207], a[88:91], v[104:107]
ds_read_b64_tr_b16 a[252:253], v223 offset:24576
v_mfma_f32_16x16x32_bf16 v[108:111], a[204:207], a[92:95], v[108:111]
v_cvt_pk_bf16_f32 v75, v90, v91
v_mfma_f32_16x16x32_bf16 v[108:111], a[200:203], a[76:79], v[108:111]
s_add_u32 s46, s74, 8192
ds_read_b64_tr_b16 a[254:255], v223 offset:28672
v_mfma_f32_16x16x32_bf16 v[108:111], a[196:199], a[60:63], v[108:111]
buffer_store_dwordx4 v[72:75], v233, s[16:19], s46 offen offset:0 sc1
v_mfma_f32_16x16x32_bf16 v[108:111], a[192:195], a[44:47], v[108:111]
ds_read_b64_tr_b16 a[192:193], v208 offset:16384
v_mfma_f32_16x16x32_bf16 v[112:115], a[208:211], a[32:35], v[112:115]
v_mfma_f32_16x16x32_bf16 v[112:115], a[212:215], a[48:51], v[112:115]
v_cvt_pk_bf16_f32 v76, v76, v77
ds_read_b64_tr_b16 a[194:195], v208 offset:20480
v_mfma_f32_16x16x32_bf16 v[112:115], a[216:219], a[64:67], v[112:115]
v_mfma_f32_16x16x32_bf16 v[112:115], a[220:223], a[80:83], v[112:115]
ds_read_b64_tr_b16 a[196:197], v208 offset:24576
v_mfma_f32_16x16x32_bf16 v[116:119], a[220:223], a[84:87], v[116:119]
v_cvt_pk_bf16_f32 v77, v78, v79
v_mfma_f32_16x16x32_bf16 v[116:119], a[216:219], a[68:71], v[116:119]
ds_read_b64_tr_b16 a[198:199], v208 offset:28672
v_mfma_f32_16x16x32_bf16 v[116:119], a[212:215], a[52:55], v[116:119]
v_cvt_pk_bf16_f32 v78, v92, v93
v_mfma_f32_16x16x32_bf16 v[116:119], a[208:211], a[36:39], v[116:119]
ds_read_b64_tr_b16 a[200:201], v208 offset:32768
v_mfma_f32_16x16x32_bf16 v[120:123], a[208:211], a[40:43], v[120:123]
v_mfma_f32_16x16x32_bf16 v[120:123], a[212:215], a[56:59], v[120:123]
v_cvt_pk_bf16_f32 v79, v94, v95
ds_read_b64_tr_b16 a[202:203], v208 offset:36864
v_mfma_f32_16x16x32_bf16 v[120:123], a[216:219], a[72:75], v[120:123]
s_add_u32 s46, s74, 8192
v_mfma_f32_16x16x32_bf16 v[120:123], a[220:223], a[88:91], v[120:123]
ds_read_b64_tr_b16 a[204:205], v208 offset:40960
v_mfma_f32_16x16x32_bf16 v[124:127], a[220:223], a[92:95], v[124:127]
buffer_store_dwordx4 v[76:79], v233, s[16:19], s46 offen offset:2048 sc1
v_mfma_f32_16x16x32_bf16 v[124:127], a[216:219], a[76:79], v[124:127]
ds_read_b64_tr_b16 a[206:207], v208 offset:45056
v_mfma_f32_16x16x32_bf16 v[124:127], a[212:215], a[60:63], v[124:127]
v_mfma_f32_16x16x32_bf16 v[124:127], a[208:211], a[44:47], v[124:127]
s_waitcnt lgkmcnt(8)
v_mfma_f32_16x16x32_bf16 v[96:99], a[224:227], a[96:99], v[96:99]
v_cvt_pk_bf16_f32 v64, v64, v65
ds_read_b64_tr_b16 a[208:209], v209 offset:16384
v_mfma_f32_16x16x32_bf16 v[96:99], a[228:231], a[112:115], v[96:99]
ds_read_b64_tr_b16 a[210:211], v209 offset:20480
v_mfma_f32_16x16x32_bf16 v[96:99], a[232:235], a[128:131], v[96:99]
v_mfma_f32_16x16x32_bf16 v[96:99], a[236:239], a[144:147], v[96:99]
v_cvt_pk_bf16_f32 v65, v66, v67
ds_read_b64_tr_b16 a[212:213], v209 offset:24576
v_mfma_f32_16x16x32_bf16 v[100:103], a[236:239], a[148:151], v[100:103]
v_mfma_f32_16x16x32_bf16 v[100:103], a[232:235], a[132:135], v[100:103]
ds_read_b64_tr_b16 a[214:215], v209 offset:28672
v_mfma_f32_16x16x32_bf16 v[100:103], a[228:231], a[116:119], v[100:103]
v_cvt_pk_bf16_f32 v66, v80, v81
v_mfma_f32_16x16x32_bf16 v[100:103], a[224:227], a[100:103], v[100:103]
ds_read_b64_tr_b16 a[216:217], v209 offset:32768
v_mfma_f32_16x16x32_bf16 v[104:107], a[224:227], a[104:107], v[104:107]
v_mfma_f32_16x16x32_bf16 v[104:107], a[228:231], a[120:123], v[104:107]
v_cvt_pk_bf16_f32 v67, v82, v83
ds_read_b64_tr_b16 a[218:219], v209 offset:36864
v_mfma_f32_16x16x32_bf16 v[104:107], a[232:235], a[136:139], v[104:107]
s_add_u32 s46, s74, 0
v_mfma_f32_16x16x32_bf16 v[104:107], a[236:239], a[152:155], v[104:107]
ds_read_b64_tr_b16 a[220:221], v209 offset:40960
v_mfma_f32_16x16x32_bf16 v[108:111], a[236:239], a[156:159], v[108:111]
buffer_store_dwordx4 v[64:67], v233, s[16:19], s46 offen offset:0 sc1
v_mfma_f32_16x16x32_bf16 v[108:111], a[232:235], a[140:143], v[108:111]
ds_read_b64_tr_b16 a[222:223], v209 offset:45056
v_mfma_f32_16x16x32_bf16 v[108:111], a[228:231], a[124:127], v[108:111]
v_mfma_f32_16x16x32_bf16 v[108:111], a[224:227], a[108:111], v[108:111]
v_cvt_pk_bf16_f32 v68, v68, v69
ds_read_b64_tr_b16 a[224:225], v216 offset:0
v_mfma_f32_16x16x32_bf16 v[112:115], a[240:243], a[96:99], v[112:115]
v_mfma_f32_16x16x32_bf16 v[112:115], a[244:247], a[112:115], v[112:115]
ds_read_b64_tr_b16 a[226:227], v216 offset:4096
v_mfma_f32_16x16x32_bf16 v[112:115], a[248:251], a[128:131], v[112:115]
v_cvt_pk_bf16_f32 v69, v70, v71
v_mfma_f32_16x16x32_bf16 v[112:115], a[252:255], a[144:147], v[112:115]
ds_read_b64_tr_b16 a[228:229], v216 offset:8192
v_mfma_f32_16x16x32_bf16 v[116:119], a[252:255], a[148:151], v[116:119]
v_mfma_f32_16x16x32_bf16 v[116:119], a[248:251], a[132:135], v[116:119]
v_cvt_pk_bf16_f32 v70, v84, v85
ds_read_b64_tr_b16 a[230:231], v216 offset:12288
v_mfma_f32_16x16x32_bf16 v[116:119], a[244:247], a[116:119], v[116:119]
v_mfma_f32_16x16x32_bf16 v[116:119], a[240:243], a[100:103], v[116:119]
ds_read_b64_tr_b16 a[232:233], v216 offset:16384
v_mfma_f32_16x16x32_bf16 v[120:123], a[240:243], a[104:107], v[120:123]
v_cvt_pk_bf16_f32 v71, v86, v87
v_mfma_f32_16x16x32_bf16 v[120:123], a[244:247], a[120:123], v[120:123]
s_add_u32 s46, s74, 0
ds_read_b64_tr_b16 a[234:235], v216 offset:20480
v_mfma_f32_16x16x32_bf16 v[120:123], a[248:251], a[136:139], v[120:123]
v_mfma_f32_16x16x32_bf16 v[120:123], a[252:255], a[152:155], v[120:123]
buffer_store_dwordx4 v[68:71], v233, s[16:19], s46 offen offset:2048 sc1
v_mfma_f32_16x16x32_bf16 v[124:127], a[252:255], a[156:159], v[124:127]
ds_read_b64_tr_b16 a[236:237], v216 offset:24576
v_mfma_f32_16x16x32_bf16 v[124:127], a[248:251], a[140:143], v[124:127]
ds_read_b64_tr_b16 a[238:239], v216 offset:28672
v_mfma_f32_16x16x32_bf16 v[124:127], a[244:247], a[124:127], v[124:127]
v_mfma_f32_16x16x32_bf16 v[124:127], a[240:243], a[108:111], v[124:127]
s_waitcnt vmcnt(10) lgkmcnt(8)
s_barrier
v_mfma_f32_16x16x32_bf16 v[8:11], a[192:195], a[40:43], v[8:11]
ds_read_b64_tr_b16 a[240:241], v217 offset:0
v_mfma_f32_16x16x32_bf16 v[8:11], a[196:199], a[56:59], v[8:11]
ds_read_b64_tr_b16 a[242:243], v217 offset:4096
v_mfma_f32_16x16x32_bf16 v[8:11], a[200:203], a[72:75], v[8:11]
ds_read_b64_tr_b16 a[244:245], v217 offset:8192
v_mfma_f32_16x16x32_bf16 v[8:11], a[204:207], a[88:91], v[8:11]
ds_read_b64_tr_b16 a[246:247], v217 offset:12288
v_mfma_f32_16x16x32_bf16 v[12:15], a[204:207], a[92:95], v[12:15]
v_cvt_pk_bf16_f32 v104, v104, v105
ds_read_b64_tr_b16 a[248:249], v217 offset:16384
v_mfma_f32_16x16x32_bf16 v[12:15], a[200:203], a[76:79], v[12:15]
v_cvt_pk_bf16_f32 v105, v106, v107
ds_read_b64_tr_b16 a[250:251], v217 offset:20480
v_mfma_f32_16x16x32_bf16 v[12:15], a[196:199], a[60:63], v[12:15]
v_cvt_pk_bf16_f32 v106, v120, v121
ds_read_b64_tr_b16 a[252:253], v217 offset:24576
v_mfma_f32_16x16x32_bf16 v[12:15], a[192:195], a[44:47], v[12:15]
v_cvt_pk_bf16_f32 v107, v122, v123
ds_read_b64_tr_b16 a[254:255], v217 offset:28672
v_mfma_f32_16x16x32_bf16 v[24:27], a[208:211], a[40:43], v[24:27]
s_add_u32 s46, s74, 8192
buffer_store_dwordx4 v[104:107], v233, s[16:19], s46 offen offset:1024 sc1
ds_read_b64_tr_b16 a[192:193], v210 offset:16384
v_mfma_f32_16x16x32_bf16 v[24:27], a[212:215], a[56:59], v[24:27]
v_cvt_pk_bf16_f32 v108, v108, v109
ds_read_b64_tr_b16 a[194:195], v210 offset:20480
v_mfma_f32_16x16x32_bf16 v[24:27], a[216:219], a[72:75], v[24:27]
v_cvt_pk_bf16_f32 v109, v110, v111
ds_read_b64_tr_b16 a[196:197], v210 offset:24576
v_mfma_f32_16x16x32_bf16 v[24:27], a[220:223], a[88:91], v[24:27]
v_cvt_pk_bf16_f32 v110, v124, v125
ds_read_b64_tr_b16 a[198:199], v210 offset:28672
v_mfma_f32_16x16x32_bf16 v[28:31], a[220:223], a[92:95], v[28:31]
v_cvt_pk_bf16_f32 v111, v126, v127
ds_read_b64_tr_b16 a[200:201], v210 offset:32768
v_mfma_f32_16x16x32_bf16 v[28:31], a[216:219], a[76:79], v[28:31]
s_add_u32 s46, s74, 8192
buffer_store_dwordx4 v[108:111], v233, s[16:19], s46 offen offset:3072 sc1
ds_read_b64_tr_b16 a[202:203], v210 offset:36864
v_mfma_f32_16x16x32_bf16 v[28:31], a[212:215], a[60:63], v[28:31]
ds_read_b64_tr_b16 a[204:205], v210 offset:40960
v_mfma_f32_16x16x32_bf16 v[28:31], a[208:211], a[44:47], v[28:31]
s_waitcnt lgkmcnt(7)
ds_read_b64_tr_b16 a[206:207], v210 offset:45056
v_mfma_f32_16x16x32_bf16 v[8:11], a[224:227], a[104:107], v[8:11]
v_cvt_pk_bf16_f32 v96, v96, v97
ds_read_b64_tr_b16 a[208:209], v211 offset:16384
v_mfma_f32_16x16x32_bf16 v[8:11], a[228:231], a[120:123], v[8:11]
v_cvt_pk_bf16_f32 v97, v98, v99
ds_read_b64_tr_b16 a[210:211], v211 offset:20480
v_mfma_f32_16x16x32_bf16 v[8:11], a[232:235], a[136:139], v[8:11]
ds_read_b64_tr_b16 a[212:213], v211 offset:24576
v_mfma_f32_16x16x32_bf16 v[8:11], a[236:239], a[152:155], v[8:11]
v_cvt_pk_bf16_f32 v98, v112, v113
ds_read_b64_tr_b16 a[214:215], v211 offset:28672
v_mfma_f32_16x16x32_bf16 v[12:15], a[236:239], a[156:159], v[12:15]
v_cvt_pk_bf16_f32 v99, v114, v115
ds_read_b64_tr_b16 a[216:217], v211 offset:32768
v_mfma_f32_16x16x32_bf16 v[12:15], a[232:235], a[140:143], v[12:15]
s_add_u32 s46, s74, 0
ds_read_b64_tr_b16 a[218:219], v211 offset:36864
v_mfma_f32_16x16x32_bf16 v[12:15], a[228:231], a[124:127], v[12:15]
buffer_store_dwordx4 v[96:99], v233, s[16:19], s46 offen offset:1024 sc1
ds_read_b64_tr_b16 a[220:221], v211 offset:40960
v_mfma_f32_16x16x32_bf16 v[12:15], a[224:227], a[108:111], v[12:15]
v_cvt_pk_bf16_f32 v100, v100, v101
ds_read_b64_tr_b16 a[222:223], v211 offset:45056
v_mfma_f32_16x16x32_bf16 v[24:27], a[240:243], a[104:107], v[24:27]
ds_read_b64_tr_b16 a[224:225], v218 offset:0
v_mfma_f32_16x16x32_bf16 v[24:27], a[244:247], a[120:123], v[24:27]
v_cvt_pk_bf16_f32 v101, v102, v103
ds_read_b64_tr_b16 a[226:227], v218 offset:4096
v_mfma_f32_16x16x32_bf16 v[24:27], a[248:251], a[136:139], v[24:27]
v_cvt_pk_bf16_f32 v102, v116, v117
ds_read_b64_tr_b16 a[228:229], v218 offset:8192
v_mfma_f32_16x16x32_bf16 v[24:27], a[252:255], a[152:155], v[24:27]
ds_read_b64_tr_b16 a[230:231], v218 offset:12288
v_mfma_f32_16x16x32_bf16 v[28:31], a[252:255], a[156:159], v[28:31]
v_cvt_pk_bf16_f32 v103, v118, v119
ds_read_b64_tr_b16 a[232:233], v218 offset:16384
v_mfma_f32_16x16x32_bf16 v[28:31], a[248:251], a[140:143], v[28:31]
s_add_u32 s46, s74, 0
buffer_store_dwordx4 v[100:103], v233, s[16:19], s46 offen offset:3072 sc1
ds_read_b64_tr_b16 a[234:235], v218 offset:20480
v_mfma_f32_16x16x32_bf16 v[28:31], a[244:247], a[124:127], v[28:31]
ds_read_b64_tr_b16 a[236:237], v218 offset:24576
v_mfma_f32_16x16x32_bf16 v[28:31], a[240:243], a[108:111], v[28:31]
s_waitcnt lgkmcnt(7)
ds_read_b64_tr_b16 a[238:239], v218 offset:28672
v_mfma_f32_16x16x32_bf16 v[40:43], a[192:195], a[40:43], v[40:43]
ds_read_b64_tr_b16 a[240:241], v219 offset:0
v_mfma_f32_16x16x32_bf16 v[40:43], a[196:199], a[56:59], v[40:43]
ds_read_b64_tr_b16 a[242:243], v219 offset:4096
v_mfma_f32_16x16x32_bf16 v[40:43], a[200:203], a[72:75], v[40:43]
ds_read_b64_tr_b16 a[244:245], v219 offset:8192
v_mfma_f32_16x16x32_bf16 v[40:43], a[204:207], a[88:91], v[40:43]
ds_read_b64_tr_b16 a[246:247], v219 offset:12288
v_mfma_f32_16x16x32_bf16 v[44:47], a[204:207], a[92:95], v[44:47]
v_cvt_pk_bf16_f32 v8, v8, v9
ds_read_b64_tr_b16 a[248:249], v219 offset:16384
v_mfma_f32_16x16x32_bf16 v[44:47], a[200:203], a[76:79], v[44:47]
v_cvt_pk_bf16_f32 v9, v10, v11
ds_read_b64_tr_b16 a[250:251], v219 offset:20480
v_mfma_f32_16x16x32_bf16 v[44:47], a[196:199], a[60:63], v[44:47]
v_cvt_pk_bf16_f32 v10, v24, v25
ds_read_b64_tr_b16 a[252:253], v219 offset:24576
v_mfma_f32_16x16x32_bf16 v[44:47], a[192:195], a[44:47], v[44:47]
v_cvt_pk_bf16_f32 v11, v26, v27
ds_read_b64_tr_b16 a[254:255], v219 offset:28672
v_mfma_f32_16x16x32_bf16 v[56:59], a[208:211], a[40:43], v[56:59]
s_add_u32 s46, s74, 4096
buffer_store_dwordx4 v[8:11], v233, s[16:19], s46 offen offset:0 sc1
ds_read_b64_tr_b16 a[192:193], v208 offset:16384
v_mfma_f32_16x16x32_bf16 v[56:59], a[212:215], a[56:59], v[56:59]
v_cvt_pk_bf16_f32 v12, v12, v13
ds_read_b64_tr_b16 a[194:195], v208 offset:20480
v_mfma_f32_16x16x32_bf16 v[56:59], a[216:219], a[72:75], v[56:59]
v_cvt_pk_bf16_f32 v13, v14, v15
ds_read_b64_tr_b16 a[196:197], v208 offset:24576
v_mfma_f32_16x16x32_bf16 v[56:59], a[220:223], a[88:91], v[56:59]
v_cvt_pk_bf16_f32 v14, v28, v29
ds_read_b64_tr_b16 a[198:199], v208 offset:28672
v_mfma_f32_16x16x32_bf16 v[60:63], a[220:223], a[92:95], v[60:63]
v_cvt_pk_bf16_f32 v15, v30, v31
ds_read_b64_tr_b16 a[200:201], v208 offset:32768
v_mfma_f32_16x16x32_bf16 v[60:63], a[216:219], a[76:79], v[60:63]
s_add_u32 s46, s74, 4096
buffer_store_dwordx4 v[12:15], v233, s[16:19], s46 offen offset:2048 sc1
ds_read_b64_tr_b16 a[202:203], v208 offset:36864
v_mfma_f32_16x16x32_bf16 v[60:63], a[212:215], a[60:63], v[60:63]
ds_read_b64_tr_b16 a[204:205], v208 offset:40960
v_mfma_f32_16x16x32_bf16 v[60:63], a[208:211], a[44:47], v[60:63]
s_waitcnt lgkmcnt(7)
ds_read_b64_tr_b16 a[206:207], v208 offset:45056
v_mfma_f32_16x16x32_bf16 v[40:43], a[224:227], a[104:107], v[40:43]
ds_read_b64_tr_b16 a[208:209], v209 offset:16384
ds_read_b64_tr_b16 a[210:211], v209 offset:20480
v_mfma_f32_16x16x32_bf16 v[40:43], a[228:231], a[120:123], v[40:43]
ds_read_b64_tr_b16 a[212:213], v209 offset:24576
v_mfma_f32_16x16x32_bf16 v[40:43], a[232:235], a[136:139], v[40:43]
ds_read_b64_tr_b16 a[214:215], v209 offset:28672
v_mfma_f32_16x16x32_bf16 v[40:43], a[236:239], a[152:155], v[40:43]
ds_read_b64_tr_b16 a[216:217], v209 offset:32768
v_mfma_f32_16x16x32_bf16 v[44:47], a[236:239], a[156:159], v[44:47]
ds_read_b64_tr_b16 a[218:219], v209 offset:36864
v_mfma_f32_16x16x32_bf16 v[44:47], a[232:235], a[140:143], v[44:47]
ds_read_b64_tr_b16 a[220:221], v209 offset:40960
v_mfma_f32_16x16x32_bf16 v[44:47], a[228:231], a[124:127], v[44:47]
ds_read_b64_tr_b16 a[222:223], v209 offset:45056
v_mfma_f32_16x16x32_bf16 v[44:47], a[224:227], a[108:111], v[44:47]
ds_read_b64_tr_b16 a[224:225], v216 offset:0
v_mfma_f32_16x16x32_bf16 v[56:59], a[240:243], a[104:107], v[56:59]
ds_read_b64_tr_b16 a[226:227], v216 offset:4096
v_mfma_f32_16x16x32_bf16 v[56:59], a[244:247], a[120:123], v[56:59]
ds_read_b64_tr_b16 a[228:229], v216 offset:8192
v_mfma_f32_16x16x32_bf16 v[56:59], a[248:251], a[136:139], v[56:59]
ds_read_b64_tr_b16 a[230:231], v216 offset:12288
v_mfma_f32_16x16x32_bf16 v[56:59], a[252:255], a[152:155], v[56:59]
ds_read_b64_tr_b16 a[232:233], v216 offset:16384
v_mfma_f32_16x16x32_bf16 v[60:63], a[252:255], a[156:159], v[60:63]
ds_read_b64_tr_b16 a[234:235], v216 offset:20480
v_mfma_f32_16x16x32_bf16 v[60:63], a[248:251], a[140:143], v[60:63]
ds_read_b64_tr_b16 a[236:237], v216 offset:24576
v_mfma_f32_16x16x32_bf16 v[60:63], a[244:247], a[124:127], v[60:63]
ds_read_b64_tr_b16 a[238:239], v216 offset:28672
v_mfma_f32_16x16x32_bf16 v[60:63], a[240:243], a[108:111], v[60:63]
s_waitcnt lgkmcnt(8)
v_mfma_f32_16x16x32_bf16 v[0:3], a[192:195], a[32:35], v[0:3]
ds_read_b64_tr_b16 a[240:241], v217 offset:0
s_waitcnt vmcnt(2)
s_add_u32 s50, s34, 786432
buffer_store_dwordx2 v[238:239], v237, s[16:19], s50 offen sc1
v_mfma_f32_16x16x32_bf16 v[0:3], a[196:199], a[48:51], v[0:3]
ds_read_b64_tr_b16 a[242:243], v217 offset:4096
v_mfma_f32_16x16x32_bf16 v[0:3], a[200:203], a[64:67], v[0:3]
ds_read_b64_tr_b16 a[244:245], v217 offset:8192
v_mfma_f32_16x16x32_bf16 v[0:3], a[204:207], a[80:83], v[0:3]
ds_read_b64_tr_b16 a[246:247], v217 offset:12288
v_mfma_f32_16x16x32_bf16 v[4:7], a[204:207], a[84:87], v[4:7]
v_cvt_pk_bf16_f32 v40, v40, v41
ds_read_b64_tr_b16 a[248:249], v217 offset:16384
v_mfma_f32_16x16x32_bf16 v[4:7], a[200:203], a[68:71], v[4:7]
v_cvt_pk_bf16_f32 v41, v42, v43
ds_read_b64_tr_b16 a[250:251], v217 offset:20480
v_mfma_f32_16x16x32_bf16 v[4:7], a[196:199], a[52:55], v[4:7]
v_cvt_pk_bf16_f32 v42, v56, v57
ds_read_b64_tr_b16 a[252:253], v217 offset:24576
v_mfma_f32_16x16x32_bf16 v[4:7], a[192:195], a[36:39], v[4:7]
v_cvt_pk_bf16_f32 v43, v58, v59
ds_read_b64_tr_b16 a[254:255], v217 offset:28672
v_mfma_f32_16x16x32_bf16 v[16:19], a[208:211], a[32:35], v[16:19]
s_add_u32 s46, s74, 4096
buffer_store_dwordx4 v[40:43], v233, s[16:19], s46 offen offset:1024 sc1
ds_read_b64_tr_b16 a[192:193], v210 offset:16384
v_mfma_f32_16x16x32_bf16 v[16:19], a[212:215], a[48:51], v[16:19]
v_cvt_pk_bf16_f32 v44, v44, v45
ds_read_b64_tr_b16 a[194:195], v210 offset:20480
v_mfma_f32_16x16x32_bf16 v[16:19], a[216:219], a[64:67], v[16:19]
v_cvt_pk_bf16_f32 v45, v46, v47
ds_read_b64_tr_b16 a[196:197], v210 offset:24576
v_mfma_f32_16x16x32_bf16 v[16:19], a[220:223], a[80:83], v[16:19]
v_cvt_pk_bf16_f32 v46, v60, v61
ds_read_b64_tr_b16 a[198:199], v210 offset:28672
v_mfma_f32_16x16x32_bf16 v[20:23], a[220:223], a[84:87], v[20:23]
v_cvt_pk_bf16_f32 v47, v62, v63
ds_read_b64_tr_b16 a[200:201], v210 offset:32768
v_mfma_f32_16x16x32_bf16 v[20:23], a[216:219], a[68:71], v[20:23]
Lpad12:
s_cbranch_execz Lwarm_done
s_add_u32 s46, s74, 4096
buffer_store_dwordx4 v[44:47], v233, s[16:19], s46 offen offset:3072 sc1
ds_read_b64_tr_b16 a[202:203], v210 offset:36864
v_mfma_f32_16x16x32_bf16 v[20:23], a[212:215], a[52:55], v[20:23]
ds_read_b64_tr_b16 a[204:205], v210 offset:40960
v_mfma_f32_16x16x32_bf16 v[20:23], a[208:211], a[36:39], v[20:23]
s_waitcnt lgkmcnt(7)
ds_read_b64_tr_b16 a[206:207], v210 offset:45056
v_mfma_f32_16x16x32_bf16 v[0:3], a[224:227], a[96:99], v[0:3]
ds_read_b64_tr_b16 a[208:209], v211 offset:16384
ds_read_b64_tr_b16 a[210:211], v211 offset:20480
v_mfma_f32_16x16x32_bf16 v[0:3], a[228:231], a[112:115], v[0:3]
ds_read_b64_tr_b16 a[212:213], v211 offset:24576
v_mfma_f32_16x16x32_bf16 v[0:3], a[232:235], a[128:131], v[0:3]
ds_read_b64_tr_b16 a[214:215], v211 offset:28672
v_mfma_f32_16x16x32_bf16 v[0:3], a[236:239], a[144:147], v[0:3]
ds_read_b64_tr_b16 a[216:217], v211 offset:32768
v_mfma_f32_16x16x32_bf16 v[4:7], a[236:239], a[148:151], v[4:7]
ds_read_b64_tr_b16 a[218:219], v211 offset:36864
v_mfma_f32_16x16x32_bf16 v[4:7], a[232:235], a[132:135], v[4:7]
ds_read_b64_tr_b16 a[220:221], v211 offset:40960
v_mfma_f32_16x16x32_bf16 v[4:7], a[228:231], a[116:119], v[4:7]
ds_read_b64_tr_b16 a[222:223], v211 offset:45056
v_mfma_f32_16x16x32_bf16 v[4:7], a[224:227], a[100:103], v[4:7]
ds_read_b64_tr_b16 a[224:225], v218 offset:0
v_mfma_f32_16x16x32_bf16 v[16:19], a[240:243], a[96:99], v[16:19]
ds_read_b64_tr_b16 a[226:227], v218 offset:4096
v_mfma_f32_16x16x32_bf16 v[16:19], a[244:247], a[112:115], v[16:19]
ds_read_b64_tr_b16 a[228:229], v218 offset:8192
v_mfma_f32_16x16x32_bf16 v[16:19], a[248:251], a[128:131], v[16:19]
ds_read_b64_tr_b16 a[230:231], v218 offset:12288
v_mfma_f32_16x16x32_bf16 v[16:19], a[252:255], a[144:147], v[16:19]
ds_read_b64_tr_b16 a[232:233], v218 offset:16384
v_mfma_f32_16x16x32_bf16 v[20:23], a[252:255], a[148:151], v[20:23]
ds_read_b64_tr_b16 a[234:235], v218 offset:20480
v_mfma_f32_16x16x32_bf16 v[20:23], a[248:251], a[132:135], v[20:23]
ds_read_b64_tr_b16 a[236:237], v218 offset:24576
v_mfma_f32_16x16x32_bf16 v[20:23], a[244:247], a[116:119], v[20:23]
ds_read_b64_tr_b16 a[238:239], v218 offset:28672
v_mfma_f32_16x16x32_bf16 v[20:23], a[240:243], a[100:103], v[20:23]
s_waitcnt lgkmcnt(8)
v_mfma_f32_16x16x32_bf16 v[32:35], a[192:195], a[32:35], v[32:35]
ds_read_b64_tr_b16 a[240:241], v219 offset:0
ds_read_b64_tr_b16 a[242:243], v219 offset:4096
v_mfma_f32_16x16x32_bf16 v[32:35], a[196:199], a[48:51], v[32:35]
ds_read_b64_tr_b16 a[244:245], v219 offset:8192
v_mfma_f32_16x16x32_bf16 v[32:35], a[200:203], a[64:67], v[32:35]
ds_read_b64_tr_b16 a[246:247], v219 offset:12288
v_mfma_f32_16x16x32_bf16 v[32:35], a[204:207], a[80:83], v[32:35]
ds_read_b64_tr_b16 a[248:249], v219 offset:16384
v_mfma_f32_16x16x32_bf16 v[36:39], a[204:207], a[84:87], v[36:39]
ds_read_b64_tr_b16 a[250:251], v219 offset:20480
v_mfma_f32_16x16x32_bf16 v[36:39], a[200:203], a[68:71], v[36:39]
ds_read_b64_tr_b16 a[252:253], v219 offset:24576
v_mfma_f32_16x16x32_bf16 v[36:39], a[196:199], a[52:55], v[36:39]
ds_read_b64_tr_b16 a[254:255], v219 offset:28672
v_mfma_f32_16x16x32_bf16 v[36:39], a[192:195], a[36:39], v[36:39]
ds_read_b64_tr_b16 a[192:193], v228 offset:32768
v_mfma_f32_16x16x32_bf16 v[48:51], a[208:211], a[32:35], v[48:51]
ds_read_b64_tr_b16 a[194:195], v228 offset:34816
v_mfma_f32_16x16x32_bf16 v[48:51], a[212:215], a[48:51], v[48:51]
ds_read_b64_tr_b16 a[196:197], v228 offset:36864
v_mfma_f32_16x16x32_bf16 v[48:51], a[216:219], a[64:67], v[48:51]
ds_read_b64_tr_b16 a[198:199], v228 offset:38912
v_mfma_f32_16x16x32_bf16 v[48:51], a[220:223], a[80:83], v[48:51]
ds_read_b64_tr_b16 a[200:201], v229 offset:32768
v_mfma_f32_16x16x32_bf16 v[52:55], a[220:223], a[84:87], v[52:55]
ds_read_b64_tr_b16 a[202:203], v229 offset:34816
v_mfma_f32_16x16x32_bf16 v[52:55], a[216:219], a[68:71], v[52:55]
ds_read_b64_tr_b16 a[204:205], v229 offset:36864
v_mfma_f32_16x16x32_bf16 v[52:55], a[212:215], a[52:55], v[52:55]
ds_read_b64_tr_b16 a[206:207], v229 offset:38912
v_mfma_f32_16x16x32_bf16 v[52:55], a[208:211], a[36:39], v[52:55]
s_waitcnt lgkmcnt(8)
v_mfma_f32_16x16x32_bf16 v[32:35], a[224:227], a[96:99], v[32:35]
s_add_u32 s51, s76, 786432
s_mov_b64 exec, 0xf
buffer_load_dwordx2 v[246:247], v232, s[16:19], s51 offen sc1
s_mov_b64 exec, -1
v_mfma_f32_16x16x32_bf16 v[32:35], a[228:231], a[112:115], v[32:35]
ds_read_b64_tr_b16 a[208:209], v230 offset:32768
ds_read_b64_tr_b16 a[210:211], v230 offset:34816
v_mfma_f32_16x16x32_bf16 v[32:35], a[232:235], a[128:131], v[32:35]
ds_read_b64_tr_b16 a[212:213], v230 offset:36864
ds_read_b64_tr_b16 a[214:215], v230 offset:38912
v_mfma_f32_16x16x32_bf16 v[32:35], a[236:239], a[144:147], v[32:35]
ds_read_b64_tr_b16 a[216:217], v231 offset:32768
v_mfma_f32_16x16x32_bf16 v[36:39], a[236:239], a[148:151], v[36:39]
ds_read_b64_tr_b16 a[218:219], v231 offset:34816
v_mfma_f32_16x16x32_bf16 v[36:39], a[232:235], a[132:135], v[36:39]
ds_read_b64_tr_b16 a[220:221], v231 offset:36864
v_mfma_f32_16x16x32_bf16 v[36:39], a[228:231], a[116:119], v[36:39]
ds_read_b64_tr_b16 a[222:223], v231 offset:38912
v_mfma_f32_16x16x32_bf16 v[36:39], a[224:227], a[100:103], v[36:39]
s_waitcnt vmcnt(1)
s_add_u32 s50, s34, 655360
buffer_store_dwordx2 v[238:239], v237, s[16:19], s50 offen sc1
v_mfma_f32_16x16x32_bf16 v[48:51], a[240:243], a[96:99], v[48:51]
ds_read_b64_tr_b16 a[224:225], v228 offset:40960
ds_read_b64_tr_b16 a[226:227], v228 offset:43008
v_mfma_f32_16x16x32_bf16 v[48:51], a[244:247], a[112:115], v[48:51]
ds_read_b64_tr_b16 a[228:229], v228 offset:45056
v_mfma_f32_16x16x32_bf16 v[48:51], a[248:251], a[128:131], v[48:51]
ds_read_b64_tr_b16 a[230:231], v228 offset:47104
v_mfma_f32_16x16x32_bf16 v[48:51], a[252:255], a[144:147], v[48:51]
ds_read_b64_tr_b16 a[232:233], v229 offset:40960
v_mfma_f32_16x16x32_bf16 v[52:55], a[252:255], a[148:151], v[52:55]
ds_read_b64_tr_b16 a[234:235], v229 offset:43008
v_mfma_f32_16x16x32_bf16 v[52:55], a[248:251], a[132:135], v[52:55]
ds_read_b64_tr_b16 a[236:237], v229 offset:45056
v_mfma_f32_16x16x32_bf16 v[52:55], a[244:247], a[116:119], v[52:55]
ds_read_b64_tr_b16 a[238:239], v229 offset:47104
v_mfma_f32_16x16x32_bf16 v[52:55], a[240:243], a[100:103], v[52:55]
s_waitcnt lgkmcnt(8)
v_mfma_f32_16x16x32_bf16 v[0:3], a[192:195], a[160:163], v[0:3]
ds_read_b64_tr_b16 a[240:241], v230 offset:40960
ds_read_b64_tr_b16 a[242:243], v230 offset:43008
v_mfma_f32_16x16x32_bf16 v[0:3], a[196:199], a[168:171], v[0:3]
ds_read_b64_tr_b16 a[244:245], v230 offset:45056
v_mfma_f32_16x16x32_bf16 v[4:7], a[196:199], a[172:175], v[4:7]
ds_read_b64_tr_b16 a[246:247], v230 offset:47104
v_mfma_f32_16x16x32_bf16 v[4:7], a[192:195], a[164:167], v[4:7]
ds_read_b64_tr_b16 a[248:249], v231 offset:40960
v_mfma_f32_16x16x32_bf16 v[16:19], a[200:203], a[160:163], v[16:19]
ds_read_b64_tr_b16 a[250:251], v231 offset:43008
v_mfma_f32_16x16x32_bf16 v[16:19], a[204:207], a[168:171], v[16:19]
ds_read_b64_tr_b16 a[252:253], v231 offset:45056
v_mfma_f32_16x16x32_bf16 v[20:23], a[204:207], a[172:175], v[20:23]
ds_read_b64_tr_b16 a[254:255], v231 offset:47104
v_mfma_f32_16x16x32_bf16 v[20:23], a[200:203], a[164:167], v[20:23]
ds_read_b64_tr_b16 a[192:193], v224 offset:0
v_mfma_f32_16x16x32_bf16 v[32:35], a[208:211], a[160:163], v[32:35]
ds_read_b64_tr_b16 a[194:195], v224 offset:2048
v_mfma_f32_16x16x32_bf16 v[32:35], a[212:215], a[168:171], v[32:35]
ds_read_b64_tr_b16 a[196:197], v224 offset:4096
v_mfma_f32_16x16x32_bf16 v[36:39], a[212:215], a[172:175], v[36:39]
ds_read_b64_tr_b16 a[198:199], v224 offset:6144
v_mfma_f32_16x16x32_bf16 v[36:39], a[208:211], a[164:167], v[36:39]
ds_read_b64_tr_b16 a[200:201], v225 offset:0
v_mfma_f32_16x16x32_bf16 v[48:51], a[216:219], a[160:163], v[48:51]
ds_read_b64_tr_b16 a[202:203], v225 offset:2048
v_mfma_f32_16x16x32_bf16 v[48:51], a[220:223], a[168:171], v[48:51]
ds_read_b64_tr_b16 a[204:205], v225 offset:4096
v_mfma_f32_16x16x32_bf16 v[52:55], a[220:223], a[172:175], v[52:55]
ds_read_b64_tr_b16 a[206:207], v225 offset:6144
v_mfma_f32_16x16x32_bf16 v[52:55], a[216:219], a[164:167], v[52:55]
s_waitcnt lgkmcnt(8)
s_waitcnt vmcnt(1)
v_cmp_ne_u64 vcc, s[36:37], v[246:247]
s_mov_b32 s49, 262144
s_cbranch_vccnz Lsp18
Lok17:
v_mfma_f32_16x16x32_bf16 v[0:3], a[224:227], a[176:179], v[0:3]
s_xor_b32 s47, s75, 1572864
ds_read_b64_tr_b16 a[208:209], v226 offset:0
ds_read_b64_tr_b16 a[210:211], v226 offset:2048
v_mfma_f32_16x16x32_bf16 v[0:3], a[228:231], a[184:187], v[0:3]
s_add_u32 s47, s47, 31465472
buffer_load_dwordx4 v[152:155], v233, s[16:19], s47 offen offset:0 sc1
v_mfma_f32_16x16x32_bf16 v[4:7], a[228:231], a[188:191], v[4:7]
ds_read_b64_tr_b16 a[212:213], v226 offset:4096
ds_read_b64_tr_b16 a[214:215], v226 offset:6144
v_mfma_f32_16x16x32_bf16 v[4:7], a[224:227], a[180:183], v[4:7]
buffer_load_dwordx4 v[156:159], v233, s[16:19], s47 offen offset:1024 sc1
v_mfma_f32_16x16x32_bf16 v[16:19], a[232:235], a[176:179], v[16:19]
ds_read_b64_tr_b16 a[216:217], v227 offset:0
ds_read_b64_tr_b16 a[218:219], v227 offset:2048
v_mfma_f32_16x16x32_bf16 v[16:19], a[236:239], a[184:187], v[16:19]
ds_read_b64_tr_b16 a[220:221], v227 offset:4096
v_mfma_f32_16x16x32_bf16 v[20:23], a[236:239], a[188:191], v[20:23]
ds_read_b64_tr_b16 a[222:223], v227 offset:6144
v_mfma_f32_16x16x32_bf16 v[20:23], a[232:235], a[180:183], v[20:23]
buffer_load_dwordx4 v[160:163], v233, s[16:19], s47 offen offset:2048 sc1
v_mfma_f32_16x16x32_bf16 v[32:35], a[240:243], a[176:179], v[32:35]
ds_read_b64_tr_b16 a[224:225], v224 offset:8192
ds_read_b64_tr_b16 a[226:227], v224 offset:10240
v_mfma_f32_16x16x32_bf16 v[32:35], a[244:247], a[184:187], v[32:35]
ds_read_b64_tr_b16 a[228:229], v224 offset:12288
v_mfma_f32_16x16x32_bf16 v[36:39], a[244:247], a[188:191], v[36:39]
buffer_load_dwordx4 v[164:167], v233, s[16:19], s47 offen offset:3072 sc1
v_mfma_f32_16x16x32_bf16 v[36:39], a[240:243], a[180:183], v[36:39]
ds_read_b64_tr_b16 a[230:231], v224 offset:14336
ds_read_b64_tr_b16 a[232:233], v225 offset:8192
v_mfma_f32_16x16x32_bf16 v[48:51], a[248:251], a[176:179], v[48:51]
ds_read_b64_tr_b16 a[234:235], v225 offset:10240
v_mfma_f32_16x16x32_bf16 v[48:51], a[252:255], a[184:187], v[48:51]
ds_read_b64_tr_b16 a[236:237], v225 offset:12288
v_mfma_f32_16x16x32_bf16 v[52:55], a[252:255], a[188:191], v[52:55]
ds_read_b64_tr_b16 a[238:239], v225 offset:14336
v_mfma_f32_16x16x32_bf16 v[52:55], a[248:251], a[180:183], v[52:55]
s_waitcnt lgkmcnt(8)
v_mfma_f32_16x16x32_bf16 v[0:3], a[192:195], a[0:3], v[0:3]
ds_read_b64_tr_b16 a[240:241], v226 offset:8192
s_add_u32 s51, s76, 655360
s_mov_b64 exec, 0xf
buffer_load_dwordx2 v[246:247], v232, s[16:19], s51 offen sc1
s_mov_b64 exec, -1
v_mfma_f32_16x16x32_bf16 v[0:3], a[196:199], a[8:11], v[0:3]
s_xor_b32 s47, s75, 524288
ds_read_b64_tr_b16 a[242:243], v226 offset:10240
v_mfma_f32_16x16x32_bf16 v[4:7], a[196:199], a[12:15], v[4:7]
s_add_u32 s47, s47, 31457280
ds_read_b64_tr_b16 a[244:245], v226 offset:12288
v_mfma_f32_16x16x32_bf16 v[4:7], a[192:195], a[4:7], v[4:7]
ds_read_b64_tr_b16 a[246:247], v226 offset:14336
buffer_load_dwordx4 v[168:171], v233, s[16:19], s47 offen offset:0 sc1
v_mfma_f32_16x16x32_bf16 v[16:19], a[200:203], a[0:3], v[16:19]
ds_read_b64_tr_b16 a[248:249], v227 offset:8192
v_mfma_f32_16x16x32_bf16 v[16:19], a[204:207], a[8:11], v[16:19]
ds_read_b64_tr_b16 a[250:251], v227 offset:10240
v_mfma_f32_16x16x32_bf16 v[20:23], a[204:207], a[12:15], v[20:23]
ds_read_b64_tr_b16 a[252:253], v227 offset:12288
buffer_load_dwordx4 v[172:175], v233, s[16:19], s47 offen offset:1024 sc1
v_mfma_f32_16x16x32_bf16 v[20:23], a[200:203], a[4:7], v[20:23]
ds_read_b64_tr_b16 a[254:255], v227 offset:14336
v_mfma_f32_16x16x32_bf16 v[32:35], a[208:211], a[0:3], v[32:35]
v_mfma_f32_16x16x32_bf16 v[32:35], a[212:215], a[8:11], v[32:35]
buffer_load_dwordx4 v[176:179], v233, s[16:19], s47 offen offset:2048 sc1
v_mfma_f32_16x16x32_bf16 v[36:39], a[212:215], a[12:15], v[36:39]
v_mfma_f32_16x16x32_bf16 v[36:39], a[208:211], a[4:7], v[36:39]
v_mfma_f32_16x16x32_bf16 v[48:51], a[216:219], a[0:3], v[48:51]
buffer_load_dwordx4 v[180:183], v233, s[16:19], s47 offen offset:3072 sc1
v_mfma_f32_16x16x32_bf16 v[48:51], a[220:223], a[8:11], v[48:51]
v_mfma_f32_16x16x32_bf16 v[52:55], a[220:223], a[12:15], v[52:55]
v_mfma_f32_16x16x32_bf16 v[52:55], a[216:219], a[4:7], v[52:55]
s_waitcnt lgkmcnt(0)
v_mfma_f32_16x16x32_bf16 v[0:3], a[224:227], a[16:19], v[0:3]
v_mfma_f32_16x16x32_bf16 v[0:3], a[228:231], a[24:27], v[0:3]
v_mfma_f32_16x16x32_bf16 v[4:7], a[228:231], a[28:31], v[4:7]
v_mfma_f32_16x16x32_bf16 v[4:7], a[224:227], a[20:23], v[4:7]
v_mfma_f32_16x16x32_bf16 v[16:19], a[232:235], a[16:19], v[16:19]
v_mfma_f32_16x16x32_bf16 v[16:19], a[236:239], a[24:27], v[16:19]
v_mfma_f32_16x16x32_bf16 v[20:23], a[236:239], a[28:31], v[20:23]
v_mfma_f32_16x16x32_bf16 v[20:23], a[232:235], a[20:23], v[20:23]
v_mfma_f32_16x16x32_bf16 v[32:35], a[240:243], a[16:19], v[32:35]
v_mfma_f32_16x16x32_bf16 v[32:35], a[244:247], a[24:27], v[32:35]
v_mfma_f32_16x16x32_bf16 v[36:39], a[244:247], a[28:31], v[36:39]
v_mfma_f32_16x16x32_bf16 v[36:39], a[240:243], a[20:23], v[36:39]
v_mfma_f32_16x16x32_bf16 v[48:51], a[248:251], a[16:19], v[48:51]
v_mfma_f32_16x16x32_bf16 v[48:51], a[252:255], a[24:27], v[48:51]
v_mfma_f32_16x16x32_bf16 v[52:55], a[252:255], a[28:31], v[52:55]
v_mfma_f32_16x16x32_bf16 v[52:55], a[248:251], a[20:23], v[52:55]
s_waitcnt vmcnt(4)
v_cmp_ne_u64 vcc, s[36:37], v[246:247]
s_mov_b32 s49, 262144
s_cbranch_vccnz Lsp20
Lok19:
s_xor_b32 s47, s75, 1048576
s_add_u32 s47, s47, 31461376
buffer_load_dwordx4 v[184:187], v233, s[16:19], s47 offen offset:0 sc1
buffer_load_dwordx4 v[188:191], v233, s[16:19], s47 offen offset:1024 sc1
buffer_load_dwordx4 v[192:195], v233, s[16:19], s47 offen offset:2048 sc1
buffer_load_dwordx4 v[196:199], v233, s[16:19], s47 offen offset:3072 sc1
v_mfma_f32_16x16x32_bf16 v[0:3], v[130:133], v[152:155], v[0:3]
v_mfma_f32_16x16x32_bf16 v[16:19], v[128:131], v[152:155], v[16:19]
v_mfma_f32_16x16x32_bf16 v[32:35], v[130:133], v[156:159], v[32:35]
v_mfma_f32_16x16x32_bf16 v[48:51], v[128:131], v[156:159], v[48:51]
v_mfma_f32_16x16x32_bf16 v[4:7], v[130:133], v[160:163], v[4:7]
v_mfma_f32_16x16x32_bf16 v[20:23], v[128:131], v[160:163], v[20:23]
v_mfma_f32_16x16x32_bf16 v[36:39], v[130:133], v[164:167], v[36:39]
v_mfma_f32_16x16x32_bf16 v[52:55], v[128:131], v[164:167], v[52:55]
s_waitcnt vmcnt(7)
v_mfma_f32_16x16x32_bf16 v[0:3], v[130:133], v[168:171], v[0:3]
v_mfma_f32_16x16x32_bf16 v[16:19], v[128:131], v[168:171], v[16:19]
s_waitcnt vmcnt(6)
v_mfma_f32_16x16x32_bf16 v[32:35], v[130:133], v[172:175], v[32:35]
v_mfma_f32_16x16x32_bf16 v[48:51], v[128:131], v[172:175], v[48:51]
s_waitcnt vmcnt(5)
v_mfma_f32_16x16x32_bf16 v[4:7], v[130:133], v[176:179], v[4:7]
v_mfma_f32_16x16x32_bf16 v[20:23], v[128:131], v[176:179], v[20:23]
s_waitcnt vmcnt(4)
v_mfma_f32_16x16x32_bf16 v[36:39], v[130:133], v[180:183], v[36:39]
v_mfma_f32_16x16x32_bf16 v[52:55], v[128:131], v[180:183], v[52:55]
s_waitcnt vmcnt(3)
v_mfma_f32_16x16x32_bf16 v[0:3], v[130:133], v[184:187], v[0:3]
v_mfma_f32_16x16x32_bf16 v[16:19], v[128:131], v[184:187], v[16:19]
s_waitcnt vmcnt(2)
v_mfma_f32_16x16x32_bf16 v[32:35], v[130:133], v[188:191], v[32:35]
v_mfma_f32_16x16x32_bf16 v[48:51], v[128:131], v[188:191], v[48:51]
s_waitcnt vmcnt(1)
v_mfma_f32_16x16x32_bf16 v[4:7], v[130:133], v[192:195], v[4:7]
v_mfma_f32_16x16x32_bf16 v[20:23], v[128:131], v[192:195], v[20:23]
s_waitcnt vmcnt(0)
v_mfma_f32_16x16x32_bf16 v[36:39], v[130:133], v[196:199], v[36:39]
v_mfma_f32_16x16x32_bf16 v[52:55], v[128:131], v[196:199], v[52:55]
v_cvt_pk_bf16_f32 v0, v0, v1
v_cvt_pk_bf16_f32 v1, v2, v3
ds_write_b64 v200, v[0:1] offset:0
v_cvt_pk_bf16_f32 v16, v16, v17
v_cvt_pk_bf16_f32 v17, v18, v19
ds_write_b64 v201, v[16:17] offset:0
v_cvt_pk_bf16_f32 v32, v32, v33
v_cvt_pk_bf16_f32 v33, v34, v35
ds_write_b64 v202, v[32:33] offset:0
v_cvt_pk_bf16_f32 v48, v48, v49
v_cvt_pk_bf16_f32 v49, v50, v51
ds_write_b64 v203, v[48:49] offset:0
ds_read_b128 v[136:139], v204 offset:0
ds_read_b128 v[140:143], v204 offset:1024
v_cvt_pk_bf16_f32 v4, v4, v5
v_cvt_pk_bf16_f32 v5, v6, v7
ds_write_b64 v200, v[4:5] offset:2048
v_cvt_pk_bf16_f32 v20, v20, v21
v_cvt_pk_bf16_f32 v21, v22, v23
ds_write_b64 v201, v[20:21] offset:2048
v_cvt_pk_bf16_f32 v36, v36, v37
v_cvt_pk_bf16_f32 v37, v38, v39
ds_write_b64 v202, v[36:37] offset:2048
v_cvt_pk_bf16_f32 v52, v52, v53
v_cvt_pk_bf16_f32 v53, v54, v55
ds_write_b64 v203, v[52:53] offset:2048
ds_read_b128 v[144:147], v204 offset:2048
ds_read_b128 v[148:151], v204 offset:3072
s_waitcnt lgkmcnt(7)
buffer_store_dwordx4 v[136:139], v251, s[28:31], s77 offen nt
s_add_u32 s77, s77, 16384
s_waitcnt lgkmcnt(6)
buffer_store_dwordx4 v[140:143], v251, s[28:31], s77 offen nt
s_add_u32 s77, s77, 16384
s_waitcnt lgkmcnt(1)
buffer_store_dwordx4 v[144:147], v251, s[28:31], s77 offen nt
s_add_u32 s77, s77, 16384
s_waitcnt lgkmcnt(0)
buffer_store_dwordx4 v[148:151], v251, s[28:31], s77 offen nt
Lend:
s_endpgm
Lsp2:
buffer_load_dwordx2 v[246:247], v235, s[16:19], s57 offen sc1
s_sub_u32 s49, s49, 1
s_waitcnt vmcnt(0)
v_cmp_ne_u64 vcc, s[36:37], v[246:247]
s_cmp_eq_u32 s49, 0
s_cbranch_scc1 Lok1
s_cbranch_vccnz Lsp2
s_branch Lok1
Lsp4:
buffer_load_dwordx2 v[246:247], v255, s[16:19], s53 offen sc1
s_sub_u32 s49, s49, 1
s_waitcnt vmcnt(0)
v_cmp_ne_u64 vcc, s[36:37], v[246:247]
s_cmp_eq_u32 s49, 0
s_cbranch_scc1 Lok3
s_cbranch_vccnz Lsp4
s_branch Lok3
Lsp6:
buffer_load_dwordx2 v[246:247], v245, s[16:19], s51 offen sc1
s_sub_u32 s49, s49, 1
s_waitcnt vmcnt(0)
v_cmp_ne_u64 vcc, s[36:37], v[246:247]
s_cmp_eq_u32 s49, 0
s_cbranch_scc1 Lok5
s_cbranch_vccnz Lsp6
s_branch Lok5
Lrs7o:
v_mov_b32 v64, 0
v_mov_b32 v65, 0
v_mov_b32 v66, 0
v_mov_b32 v67, 0
v_mov_b32 v68, 0
v_mov_b32 v69, 0
v_mov_b32 v70, 0
v_mov_b32 v71, 0
v_mov_b32 v72, 0
v_mov_b32 v73, 0
v_mov_b32 v74, 0
v_mov_b32 v75, 0
v_mov_b32 v76, 0
v_mov_b32 v77, 0
v_mov_b32 v78, 0
v_mov_b32 v79, 0
v_mov_b32 v80, 0
v_mov_b32 v81, 0
v_mov_b32 v82, 0
v_mov_b32 v83, 0
v_mov_b32 v84, 0
v_mov_b32 v85, 0
v_mov_b32 v86, 0
v_mov_b32 v87, 0
v_mov_b32 v88, 0
v_mov_b32 v89, 0
v_mov_b32 v90, 0
v_mov_b32 v91, 0
v_mov_b32 v92, 0
v_mov_b32 v93, 0
v_mov_b32 v94, 0
v_mov_b32 v95, 0
v_mov_b32 v96, 0
v_mov_b32 v97, 0
v_mov_b32 v98, 0
v_mov_b32 v99, 0
v_mov_b32 v100, 0
v_mov_b32 v101, 0
v_mov_b32 v102, 0
v_mov_b32 v103, 0
v_mov_b32 v104, 0
v_mov_b32 v105, 0
v_mov_b32 v106, 0
v_mov_b32 v107, 0
v_mov_b32 v108, 0
v_mov_b32 v109, 0
v_mov_b32 v110, 0
v_mov_b32 v111, 0
s_branch Lrs7
Lsp9:
buffer_load_dwordx2 v[246:247], v235, s[16:19], s51 offen sc1
s_sub_u32 s49, s49, 1
s_waitcnt vmcnt(0)
v_cmp_ne_u64 vcc, s[36:37], v[246:247]
s_cmp_eq_u32 s49, 0
s_cbranch_scc1 Lok8
s_cbranch_vccnz Lsp9
s_branch Lok8
Lrs10o:
v_mov_b32 v64, 0
v_mov_b32 v65, 0
v_mov_b32 v66, 0
v_mov_b32 v67, 0
v_mov_b32 v68, 0
v_mov_b32 v69, 0
v_mov_b32 v70, 0
v_mov_b32 v71, 0
v_mov_b32 v72, 0
v_mov_b32 v73, 0
v_mov_b32 v74, 0
v_mov_b32 v75, 0
v_mov_b32 v76, 0
v_mov_b32 v77, 0
v_mov_b32 v78, 0
v_mov_b32 v79, 0
v_mov_b32 v80, 0
v_mov_b32 v81, 0
v_mov_b32 v82, 0
v_mov_b32 v83, 0
v_mov_b32 v84, 0
v_mov_b32 v85, 0
v_mov_b32 v86, 0
v_mov_b32 v87, 0
v_mov_b32 v88, 0
v_mov_b32 v89, 0
v_mov_b32 v90, 0
v_mov_b32 v91, 0
v_mov_b32 v92, 0
v_mov_b32 v93, 0
v_mov_b32 v94, 0
v_mov_b32 v95, 0
v_mov_b32 v96, 0
v_mov_b32 v97, 0
v_mov_b32 v98, 0
v_mov_b32 v99, 0
v_mov_b32 v100, 0
v_mov_b32 v101, 0
v_mov_b32 v102, 0
v_mov_b32 v103, 0
v_mov_b32 v104, 0
v_mov_b32 v105, 0
v_mov_b32 v106, 0
v_mov_b32 v107, 0
v_mov_b32 v108, 0
v_mov_b32 v109, 0
v_mov_b32 v110, 0
v_mov_b32 v111, 0
s_branch Lrs10
Lrs11o:
v_mov_b32 v64, 0
v_mov_b32 v65, 0
v_mov_b32 v66, 0
v_mov_b32 v67, 0
v_mov_b32 v68, 0
v_mov_b32 v69, 0
v_mov_b32 v70, 0
v_mov_b32 v71, 0
v_mov_b32 v72, 0
v_mov_b32 v73, 0
v_mov_b32 v74, 0
v_mov_b32 v75, 0
v_mov_b32 v76, 0
v_mov_b32 v77, 0
v_mov_b32 v78, 0
v_mov_b32 v79, 0
v_mov_b32 v80, 0
v_mov_b32 v81, 0
v_mov_b32 v82, 0
v_mov_b32 v83, 0
v_mov_b32 v84, 0
v_mov_b32 v85, 0
v_mov_b32 v86, 0
v_mov_b32 v87, 0
v_mov_b32 v88, 0
v_mov_b32 v89, 0
v_mov_b32 v90, 0
v_mov_b32 v91, 0
v_mov_b32 v92, 0
v_mov_b32 v93, 0
v_mov_b32 v94, 0
v_mov_b32 v95, 0
v_mov_b32 v96, 0
v_mov_b32 v97, 0
v_mov_b32 v98, 0
v_mov_b32 v99, 0
v_mov_b32 v100, 0
v_mov_b32 v101, 0
v_mov_b32 v102, 0
v_mov_b32 v103, 0
v_mov_b32 v104, 0
v_mov_b32 v105, 0
v_mov_b32 v106, 0
v_mov_b32 v107, 0
v_mov_b32 v108, 0
v_mov_b32 v109, 0
v_mov_b32 v110, 0
v_mov_b32 v111, 0
s_branch Lrs11
Lrs12o:
v_mov_b32 v64, 0
v_mov_b32 v65, 0
v_mov_b32 v66, 0
v_mov_b32 v67, 0
v_mov_b32 v68, 0
v_mov_b32 v69, 0
v_mov_b32 v70, 0
v_mov_b32 v71, 0
v_mov_b32 v72, 0
v_mov_b32 v73, 0
v_mov_b32 v74, 0
v_mov_b32 v75, 0
v_mov_b32 v76, 0
v_mov_b32 v77, 0
v_mov_b32 v78, 0
v_mov_b32 v79, 0
v_mov_b32 v80, 0
v_mov_b32 v81, 0
v_mov_b32 v82, 0
v_mov_b32 v83, 0
v_mov_b32 v84, 0
v_mov_b32 v85, 0
v_mov_b32 v86, 0
v_mov_b32 v87, 0
v_mov_b32 v88, 0
v_mov_b32 v89, 0
v_mov_b32 v90, 0
v_mov_b32 v91, 0
v_mov_b32 v92, 0
v_mov_b32 v93, 0
v_mov_b32 v94, 0
v_mov_b32 v95, 0
v_mov_b32 v96, 0
v_mov_b32 v97, 0
v_mov_b32 v98, 0
v_mov_b32 v99, 0
v_mov_b32 v100, 0
v_mov_b32 v101, 0
v_mov_b32 v102, 0
v_mov_b32 v103, 0
v_mov_b32 v104, 0
v_mov_b32 v105, 0
v_mov_b32 v106, 0
v_mov_b32 v107, 0
v_mov_b32 v108, 0
v_mov_b32 v109, 0
v_mov_b32 v110, 0
v_mov_b32 v111, 0
s_branch Lrs12
Lsp14:
buffer_load_dwordx2 v[246:247], v235, s[16:19], s51 offen sc1
s_sub_u32 s49, s49, 1
s_waitcnt vmcnt(0)
v_cmp_ne_u64 vcc, s[36:37], v[246:247]
s_cmp_eq_u32 s49, 0
s_cbranch_scc1 Lok13
s_cbranch_vccnz Lsp14
s_branch Lok13
Lsp16:
buffer_load_dwordx2 v[246:247], v236, s[16:19], s51 offen sc1
s_sub_u32 s49, s49, 1
s_waitcnt vmcnt(0)
v_cmp_ne_u64 vcc, s[36:37], v[246:247]
s_cmp_eq_u32 s49, 0
s_cbranch_scc1 Lok15
s_cbranch_vccnz Lsp16
s_branch Lok15
Lsp18:
buffer_load_dwordx2 v[246:247], v232, s[16:19], s51 offen sc1
s_sub_u32 s49, s49, 1
s_waitcnt vmcnt(0)
v_cmp_ne_u64 vcc, s[36:37], v[246:247]
s_cmp_eq_u32 s49, 0
s_cbranch_scc1 Lok17
s_cbranch_vccnz Lsp18
s_branch Lok17
Lsp20:
buffer_load_dwordx2 v[246:247], v232, s[16:19], s51 offen sc1
s_sub_u32 s49, s49, 1
s_waitcnt vmcnt(0)
v_cmp_ne_u64 vcc, s[36:37], v[246:247]
s_cmp_eq_u32 s49, 0
s_cbranch_scc1 Lok19
s_cbranch_vccnz Lsp20
s_branch Lok19
Lhot_end:
Lfallback:
s_waitcnt lgkmcnt(0)
v_mov_b32 v60, v58
v_mov_b32 v61, v58
v_mov_b32 v62, v58
v_mov_b32 v63, v58
ds_read_b128 a[192:195], v56 offset:0
ds_read_b128 a[196:199], v56 offset:1024
s_waitcnt lgkmcnt(0)
v_mfma_f32_16x16x32_bf16 v[112:115], a[192:195], v[0:3], v[52:55]
ds_read_b128 a[200:203], v56 offset:2048
ds_read_b128 a[204:207], v56 offset:3072
v_mfma_f32_16x16x32_bf16 v[116:119], a[196:199], v[0:3], 0
v_mfma_f32_16x16x32_bf16 v[120:123], a[196:199], v[4:7], v[52:55]
s_waitcnt lgkmcnt(0)
v_mfma_f32_16x16x32_bf16 v[124:127], a[200:203], v[0:3], 0
ds_read_b128 a[192:195], v56 offset:4096
ds_read_b128 a[196:199], v56 offset:5120
v_max3_f32 v60, v112, v113, v60
v_max3_f32 v60, v114, v115, v60
v_mfma_f32_16x16x32_bf16 v[128:131], a[204:207], v[0:3], 0
v_max3_f32 v60, v116, v117, v60
v_max3_f32 v60, v118, v119, v60
v_mfma_f32_16x16x32_bf16 v[132:135], a[200:203], v[4:7], 0
v_max3_f32 v61, v120, v121, v61
v_max3_f32 v61, v122, v123, v61
v_mfma_f32_16x16x32_bf16 v[136:139], a[204:207], v[4:7], 0
v_max3_f32 v60, v124, v125, v60
v_max3_f32 v60, v126, v127, v60
v_mfma_f32_16x16x32_bf16 v[140:143], a[200:203], v[8:11], v[52:55]
v_max3_f32 v60, v128, v129, v60
v_max3_f32 v60, v130, v131, v60
v_mfma_f32_16x16x32_bf16 v[112:115], a[204:207], v[8:11], 0
v_max3_f32 v61, v132, v133, v61
v_max3_f32 v61, v134, v135, v61
v_mfma_f32_16x16x32_bf16 v[116:119], a[204:207], v[12:15], v[52:55]
v_max3_f32 v61, v136, v137, v61
v_max3_f32 v61, v138, v139, v61
s_waitcnt lgkmcnt(0)
v_mfma_f32_16x16x32_bf16 v[120:123], a[192:195], v[0:3], 0
ds_read_b128 a[200:203], v56 offset:6144
ds_read_b128 a[204:207], v56 offset:7168
v_max3_f32 v62, v140, v141, v62
v_max3_f32 v62, v142, v143, v62
v_mfma_f32_16x16x32_bf16 v[124:127], a[196:199], v[0:3], 0
v_max3_f32 v62, v112, v113, v62
v_max3_f32 v62, v114, v115, v62
v_mfma_f32_16x16x32_bf16 v[128:131], a[192:195], v[4:7], 0
v_max3_f32 v63, v116, v117, v63
v_max3_f32 v63, v118, v119, v63
v_mfma_f32_16x16x32_bf16 v[132:135], a[196:199], v[4:7], 0
s_cmp_eq_u32 s35, 2
s_cbranch_scc1 Lrs21o
Lrs21:
v_max3_f32 v60, v120, v121, v60
v_max3_f32 v60, v122, v123, v60
v_mfma_f32_16x16x32_bf16 v[136:139], a[192:195], v[8:11], 0
v_max3_f32 v60, v124, v125, v60
v_max3_f32 v60, v126, v127, v60
v_mfma_f32_16x16x32_bf16 v[140:143], a[196:199], v[8:11], 0
v_max3_f32 v61, v128, v129, v61
v_max3_f32 v61, v130, v131, v61
v_mfma_f32_16x16x32_bf16 v[112:115], a[192:195], v[12:15], 0
v_max3_f32 v61, v132, v133, v61
v_max3_f32 v61, v134, v135, v61
v_mfma_f32_16x16x32_bf16 v[116:119], a[196:199], v[12:15], 0
v_max3_f32 v62, v136, v137, v62
v_max3_f32 v62, v138, v139, v62
s_waitcnt lgkmcnt(0)
v_mfma_f32_16x16x32_bf16 v[120:123], a[200:203], v[0:3], 0
ds_read_b128 a[192:195], v56 offset:8192
ds_read_b128 a[196:199], v56 offset:9216
v_max3_f32 v62, v140, v141, v62
v_max3_f32 v62, v142, v143, v62
v_mfma_f32_16x16x32_bf16 v[124:127], a[204:207], v[0:3], 0
v_max3_f32 v63, v112, v113, v63
v_max3_f32 v63, v114, v115, v63
v_mfma_f32_16x16x32_bf16 v[128:131], a[200:203], v[4:7], 0
v_max3_f32 v63, v116, v117, v63
v_max3_f32 v63, v118, v119, v63
v_mfma_f32_16x16x32_bf16 v[132:135], a[204:207], v[4:7], 0
v_max3_f32 v60, v120, v121, v60
v_max3_f32 v60, v122, v123, v60
v_mfma_f32_16x16x32_bf16 v[136:139], a[200:203], v[8:11], 0
v_max3_f32 v60, v124, v125, v60
v_max3_f32 v60, v126, v127, v60
v_mfma_f32_16x16x32_bf16 v[140:143], a[204:207], v[8:11], 0
v_max3_f32 v61, v128, v129, v61
v_max3_f32 v61, v130, v131, v61
v_mfma_f32_16x16x32_bf16 v[112:115], a[200:203], v[12:15], 0
v_max3_f32 v61, v132, v133, v61
v_max3_f32 v61, v134, v135, v61
v_mfma_f32_16x16x32_bf16 v[116:119], a[204:207], v[12:15], 0
v_max3_f32 v62, v136, v137, v62
v_max3_f32 v62, v138, v139, v62
s_waitcnt lgkmcnt(0)
v_mfma_f32_16x16x32_bf16 v[120:123], a[192:195], v[0:3], 0
ds_read_b128 a[200:203], v56 offset:10240
ds_read_b128 a[204:207], v56 offset:11264
v_max3_f32 v62, v140, v141, v62
v_max3_f32 v62, v142, v143, v62
v_mfma_f32_16x16x32_bf16 v[124:127], a[196:199], v[0:3], 0
v_max3_f32 v63, v112, v113, v63
v_max3_f32 v63, v114, v115, v63
v_mfma_f32_16x16x32_bf16 v[128:131], a[192:195], v[4:7], 0
v_max3_f32 v63, v116, v117, v63
v_max3_f32 v63, v118, v119, v63
v_mfma_f32_16x16x32_bf16 v[132:135], a[196:199], v[4:7], 0
s_cmp_eq_u32 s35, 4
s_cbranch_scc1 Lrs22o
Lrs22:
v_max3_f32 v60, v120, v121, v60
v_max3_f32 v60, v122, v123, v60
v_mfma_f32_16x16x32_bf16 v[136:139], a[192:195], v[8:11], 0
v_max3_f32 v60, v124, v125, v60
v_max3_f32 v60, v126, v127, v60
v_mfma_f32_16x16x32_bf16 v[140:143], a[196:199], v[8:11], 0
v_max3_f32 v61, v128, v129, v61
v_max3_f32 v61, v130, v131, v61
v_mfma_f32_16x16x32_bf16 v[112:115], a[192:195], v[12:15], 0
v_max3_f32 v61, v132, v133, v61
v_max3_f32 v61, v134, v135, v61
v_mfma_f32_16x16x32_bf16 v[116:119], a[196:199], v[12:15], 0
v_max3_f32 v62, v136, v137, v62
v_max3_f32 v62, v138, v139, v62
s_waitcnt lgkmcnt(0)
v_mfma_f32_16x16x32_bf16 v[120:123], a[200:203], v[0:3], 0
ds_read_b128 a[192:195], v56 offset:12288
ds_read_b128 a[196:199], v56 offset:13312
v_max3_f32 v62, v140, v141, v62
v_max3_f32 v62, v142, v143, v62
v_mfma_f32_16x16x32_bf16 v[124:127], a[204:207], v[0:3], 0
v_max3_f32 v63, v112, v113, v63
v_max3_f32 v63, v114, v115, v63
v_mfma_f32_16x16x32_bf16 v[128:131], a[200:203], v[4:7], 0
v_max3_f32 v63, v116, v117, v63
v_max3_f32 v63, v118, v119, v63
v_mfma_f32_16x16x32_bf16 v[132:135], a[204:207], v[4:7], 0
v_max3_f32 v60, v120, v121, v60
v_max3_f32 v60, v122, v123, v60
v_mfma_f32_16x16x32_bf16 v[136:139], a[200:203], v[8:11], 0
v_max3_f32 v60, v124, v125, v60
v_max3_f32 v60, v126, v127, v60
v_mfma_f32_16x16x32_bf16 v[140:143], a[204:207], v[8:11], 0
v_max3_f32 v61, v128, v129, v61
v_max3_f32 v61, v130, v131, v61
v_mfma_f32_16x16x32_bf16 v[112:115], a[200:203], v[12:15], 0
v_max3_f32 v61, v132, v133, v61
v_max3_f32 v61, v134, v135, v61
v_mfma_f32_16x16x32_bf16 v[116:119], a[204:207], v[12:15], 0
v_max3_f32 v62, v136, v137, v62
v_max3_f32 v62, v138, v139, v62
s_waitcnt lgkmcnt(0)
v_mfma_f32_16x16x32_bf16 v[120:123], a[192:195], v[0:3], 0
ds_read_b128 a[200:203], v56 offset:14336
ds_read_b128 a[204:207], v56 offset:15360
v_max3_f32 v62, v140, v141, v62
v_max3_f32 v62, v142, v143, v62
v_mfma_f32_16x16x32_bf16 v[124:127], a[196:199], v[0:3], 0
v_max3_f32 v63, v112, v113, v63
v_max3_f32 v63, v114, v115, v63
v_mfma_f32_16x16x32_bf16 v[128:131], a[192:195], v[4:7], 0
v_max3_f32 v63, v116, v117, v63
v_max3_f32 v63, v118, v119, v63
v_mfma_f32_16x16x32_bf16 v[132:135], a[196:199], v[4:7], 0
s_cmp_eq_u32 s35, 6
s_cbranch_scc1 Lrs23o
Lrs23:
v_max3_f32 v60, v120, v121, v60
v_max3_f32 v60, v122, v123, v60
v_mfma_f32_16x16x32_bf16 v[136:139], a[192:195], v[8:11], 0
v_max3_f32 v60, v124, v125, v60
v_max3_f32 v60, v126, v127, v60
v_mfma_f32_16x16x32_bf16 v[140:143], a[196:199], v[8:11], 0
v_max3_f32 v61, v128, v129, v61
v_max3_f32 v61, v130, v131, v61
v_mfma_f32_16x16x32_bf16 v[112:115], a[192:195], v[12:15], 0
v_max3_f32 v61, v132, v133, v61
v_max3_f32 v61, v134, v135, v61
v_mfma_f32_16x16x32_bf16 v[116:119], a[196:199], v[12:15], 0
v_max3_f32 v62, v136, v137, v62
v_max3_f32 v62, v138, v139, v62
s_waitcnt lgkmcnt(0)
v_mfma_f32_16x16x32_bf16 v[120:123], a[200:203], v[0:3], 0
ds_read_b128 a[192:195], v56 offset:16384
ds_read_b128 a[196:199], v56 offset:17408
v_max3_f32 v62, v140, v141, v62
v_max3_f32 v62, v142, v143, v62
v_mfma_f32_16x16x32_bf16 v[124:127], a[204:207], v[0:3], 0
v_max3_f32 v63, v112, v113, v63
v_max3_f32 v63, v114, v115, v63
v_mfma_f32_16x16x32_bf16 v[128:131], a[200:203], v[4:7], 0
v_max3_f32 v63, v116, v117, v63
v_max3_f32 v63, v118, v119, v63
v_mfma_f32_16x16x32_bf16 v[132:135], a[204:207], v[4:7], 0
v_max3_f32 v60, v120, v121, v60
v_max3_f32 v60, v122, v123, v60
v_mfma_f32_16x16x32_bf16 v[136:139], a[200:203], v[8:11], 0
v_max3_f32 v60, v124, v125, v60
v_max3_f32 v60, v126, v127, v60
v_mfma_f32_16x16x32_bf16 v[140:143], a[204:207], v[8:11], 0
v_max3_f32 v61, v128, v129, v61
v_max3_f32 v61, v130, v131, v61
v_mfma_f32_16x16x32_bf16 v[112:115], a[200:203], v[12:15], 0
v_max3_f32 v61, v132, v133, v61
v_max3_f32 v61, v134, v135, v61
v_mfma_f32_16x16x32_bf16 v[116:119], a[204:207], v[12:15], 0
v_max3_f32 v62, v136, v137, v62
v_max3_f32 v62, v138, v139, v62
s_waitcnt lgkmcnt(0)
v_mfma_f32_16x16x32_bf16 v[120:123], a[192:195], v[0:3], v[48:51]
ds_read_b128 a[200:203], v56 offset:18432
ds_read_b128 a[204:207], v56 offset:19456
v_max3_f32 v62, v140, v141, v62
v_max3_f32 v62, v142, v143, v62
v_mfma_f32_16x16x32_bf16 v[124:127], a[192:195], v[4:7], 0
v_max3_f32 v63, v112, v113, v63
v_max3_f32 v63, v114, v115, v63
v_mfma_f32_16x16x32_bf16 v[128:131], a[196:199], v[4:7], v[48:51]
v_max3_f32 v63, v116, v117, v63
v_max3_f32 v63, v118, v119, v63
v_mfma_f32_16x16x32_bf16 v[132:135], a[192:195], v[8:11], 0
s_cmp_eq_u32 s35, 8
s_cbranch_scc1 Lrs24o
Lrs24:
v_max3_f32 v60, v120, v121, v60
v_max3_f32 v60, v122, v123, v60
v_mfma_f32_16x16x32_bf16 v[136:139], a[196:199], v[8:11], 0
v_max3_f32 v61, v124, v125, v61
v_max3_f32 v61, v126, v127, v61
v_mfma_f32_16x16x32_bf16 v[140:143], a[192:195], v[12:15], 0
v_max3_f32 v61, v128, v129, v61
v_max3_f32 v61, v130, v131, v61
v_mfma_f32_16x16x32_bf16 v[112:115], a[196:199], v[12:15], 0
v_max3_f32 v62, v132, v133, v62
v_max3_f32 v62, v134, v135, v62
s_waitcnt lgkmcnt(0)
v_mfma_f32_16x16x32_bf16 v[116:119], a[200:203], v[8:11], v[48:51]
v_max3_f32 v62, v136, v137, v62
v_max3_f32 v62, v138, v139, v62
v_mfma_f32_16x16x32_bf16 v[120:123], a[200:203], v[12:15], 0
v_max3_f32 v63, v140, v141, v63
v_max3_f32 v63, v142, v143, v63
v_mfma_f32_16x16x32_bf16 v[124:127], a[204:207], v[12:15], v[48:51]
v_max3_f32 v63, v112, v113, v63
v_max3_f32 v63, v114, v115, v63
v_max3_f32 v62, v116, v117, v62
v_max3_f32 v62, v118, v119, v62
s_nop 0
v_max3_f32 v63, v120, v121, v63
v_max3_f32 v63, v122, v123, v63
s_nop 0
v_max3_f32 v63, v124, v125, v63
v_max3_f32 v63, v126, v127, v63
v_mov_b32 v196, v60
v_mov_b32 v197, v61
v_mov_b32 v198, v62
v_mov_b32 v199, v63
v_permlane16_swap_b32 v60, v196
v_permlane16_swap_b32 v61, v197
v_permlane16_swap_b32 v62, v198
v_permlane16_swap_b32 v63, v199
v_max_f32 v60, v60, v196
v_max_f32 v61, v61, v197
v_max_f32 v62, v62, v198
v_max_f32 v63, v63, v199
v_mov_b32 v196, v60
v_mov_b32 v197, v61
v_mov_b32 v198, v62
v_mov_b32 v199, v63
v_permlane32_swap_b32 v60, v196
v_permlane32_swap_b32 v61, v197
v_permlane32_swap_b32 v62, v198
v_permlane32_swap_b32 v63, v199
v_max_f32 v60, v60, v196
v_max_f32 v61, v61, v197
v_max_f32 v62, v62, v198
v_max_f32 v63, v63, v199
v_sub_f32 v16, 0, v60
v_sub_f32 v17, 0, v60
v_sub_f32 v18, 0, v60
v_sub_f32 v19, 0, v60
v_sub_f32 v20, 0, v61
v_sub_f32 v21, 0, v61
v_sub_f32 v22, 0, v61
v_sub_f32 v23, 0, v61
v_sub_f32 v24, 0, v62
v_sub_f32 v25, 0, v62
v_sub_f32 v26, 0, v62
v_sub_f32 v27, 0, v62
v_sub_f32 v28, 0, v63
v_sub_f32 v29, 0, v63
v_sub_f32 v30, 0, v63
v_sub_f32 v31, 0, v63
ds_read_b128 a[192:195], v56 offset:0
ds_read_b128 a[196:199], v56 offset:1024
ds_read_b128 a[200:203], v56 offset:2048
ds_read_b128 a[204:207], v56 offset:3072
ds_read_b128 a[208:211], v57 offset:0
ds_read_b128 a[212:215], v57 offset:1024
v_add_f32 v32, v52, v16
v_add_f32 v33, v53, v17
v_add_f32 v34, v54, v18
v_add_f32 v35, v55, v19
v_add_f32 v36, v52, v20
v_add_f32 v37, v53, v21
v_add_f32 v38, v54, v22
v_add_f32 v39, v55, v23
s_waitcnt lgkmcnt(4)
v_mfma_f32_16x16x32_bf16 v[112:115], a[192:195], v[0:3], v[32:35]
v_mfma_f32_16x16x32_bf16 v[116:119], a[196:199], v[0:3], v[16:19]
v_mfma_f32_16x16x32_bf16 v[124:127], a[196:199], v[4:7], v[36:39]
s_waitcnt lgkmcnt(2)
v_mfma_f32_16x16x32_bf16 v[128:131], a[200:203], v[0:3], v[16:19]
ds_read_b128 a[192:195], v56 offset:4096
ds_read_b128 a[196:199], v56 offset:5120
ds_read_b128 a[216:219], v57 offset:2048
ds_read_b128 a[220:223], v57 offset:3072
v_exp_f32 v112, v112
v_exp_f32 v113, v113
v_exp_f32 v114, v114
v_cvt_pk_bf16_f32 v144, v112, v113
v_exp_f32 v115, v115
v_mfma_f32_16x16x32_bf16 v[132:135], a[204:207], v[0:3], v[16:19]
v_exp_f32 v116, v116
v_cvt_pk_bf16_f32 v145, v114, v115
v_exp_f32 v117, v117
v_exp_f32 v118, v118
v_mfma_f32_16x16x32_bf16 v[136:139], a[200:203], v[4:7], v[20:23]
v_cvt_pk_bf16_f32 v146, v116, v117
v_exp_f32 v119, v119
v_mov_b32 v148, 0
v_cvt_pk_bf16_f32 v147, v118, v119
v_mov_b32 v149, 0
v_exp_f32 v124, v124
v_mfma_f32_16x16x32_bf16 v[140:143], a[204:207], v[4:7], v[20:23]
v_exp_f32 v125, v125
v_exp_f32 v126, v126
v_cvt_pk_bf16_f32 v150, v124, v125
v_exp_f32 v127, v127
v_add_f32 v32, v52, v24
v_add_f32 v33, v53, v25
v_add_f32 v34, v54, v26
v_add_f32 v35, v55, v27
v_add_f32 v36, v52, v28
v_add_f32 v37, v53, v29
v_add_f32 v38, v54, v30
v_add_f32 v39, v55, v31
v_mfma_f32_16x16x32_bf16 v[112:115], a[200:203], v[8:11], v[32:35]
v_cvt_pk_bf16_f32 v151, v126, v127
v_exp_f32 v128, v128
v_exp_f32 v129, v129
v_mfma_f32_16x16x32_bf16 v[116:119], a[204:207], v[8:11], v[24:27]
v_exp_f32 v130, v130
v_cvt_pk_bf16_f32 v152, v128, v129
v_exp_f32 v131, v131
v_mfma_f32_16x16x32_bf16 v[124:127], a[204:207], v[12:15], v[36:39]
s_waitcnt lgkmcnt(4)
v_exp_f32 v132, v132
v_cvt_pk_bf16_f32 v153, v130, v131
v_exp_f32 v133, v133
v_mfma_f32_16x16x32_bf16 v[64:67], a[208:211], v[144:147], 0
v_exp_f32 v134, v134
v_cvt_pk_bf16_f32 v154, v132, v133
v_mfma_f32_16x16x32_bf16 v[68:71], a[212:215], v[144:147], 0
v_exp_f32 v135, v135
v_exp_f32 v136, v136
v_cvt_pk_bf16_f32 v155, v134, v135
v_mfma_f32_16x16x32_bf16 v[96:99], a[232:235], v[144:147], 0
v_exp_f32 v137, v137
v_exp_f32 v138, v138
v_mfma_f32_16x16x32_bf16 v[72:75], a[208:211], v[148:151], 0
v_cvt_pk_bf16_f32 v156, v136, v137
v_exp_f32 v139, v139
v_exp_f32 v140, v140
v_mfma_f32_16x16x32_bf16 v[76:79], a[212:215], v[148:151], 0
v_cvt_pk_bf16_f32 v157, v138, v139
v_exp_f32 v141, v141
v_exp_f32 v142, v142
v_mfma_f32_16x16x32_bf16 v[100:103], a[232:235], v[148:151], 0
v_cvt_pk_bf16_f32 v158, v140, v141
v_exp_f32 v143, v143
s_waitcnt lgkmcnt(2)
v_mfma_f32_16x16x32_bf16 v[128:131], a[192:195], v[0:3], v[16:19]
ds_read_b128 a[200:203], v56 offset:6144
ds_read_b128 a[204:207], v56 offset:7168
ds_read_b128 a[224:227], v57 offset:4096
ds_read_b128 a[228:231], v57 offset:5120
v_cvt_pk_bf16_f32 v159, v142, v143
v_exp_f32 v112, v112
v_exp_f32 v113, v113
v_mfma_f32_16x16x32_bf16 v[132:135], a[196:199], v[0:3], v[16:19]
v_exp_f32 v114, v114
v_mfma_f32_16x16x32_bf16 v[136:139], a[192:195], v[4:7], v[20:23]
v_cvt_pk_bf16_f32 v144, v112, v113
v_exp_f32 v115, v115
v_mfma_f32_16x16x32_bf16 v[140:143], a[196:199], v[4:7], v[20:23]
s_waitcnt lgkmcnt(4)
v_exp_f32 v116, v116
v_cvt_pk_bf16_f32 v145, v114, v115
v_mfma_f32_16x16x32_bf16 v[64:67], a[216:219], v[152:155], v[64:67]
v_exp_f32 v117, v117
v_exp_f32 v118, v118
v_mfma_f32_16x16x32_bf16 v[68:71], a[220:223], v[152:155], v[68:71]
v_cvt_pk_bf16_f32 v146, v116, v117
v_exp_f32 v119, v119
v_mfma_f32_16x16x32_bf16 v[96:99], a[232:235], v[152:155], v[96:99]
v_mov_b32 v148, 0
v_cvt_pk_bf16_f32 v147, v118, v119
v_mov_b32 v149, 0
v_mfma_f32_16x16x32_bf16 v[72:75], a[216:219], v[156:159], v[72:75]
v_exp_f32 v124, v124
v_exp_f32 v125, v125
v_mfma_f32_16x16x32_bf16 v[76:79], a[220:223], v[156:159], v[76:79]
v_exp_f32 v126, v126
v_mfma_f32_16x16x32_bf16 v[100:103], a[232:235], v[156:159], v[100:103]
v_cvt_pk_bf16_f32 v150, v124, v125
v_exp_f32 v127, v127
v_mfma_f32_16x16x32_bf16 v[112:115], a[192:195], v[8:11], v[24:27]
v_cvt_pk_bf16_f32 v151, v126, v127
v_exp_f32 v128, v128
v_exp_f32 v129, v129
v_mfma_f32_16x16x32_bf16 v[116:119], a[196:199], v[8:11], v[24:27]
v_exp_f32 v130, v130
v_cvt_pk_bf16_f32 v152, v128, v129
v_mfma_f32_16x16x32_bf16 v[120:123], a[192:195], v[12:15], v[28:31]
v_exp_f32 v131, v131
v_exp_f32 v132, v132
v_mfma_f32_16x16x32_bf16 v[124:127], a[196:199], v[12:15], v[28:31]
v_cvt_pk_bf16_f32 v153, v130, v131
v_exp_f32 v133, v133
v_exp_f32 v134, v134
v_mfma_f32_16x16x32_bf16 v[80:83], a[216:219], v[144:147], 0
v_cvt_pk_bf16_f32 v154, v132, v133
v_exp_f32 v135, v135
v_mfma_f32_16x16x32_bf16 v[84:87], a[220:223], v[144:147], 0
v_exp_f32 v136, v136
v_cvt_pk_bf16_f32 v155, v134, v135
v_exp_f32 v137, v137
v_mfma_f32_16x16x32_bf16 v[104:107], a[232:235], v[144:147], 0
v_exp_f32 v138, v138
v_cvt_pk_bf16_f32 v156, v136, v137
v_mfma_f32_16x16x32_bf16 v[88:91], a[216:219], v[148:151], 0
v_exp_f32 v139, v139
v_exp_f32 v140, v140
v_mfma_f32_16x16x32_bf16 v[92:95], a[220:223], v[148:151], 0
v_cvt_pk_bf16_f32 v157, v138, v139
v_exp_f32 v141, v141
v_exp_f32 v142, v142
v_mfma_f32_16x16x32_bf16 v[108:111], a[232:235], v[148:151], 0
v_cvt_pk_bf16_f32 v158, v140, v141
v_exp_f32 v143, v143
s_waitcnt lgkmcnt(2)
v_mfma_f32_16x16x32_bf16 v[128:131], a[200:203], v[0:3], v[16:19]
ds_read_b128 a[192:195], v56 offset:8192
ds_read_b128 a[196:199], v56 offset:9216
ds_read_b128 a[208:211], v57 offset:6144
ds_read_b128 a[212:215], v57 offset:7168
v_cvt_pk_bf16_f32 v159, v142, v143
v_exp_f32 v112, v112
v_exp_f32 v113, v113
v_mfma_f32_16x16x32_bf16 v[132:135], a[204:207], v[0:3], v[16:19]
v_exp_f32 v114, v114
v_cvt_pk_bf16_f32 v144, v112, v113
v_mfma_f32_16x16x32_bf16 v[136:139], a[200:203], v[4:7], v[20:23]
v_exp_f32 v115, v115
v_exp_f32 v116, v116
v_mfma_f32_16x16x32_bf16 v[140:143], a[204:207], v[4:7], v[20:23]
s_waitcnt lgkmcnt(4)
v_cvt_pk_bf16_f32 v145, v114, v115
v_exp_f32 v117, v117
v_exp_f32 v118, v118
s_cmp_eq_u32 s35, 2
s_cbranch_scc1 Lrs25o
Lrs25:
v_mfma_f32_16x16x32_bf16 v[64:67], a[224:227], v[152:155], v[64:67]
v_cvt_pk_bf16_f32 v146, v116, v117
v_exp_f32 v119, v119
v_mfma_f32_16x16x32_bf16 v[68:71], a[228:231], v[152:155], v[68:71]
v_exp_f32 v120, v120
v_cvt_pk_bf16_f32 v147, v118, v119
v_exp_f32 v121, v121
v_mfma_f32_16x16x32_bf16 v[96:99], a[232:235], v[152:155], v[96:99]
v_exp_f32 v122, v122
v_cvt_pk_bf16_f32 v148, v120, v121
v_mfma_f32_16x16x32_bf16 v[72:75], a[224:227], v[156:159], v[72:75]
v_exp_f32 v123, v123
v_exp_f32 v124, v124
v_mfma_f32_16x16x32_bf16 v[76:79], a[228:231], v[156:159], v[76:79]
v_cvt_pk_bf16_f32 v149, v122, v123
v_exp_f32 v125, v125
v_exp_f32 v126, v126
v_mfma_f32_16x16x32_bf16 v[100:103], a[232:235], v[156:159], v[100:103]
v_cvt_pk_bf16_f32 v150, v124, v125
v_exp_f32 v127, v127
v_mfma_f32_16x16x32_bf16 v[112:115], a[200:203], v[8:11], v[24:27]
v_cvt_pk_bf16_f32 v151, v126, v127
v_exp_f32 v128, v128
v_exp_f32 v129, v129
v_mfma_f32_16x16x32_bf16 v[116:119], a[204:207], v[8:11], v[24:27]
v_exp_f32 v130, v130
v_cvt_pk_bf16_f32 v152, v128, v129
v_mfma_f32_16x16x32_bf16 v[120:123], a[200:203], v[12:15], v[28:31]
v_exp_f32 v131, v131
v_exp_f32 v132, v132
v_mfma_f32_16x16x32_bf16 v[124:127], a[204:207], v[12:15], v[28:31]
v_cvt_pk_bf16_f32 v153, v130, v131
v_exp_f32 v133, v133
v_exp_f32 v134, v134
v_mfma_f32_16x16x32_bf16 v[80:83], a[224:227], v[144:147], v[80:83]
v_cvt_pk_bf16_f32 v154, v132, v133
v_exp_f32 v135, v135
v_mfma_f32_16x16x32_bf16 v[84:87], a[228:231], v[144:147], v[84:87]
v_exp_f32 v136, v136
v_cvt_pk_bf16_f32 v155, v134, v135
v_exp_f32 v137, v137
v_mfma_f32_16x16x32_bf16 v[104:107], a[232:235], v[144:147], v[104:107]
v_exp_f32 v138, v138
v_cvt_pk_bf16_f32 v156, v136, v137
v_mfma_f32_16x16x32_bf16 v[88:91], a[224:227], v[148:151], v[88:91]
v_exp_f32 v139, v139
v_exp_f32 v140, v140
v_mfma_f32_16x16x32_bf16 v[92:95], a[228:231], v[148:151], v[92:95]
v_cvt_pk_bf16_f32 v157, v138, v139
v_exp_f32 v141, v141
v_exp_f32 v142, v142
v_mfma_f32_16x16x32_bf16 v[108:111], a[232:235], v[148:151], v[108:111]
v_cvt_pk_bf16_f32 v158, v140, v141
v_exp_f32 v143, v143
s_waitcnt lgkmcnt(2)
v_mfma_f32_16x16x32_bf16 v[128:131], a[192:195], v[0:3], v[16:19]
ds_read_b128 a[200:203], v56 offset:10240
ds_read_b128 a[204:207], v56 offset:11264
ds_read_b128 a[216:219], v57 offset:8192
ds_read_b128 a[220:223], v57 offset:9216
v_cvt_pk_bf16_f32 v159, v142, v143
v_exp_f32 v112, v112
v_exp_f32 v113, v113
v_mfma_f32_16x16x32_bf16 v[132:135], a[196:199], v[0:3], v[16:19]
v_exp_f32 v114, v114
v_cvt_pk_bf16_f32 v144, v112, v113
v_mfma_f32_16x16x32_bf16 v[136:139], a[192:195], v[4:7], v[20:23]
v_exp_f32 v115, v115
v_exp_f32 v116, v116
v_mfma_f32_16x16x32_bf16 v[140:143], a[196:199], v[4:7], v[20:23]
s_waitcnt lgkmcnt(4)
v_cvt_pk_bf16_f32 v145, v114, v115
v_exp_f32 v117, v117
v_exp_f32 v118, v118
v_mfma_f32_16x16x32_bf16 v[64:67], a[208:211], v[152:155], v[64:67]
v_cvt_pk_bf16_f32 v146, v116, v117
v_exp_f32 v119, v119
v_mfma_f32_16x16x32_bf16 v[68:71], a[212:215], v[152:155], v[68:71]
v_exp_f32 v120, v120
v_cvt_pk_bf16_f32 v147, v118, v119
v_exp_f32 v121, v121
v_mfma_f32_16x16x32_bf16 v[96:99], a[232:235], v[152:155], v[96:99]
v_exp_f32 v122, v122
v_cvt_pk_bf16_f32 v148, v120, v121
v_mfma_f32_16x16x32_bf16 v[72:75], a[208:211], v[156:159], v[72:75]
v_exp_f32 v123, v123
v_exp_f32 v124, v124
v_mfma_f32_16x16x32_bf16 v[76:79], a[212:215], v[156:159], v[76:79]
v_cvt_pk_bf16_f32 v149, v122, v123
v_exp_f32 v125, v125
v_exp_f32 v126, v126
v_mfma_f32_16x16x32_bf16 v[100:103], a[232:235], v[156:159], v[100:103]
v_cvt_pk_bf16_f32 v150, v124, v125
v_exp_f32 v127, v127
v_mfma_f32_16x16x32_bf16 v[112:115], a[192:195], v[8:11], v[24:27]
v_cvt_pk_bf16_f32 v151, v126, v127
v_exp_f32 v128, v128
v_exp_f32 v129, v129
v_mfma_f32_16x16x32_bf16 v[116:119], a[196:199], v[8:11], v[24:27]
v_exp_f32 v130, v130
v_cvt_pk_bf16_f32 v152, v128, v129
v_mfma_f32_16x16x32_bf16 v[120:123], a[192:195], v[12:15], v[28:31]
v_exp_f32 v131, v131
v_exp_f32 v132, v132
v_mfma_f32_16x16x32_bf16 v[124:127], a[196:199], v[12:15], v[28:31]
v_cvt_pk_bf16_f32 v153, v130, v131
v_exp_f32 v133, v133
v_exp_f32 v134, v134
v_mfma_f32_16x16x32_bf16 v[80:83], a[208:211], v[144:147], v[80:83]
v_cvt_pk_bf16_f32 v154, v132, v133
v_exp_f32 v135, v135
v_mfma_f32_16x16x32_bf16 v[84:87], a[212:215], v[144:147], v[84:87]
v_exp_f32 v136, v136
v_cvt_pk_bf16_f32 v155, v134, v135
v_exp_f32 v137, v137
v_mfma_f32_16x16x32_bf16 v[104:107], a[232:235], v[144:147], v[104:107]
v_exp_f32 v138, v138
v_cvt_pk_bf16_f32 v156, v136, v137
v_mfma_f32_16x16x32_bf16 v[88:91], a[208:211], v[148:151], v[88:91]
v_exp_f32 v139, v139
v_exp_f32 v140, v140
v_mfma_f32_16x16x32_bf16 v[92:95], a[212:215], v[148:151], v[92:95]
v_cvt_pk_bf16_f32 v157, v138, v139
v_exp_f32 v141, v141
v_exp_f32 v142, v142
v_mfma_f32_16x16x32_bf16 v[108:111], a[232:235], v[148:151], v[108:111]
v_cvt_pk_bf16_f32 v158, v140, v141
v_exp_f32 v143, v143
s_waitcnt lgkmcnt(2)
v_mfma_f32_16x16x32_bf16 v[128:131], a[200:203], v[0:3], v[16:19]
ds_read_b128 a[192:195], v56 offset:12288
ds_read_b128 a[196:199], v56 offset:13312
ds_read_b128 a[224:227], v57 offset:10240
ds_read_b128 a[228:231], v57 offset:11264
v_cvt_pk_bf16_f32 v159, v142, v143
v_exp_f32 v112, v112
v_exp_f32 v113, v113
v_mfma_f32_16x16x32_bf16 v[132:135], a[204:207], v[0:3], v[16:19]
v_exp_f32 v114, v114
v_cvt_pk_bf16_f32 v144, v112, v113
v_mfma_f32_16x16x32_bf16 v[136:139], a[200:203], v[4:7], v[20:23]
v_exp_f32 v115, v115
v_exp_f32 v116, v116
v_mfma_f32_16x16x32_bf16 v[140:143], a[204:207], v[4:7], v[20:23]
s_waitcnt lgkmcnt(4)
v_cvt_pk_bf16_f32 v145, v114, v115
v_exp_f32 v117, v117
v_exp_f32 v118, v118
s_cmp_eq_u32 s35, 4
s_cbranch_scc1 Lrs26o
Lrs26:
v_mfma_f32_16x16x32_bf16 v[64:67], a[216:219], v[152:155], v[64:67]
v_cvt_pk_bf16_f32 v146, v116, v117
v_exp_f32 v119, v119
v_mfma_f32_16x16x32_bf16 v[68:71], a[220:223], v[152:155], v[68:71]
v_exp_f32 v120, v120
v_cvt_pk_bf16_f32 v147, v118, v119
v_exp_f32 v121, v121
v_mfma_f32_16x16x32_bf16 v[96:99], a[232:235], v[152:155], v[96:99]
v_exp_f32 v122, v122
v_cvt_pk_bf16_f32 v148, v120, v121
v_mfma_f32_16x16x32_bf16 v[72:75], a[216:219], v[156:159], v[72:75]
v_exp_f32 v123, v123
v_exp_f32 v124, v124
v_mfma_f32_16x16x32_bf16 v[76:79], a[220:223], v[156:159], v[76:79]
v_cvt_pk_bf16_f32 v149, v122, v123
v_exp_f32 v125, v125
v_exp_f32 v126, v126
v_mfma_f32_16x16x32_bf16 v[100:103], a[232:235], v[156:159], v[100:103]
v_cvt_pk_bf16_f32 v150, v124, v125
v_exp_f32 v127, v127
v_mfma_f32_16x16x32_bf16 v[112:115], a[200:203], v[8:11], v[24:27]
v_cvt_pk_bf16_f32 v151, v126, v127
v_exp_f32 v128, v128
v_exp_f32 v129, v129
v_mfma_f32_16x16x32_bf16 v[116:119], a[204:207], v[8:11], v[24:27]
v_exp_f32 v130, v130
v_cvt_pk_bf16_f32 v152, v128, v129
v_mfma_f32_16x16x32_bf16 v[120:123], a[200:203], v[12:15], v[28:31]
v_exp_f32 v131, v131
v_exp_f32 v132, v132
v_mfma_f32_16x16x32_bf16 v[124:127], a[204:207], v[12:15], v[28:31]
v_cvt_pk_bf16_f32 v153, v130, v131
v_exp_f32 v133, v133
v_exp_f32 v134, v134
v_mfma_f32_16x16x32_bf16 v[80:83], a[216:219], v[144:147], v[80:83]
v_cvt_pk_bf16_f32 v154, v132, v133
v_exp_f32 v135, v135
v_mfma_f32_16x16x32_bf16 v[84:87], a[220:223], v[144:147], v[84:87]
v_exp_f32 v136, v136
v_cvt_pk_bf16_f32 v155, v134, v135
v_exp_f32 v137, v137
v_mfma_f32_16x16x32_bf16 v[104:107], a[232:235], v[144:147], v[104:107]
v_exp_f32 v138, v138
v_cvt_pk_bf16_f32 v156, v136, v137
v_mfma_f32_16x16x32_bf16 v[88:91], a[216:219], v[148:151], v[88:91]
v_exp_f32 v139, v139
v_exp_f32 v140, v140
v_mfma_f32_16x16x32_bf16 v[92:95], a[220:223], v[148:151], v[92:95]
v_cvt_pk_bf16_f32 v157, v138, v139
v_exp_f32 v141, v141
v_exp_f32 v142, v142
v_mfma_f32_16x16x32_bf16 v[108:111], a[232:235], v[148:151], v[108:111]
v_cvt_pk_bf16_f32 v158, v140, v141
v_exp_f32 v143, v143
s_waitcnt lgkmcnt(2)
v_mfma_f32_16x16x32_bf16 v[128:131], a[192:195], v[0:3], v[16:19]
ds_read_b128 a[200:203], v56 offset:14336
ds_read_b128 a[204:207], v56 offset:15360
ds_read_b128 a[208:211], v57 offset:12288
ds_read_b128 a[212:215], v57 offset:13312
v_cvt_pk_bf16_f32 v159, v142, v143
v_exp_f32 v112, v112
v_exp_f32 v113, v113
v_mfma_f32_16x16x32_bf16 v[132:135], a[196:199], v[0:3], v[16:19]
v_exp_f32 v114, v114
v_cvt_pk_bf16_f32 v144, v112, v113
v_mfma_f32_16x16x32_bf16 v[136:139], a[192:195], v[4:7], v[20:23]
v_exp_f32 v115, v115
v_exp_f32 v116, v116
v_mfma_f32_16x16x32_bf16 v[140:143], a[196:199], v[4:7], v[20:23]
s_waitcnt lgkmcnt(4)
v_cvt_pk_bf16_f32 v145, v114, v115
v_exp_f32 v117, v117
v_exp_f32 v118, v118
v_mfma_f32_16x16x32_bf16 v[64:67], a[224:227], v[152:155], v[64:67]
v_cvt_pk_bf16_f32 v146, v116, v117
v_exp_f32 v119, v119
v_mfma_f32_16x16x32_bf16 v[68:71], a[228:231], v[152:155], v[68:71]
v_exp_f32 v120, v120
v_cvt_pk_bf16_f32 v147, v118, v119
v_exp_f32 v121, v121
v_mfma_f32_16x16x32_bf16 v[96:99], a[232:235], v[152:155], v[96:99]
v_exp_f32 v122, v122
v_cvt_pk_bf16_f32 v148, v120, v121
v_mfma_f32_16x16x32_bf16 v[72:75], a[224:227], v[156:159], v[72:75]
v_exp_f32 v123, v123
v_exp_f32 v124, v124
v_mfma_f32_16x16x32_bf16 v[76:79], a[228:231], v[156:159], v[76:79]
v_cvt_pk_bf16_f32 v149, v122, v123
v_exp_f32 v125, v125
v_exp_f32 v126, v126
v_mfma_f32_16x16x32_bf16 v[100:103], a[232:235], v[156:159], v[100:103]
v_cvt_pk_bf16_f32 v150, v124, v125
v_exp_f32 v127, v127
v_mfma_f32_16x16x32_bf16 v[112:115], a[192:195], v[8:11], v[24:27]
v_cvt_pk_bf16_f32 v151, v126, v127
v_exp_f32 v128, v128
v_exp_f32 v129, v129
v_mfma_f32_16x16x32_bf16 v[116:119], a[196:199], v[8:11], v[24:27]
v_exp_f32 v130, v130
v_cvt_pk_bf16_f32 v152, v128, v129
v_mfma_f32_16x16x32_bf16 v[120:123], a[192:195], v[12:15], v[28:31]
v_exp_f32 v131, v131
v_exp_f32 v132, v132
v_mfma_f32_16x16x32_bf16 v[124:127], a[196:199], v[12:15], v[28:31]
v_cvt_pk_bf16_f32 v153, v130, v131
v_exp_f32 v133, v133
v_exp_f32 v134, v134
v_mfma_f32_16x16x32_bf16 v[80:83], a[224:227], v[144:147], v[80:83]
v_cvt_pk_bf16_f32 v154, v132, v133
v_exp_f32 v135, v135
v_mfma_f32_16x16x32_bf16 v[84:87], a[228:231], v[144:147], v[84:87]
v_exp_f32 v136, v136
v_cvt_pk_bf16_f32 v155, v134, v135
v_exp_f32 v137, v137
v_mfma_f32_16x16x32_bf16 v[104:107], a[232:235], v[144:147], v[104:107]
v_exp_f32 v138, v138
v_cvt_pk_bf16_f32 v156, v136, v137
v_mfma_f32_16x16x32_bf16 v[88:91], a[224:227], v[148:151], v[88:91]
v_exp_f32 v139, v139
v_exp_f32 v140, v140
v_mfma_f32_16x16x32_bf16 v[92:95], a[228:231], v[148:151], v[92:95]
v_cvt_pk_bf16_f32 v157, v138, v139
v_exp_f32 v141, v141
v_exp_f32 v142, v142
v_mfma_f32_16x16x32_bf16 v[108:111], a[232:235], v[148:151], v[108:111]
v_cvt_pk_bf16_f32 v158, v140, v141
v_exp_f32 v143, v143
s_waitcnt lgkmcnt(2)
v_mfma_f32_16x16x32_bf16 v[128:131], a[200:203], v[0:3], v[16:19]
ds_read_b128 a[192:195], v56 offset:16384
ds_read_b128 a[196:199], v56 offset:17408
ds_read_b128 a[216:219], v57 offset:14336
ds_read_b128 a[220:223], v57 offset:15360
v_cvt_pk_bf16_f32 v159, v142, v143
v_exp_f32 v112, v112
v_exp_f32 v113, v113
v_mfma_f32_16x16x32_bf16 v[132:135], a[204:207], v[0:3], v[16:19]
v_exp_f32 v114, v114
v_cvt_pk_bf16_f32 v144, v112, v113
v_mfma_f32_16x16x32_bf16 v[136:139], a[200:203], v[4:7], v[20:23]
v_exp_f32 v115, v115
v_exp_f32 v116, v116
v_mfma_f32_16x16x32_bf16 v[140:143], a[204:207], v[4:7], v[20:23]
s_waitcnt lgkmcnt(4)
v_cvt_pk_bf16_f32 v145, v114, v115
v_exp_f32 v117, v117
v_exp_f32 v118, v118
s_cmp_eq_u32 s35, 6
s_cbranch_scc1 Lrs27o
Lrs27:
v_mfma_f32_16x16x32_bf16 v[64:67], a[208:211], v[152:155], v[64:67]
v_cvt_pk_bf16_f32 v146, v116, v117
v_exp_f32 v119, v119
v_mfma_f32_16x16x32_bf16 v[68:71], a[212:215], v[152:155], v[68:71]
v_exp_f32 v120, v120
v_cvt_pk_bf16_f32 v147, v118, v119
v_exp_f32 v121, v121
v_mfma_f32_16x16x32_bf16 v[96:99], a[232:235], v[152:155], v[96:99]
v_exp_f32 v122, v122
v_cvt_pk_bf16_f32 v148, v120, v121
v_mfma_f32_16x16x32_bf16 v[72:75], a[208:211], v[156:159], v[72:75]
v_exp_f32 v123, v123
v_exp_f32 v124, v124
v_mfma_f32_16x16x32_bf16 v[76:79], a[212:215], v[156:159], v[76:79]
v_cvt_pk_bf16_f32 v149, v122, v123
v_exp_f32 v125, v125
v_exp_f32 v126, v126
v_mfma_f32_16x16x32_bf16 v[100:103], a[232:235], v[156:159], v[100:103]
v_cvt_pk_bf16_f32 v150, v124, v125
v_exp_f32 v127, v127
v_mfma_f32_16x16x32_bf16 v[112:115], a[200:203], v[8:11], v[24:27]
v_cvt_pk_bf16_f32 v151, v126, v127
v_exp_f32 v128, v128
v_exp_f32 v129, v129
v_mfma_f32_16x16x32_bf16 v[116:119], a[204:207], v[8:11], v[24:27]
v_exp_f32 v130, v130
v_cvt_pk_bf16_f32 v152, v128, v129
v_mfma_f32_16x16x32_bf16 v[120:123], a[200:203], v[12:15], v[28:31]
v_exp_f32 v131, v131
v_exp_f32 v132, v132
v_mfma_f32_16x16x32_bf16 v[124:127], a[204:207], v[12:15], v[28:31]
v_cvt_pk_bf16_f32 v153, v130, v131
v_exp_f32 v133, v133
v_exp_f32 v134, v134
v_mfma_f32_16x16x32_bf16 v[80:83], a[208:211], v[144:147], v[80:83]
v_cvt_pk_bf16_f32 v154, v132, v133
v_exp_f32 v135, v135
v_mfma_f32_16x16x32_bf16 v[84:87], a[212:215], v[144:147], v[84:87]
v_exp_f32 v136, v136
v_cvt_pk_bf16_f32 v155, v134, v135
v_exp_f32 v137, v137
v_mfma_f32_16x16x32_bf16 v[104:107], a[232:235], v[144:147], v[104:107]
v_exp_f32 v138, v138
v_cvt_pk_bf16_f32 v156, v136, v137
v_mfma_f32_16x16x32_bf16 v[88:91], a[208:211], v[148:151], v[88:91]
v_exp_f32 v139, v139
v_exp_f32 v140, v140
v_mfma_f32_16x16x32_bf16 v[92:95], a[212:215], v[148:151], v[92:95]
v_cvt_pk_bf16_f32 v157, v138, v139
v_exp_f32 v141, v141
v_exp_f32 v142, v142
v_mfma_f32_16x16x32_bf16 v[108:111], a[232:235], v[148:151], v[108:111]
v_cvt_pk_bf16_f32 v158, v140, v141
v_exp_f32 v143, v143
v_add_f32 v40, v48, v16
v_add_f32 v41, v49, v17
v_add_f32 v42, v50, v18
v_add_f32 v43, v51, v19
v_add_f32 v44, v48, v20
v_add_f32 v45, v49, v21
v_add_f32 v46, v50, v22
v_add_f32 v47, v51, v23
s_waitcnt lgkmcnt(2)
v_mfma_f32_16x16x32_bf16 v[128:131], a[192:195], v[0:3], v[40:43]
ds_read_b128 a[200:203], v56 offset:18432
ds_read_b128 a[204:207], v56 offset:19456
ds_read_b128 a[224:227], v57 offset:16384
ds_read_b128 a[228:231], v57 offset:17408
v_cvt_pk_bf16_f32 v159, v142, v143
v_exp_f32 v112, v112
v_exp_f32 v113, v113
v_mfma_f32_16x16x32_bf16 v[136:139], a[192:195], v[4:7], v[20:23]
v_exp_f32 v114, v114
v_cvt_pk_bf16_f32 v144, v112, v113
v_exp_f32 v115, v115
v_mfma_f32_16x16x32_bf16 v[140:143], a[196:199], v[4:7], v[44:47]
s_waitcnt lgkmcnt(4)
v_exp_f32 v116, v116
v_cvt_pk_bf16_f32 v145, v114, v115
v_exp_f32 v117, v117
v_mfma_f32_16x16x32_bf16 v[64:67], a[216:219], v[152:155], v[64:67]
v_exp_f32 v118, v118
v_cvt_pk_bf16_f32 v146, v116, v117
v_mfma_f32_16x16x32_bf16 v[68:71], a[220:223], v[152:155], v[68:71]
v_exp_f32 v119, v119
v_exp_f32 v120, v120
v_cvt_pk_bf16_f32 v147, v118, v119
v_mfma_f32_16x16x32_bf16 v[96:99], a[232:235], v[152:155], v[96:99]
v_exp_f32 v121, v121
v_exp_f32 v122, v122
v_mfma_f32_16x16x32_bf16 v[72:75], a[216:219], v[156:159], v[72:75]
v_cvt_pk_bf16_f32 v148, v120, v121
v_exp_f32 v123, v123
v_exp_f32 v124, v124
v_mfma_f32_16x16x32_bf16 v[76:79], a[220:223], v[156:159], v[76:79]
v_cvt_pk_bf16_f32 v149, v122, v123
v_exp_f32 v125, v125
v_exp_f32 v126, v126
v_mfma_f32_16x16x32_bf16 v[100:103], a[232:235], v[156:159], v[100:103]
v_cvt_pk_bf16_f32 v150, v124, v125
v_exp_f32 v127, v127
v_mfma_f32_16x16x32_bf16 v[112:115], a[192:195], v[8:11], v[24:27]
v_cvt_pk_bf16_f32 v151, v126, v127
v_exp_f32 v128, v128
v_exp_f32 v129, v129
v_mfma_f32_16x16x32_bf16 v[116:119], a[196:199], v[8:11], v[24:27]
v_exp_f32 v130, v130
v_mfma_f32_16x16x32_bf16 v[120:123], a[192:195], v[12:15], v[28:31]
v_cvt_pk_bf16_f32 v152, v128, v129
v_exp_f32 v131, v131
v_mfma_f32_16x16x32_bf16 v[124:127], a[196:199], v[12:15], v[28:31]
v_mov_b32 v154, 0
v_cvt_pk_bf16_f32 v153, v130, v131
v_mov_b32 v155, 0
v_mfma_f32_16x16x32_bf16 v[80:83], a[216:219], v[144:147], v[80:83]
v_exp_f32 v136, v136
v_exp_f32 v137, v137
v_mfma_f32_16x16x32_bf16 v[84:87], a[220:223], v[144:147], v[84:87]
v_exp_f32 v138, v138
v_cvt_pk_bf16_f32 v156, v136, v137
v_mfma_f32_16x16x32_bf16 v[104:107], a[232:235], v[144:147], v[104:107]
v_exp_f32 v139, v139
v_exp_f32 v140, v140
v_mfma_f32_16x16x32_bf16 v[88:91], a[216:219], v[148:151], v[88:91]
v_cvt_pk_bf16_f32 v157, v138, v139
v_exp_f32 v141, v141
v_mfma_f32_16x16x32_bf16 v[92:95], a[220:223], v[148:151], v[92:95]
v_exp_f32 v142, v142
v_mfma_f32_16x16x32_bf16 v[108:111], a[232:235], v[148:151], v[108:111]
v_cvt_pk_bf16_f32 v158, v140, v141
v_exp_f32 v143, v143
v_add_f32 v40, v48, v24
v_add_f32 v41, v49, v25
v_add_f32 v42, v50, v26
v_add_f32 v43, v51, v27
v_add_f32 v44, v48, v28
v_add_f32 v45, v49, v29
v_add_f32 v46, v50, v30
v_add_f32 v47, v51, v31
s_waitcnt lgkmcnt(2)
v_mfma_f32_16x16x32_bf16 v[128:131], a[200:203], v[8:11], v[40:43]
ds_read_b128 a[208:211], v57 offset:18432
ds_read_b128 a[212:215], v57 offset:19456
v_cvt_pk_bf16_f32 v159, v142, v143
v_exp_f32 v112, v112
v_exp_f32 v113, v113
v_mfma_f32_16x16x32_bf16 v[136:139], a[200:203], v[12:15], v[28:31]
v_exp_f32 v114, v114
v_cvt_pk_bf16_f32 v144, v112, v113
v_exp_f32 v115, v115
v_mfma_f32_16x16x32_bf16 v[140:143], a[204:207], v[12:15], v[44:47]
s_waitcnt lgkmcnt(2)
v_exp_f32 v116, v116
v_cvt_pk_bf16_f32 v145, v114, v115
v_exp_f32 v117, v117
s_cmp_eq_u32 s35, 8
s_cbranch_scc1 Lrs28o
Lrs28:
v_mfma_f32_16x16x32_bf16 v[64:67], a[224:227], v[152:155], v[64:67]
v_exp_f32 v118, v118
v_cvt_pk_bf16_f32 v146, v116, v117
v_mfma_f32_16x16x32_bf16 v[68:71], a[228:231], v[152:155], v[68:71]
v_exp_f32 v119, v119
v_exp_f32 v120, v120
v_cvt_pk_bf16_f32 v147, v118, v119
v_mfma_f32_16x16x32_bf16 v[96:99], a[232:235], v[152:155], v[96:99]
v_exp_f32 v121, v121
v_exp_f32 v122, v122
v_mfma_f32_16x16x32_bf16 v[72:75], a[224:227], v[156:159], v[72:75]
v_cvt_pk_bf16_f32 v148, v120, v121
v_exp_f32 v123, v123
v_exp_f32 v124, v124
v_mfma_f32_16x16x32_bf16 v[76:79], a[228:231], v[156:159], v[76:79]
v_cvt_pk_bf16_f32 v149, v122, v123
v_exp_f32 v125, v125
v_exp_f32 v126, v126
v_mfma_f32_16x16x32_bf16 v[100:103], a[232:235], v[156:159], v[100:103]
v_cvt_pk_bf16_f32 v150, v124, v125
v_exp_f32 v127, v127
s_waitcnt lgkmcnt(0)
v_mfma_f32_16x16x32_bf16 v[80:83], a[224:227], v[144:147], v[80:83]
v_cvt_pk_bf16_f32 v151, v126, v127
v_exp_f32 v128, v128
v_exp_f32 v129, v129
v_exp_f32 v130, v130
v_mfma_f32_16x16x32_bf16 v[84:87], a[228:231], v[144:147], v[84:87]
v_cvt_pk_bf16_f32 v152, v128, v129
v_exp_f32 v131, v131
v_mov_b32 v154, 0
v_mfma_f32_16x16x32_bf16 v[104:107], a[232:235], v[144:147], v[104:107]
v_cvt_pk_bf16_f32 v153, v130, v131
v_mov_b32 v155, 0
v_exp_f32 v136, v136
v_exp_f32 v137, v137
v_mfma_f32_16x16x32_bf16 v[88:91], a[224:227], v[148:151], v[88:91]
v_exp_f32 v138, v138
v_cvt_pk_bf16_f32 v156, v136, v137
v_exp_f32 v139, v139
v_mfma_f32_16x16x32_bf16 v[92:95], a[228:231], v[148:151], v[92:95]
v_exp_f32 v140, v140
v_cvt_pk_bf16_f32 v157, v138, v139
v_exp_f32 v141, v141
v_mfma_f32_16x16x32_bf16 v[108:111], a[232:235], v[148:151], v[108:111]
v_exp_f32 v142, v142
v_cvt_pk_bf16_f32 v158, v140, v141
v_exp_f32 v143, v143
s_nop 0
v_cvt_pk_bf16_f32 v159, v142, v143
v_mfma_f32_16x16x32_bf16 v[80:83], a[208:211], v[152:155], v[80:83]
v_mfma_f32_16x16x32_bf16 v[84:87], a[212:215], v[152:155], v[84:87]
v_mfma_f32_16x16x32_bf16 v[104:107], a[232:235], v[152:155], v[104:107]
v_mfma_f32_16x16x32_bf16 v[88:91], a[208:211], v[156:159], v[88:91]
v_mfma_f32_16x16x32_bf16 v[92:95], a[212:215], v[156:159], v[92:95]
v_mfma_f32_16x16x32_bf16 v[108:111], a[232:235], v[156:159], v[108:111]
s_nop 7
s_branch Lattn_done
Lrs21o:
v_mov_b32 v60, v58
v_mov_b32 v61, v58
v_mov_b32 v62, v58
v_mov_b32 v63, v58
s_branch Lrs21
Lrs22o:
v_mov_b32 v60, v58
v_mov_b32 v61, v58
v_mov_b32 v62, v58
v_mov_b32 v63, v58
s_branch Lrs22
Lrs23o:
v_mov_b32 v60, v58
v_mov_b32 v61, v58
v_mov_b32 v62, v58
v_mov_b32 v63, v58
s_branch Lrs23
Lrs24o:
v_mov_b32 v60, v58
v_mov_b32 v61, v58
v_mov_b32 v62, v58
v_mov_b32 v63, v58
s_branch Lrs24
Lrs25o:
v_mov_b32 v64, 0
v_mov_b32 v65, 0
v_mov_b32 v66, 0
v_mov_b32 v67, 0
v_mov_b32 v68, 0
v_mov_b32 v69, 0
v_mov_b32 v70, 0
v_mov_b32 v71, 0
v_mov_b32 v72, 0
v_mov_b32 v73, 0
v_mov_b32 v74, 0
v_mov_b32 v75, 0
v_mov_b32 v76, 0
v_mov_b32 v77, 0
v_mov_b32 v78, 0
v_mov_b32 v79, 0
v_mov_b32 v80, 0
v_mov_b32 v81, 0
v_mov_b32 v82, 0
v_mov_b32 v83, 0
v_mov_b32 v84, 0
v_mov_b32 v85, 0
v_mov_b32 v86, 0
v_mov_b32 v87, 0
v_mov_b32 v88, 0
v_mov_b32 v89, 0
v_mov_b32 v90, 0
v_mov_b32 v91, 0
v_mov_b32 v92, 0
v_mov_b32 v93, 0
v_mov_b32 v94, 0
v_mov_b32 v95, 0
v_mov_b32 v96, 0
v_mov_b32 v97, 0
v_mov_b32 v98, 0
v_mov_b32 v99, 0
v_mov_b32 v100, 0
v_mov_b32 v101, 0
v_mov_b32 v102, 0
v_mov_b32 v103, 0
v_mov_b32 v104, 0
v_mov_b32 v105, 0
v_mov_b32 v106, 0
v_mov_b32 v107, 0
v_mov_b32 v108, 0
v_mov_b32 v109, 0
v_mov_b32 v110, 0
v_mov_b32 v111, 0
s_branch Lrs25
Lrs26o:
v_mov_b32 v64, 0
v_mov_b32 v65, 0
v_mov_b32 v66, 0
v_mov_b32 v67, 0
v_mov_b32 v68, 0
v_mov_b32 v69, 0
v_mov_b32 v70, 0
v_mov_b32 v71, 0
v_mov_b32 v72, 0
v_mov_b32 v73, 0
v_mov_b32 v74, 0
v_mov_b32 v75, 0
v_mov_b32 v76, 0
v_mov_b32 v77, 0
v_mov_b32 v78, 0
v_mov_b32 v79, 0
v_mov_b32 v80, 0
v_mov_b32 v81, 0
v_mov_b32 v82, 0
v_mov_b32 v83, 0
v_mov_b32 v84, 0
v_mov_b32 v85, 0
v_mov_b32 v86, 0
v_mov_b32 v87, 0
v_mov_b32 v88, 0
v_mov_b32 v89, 0
v_mov_b32 v90, 0
v_mov_b32 v91, 0
v_mov_b32 v92, 0
v_mov_b32 v93, 0
v_mov_b32 v94, 0
v_mov_b32 v95, 0
v_mov_b32 v96, 0
v_mov_b32 v97, 0
v_mov_b32 v98, 0
v_mov_b32 v99, 0
v_mov_b32 v100, 0
v_mov_b32 v101, 0
v_mov_b32 v102, 0
v_mov_b32 v103, 0
v_mov_b32 v104, 0
v_mov_b32 v105, 0
v_mov_b32 v106, 0
v_mov_b32 v107, 0
v_mov_b32 v108, 0
v_mov_b32 v109, 0
v_mov_b32 v110, 0
v_mov_b32 v111, 0
s_branch Lrs26
Lrs27o:
v_mov_b32 v64, 0
v_mov_b32 v65, 0
v_mov_b32 v66, 0
v_mov_b32 v67, 0
v_mov_b32 v68, 0
v_mov_b32 v69, 0
v_mov_b32 v70, 0
v_mov_b32 v71, 0
v_mov_b32 v72, 0
v_mov_b32 v73, 0
v_mov_b32 v74, 0
v_mov_b32 v75, 0
v_mov_b32 v76, 0
v_mov_b32 v77, 0
v_mov_b32 v78, 0
v_mov_b32 v79, 0
v_mov_b32 v80, 0
v_mov_b32 v81, 0
v_mov_b32 v82, 0
v_mov_b32 v83, 0
v_mov_b32 v84, 0
v_mov_b32 v85, 0
v_mov_b32 v86, 0
v_mov_b32 v87, 0
v_mov_b32 v88, 0
v_mov_b32 v89, 0
v_mov_b32 v90, 0
v_mov_b32 v91, 0
v_mov_b32 v92, 0
v_mov_b32 v93, 0
v_mov_b32 v94, 0
v_mov_b32 v95, 0
v_mov_b32 v96, 0
v_mov_b32 v97, 0
v_mov_b32 v98, 0
v_mov_b32 v99, 0
v_mov_b32 v100, 0
v_mov_b32 v101, 0
v_mov_b32 v102, 0
v_mov_b32 v103, 0
v_mov_b32 v104, 0
v_mov_b32 v105, 0
v_mov_b32 v106, 0
v_mov_b32 v107, 0
v_mov_b32 v108, 0
v_mov_b32 v109, 0
v_mov_b32 v110, 0
v_mov_b32 v111, 0
s_branch Lrs27
Lrs28o:
v_mov_b32 v64, 0
v_mov_b32 v65, 0
v_mov_b32 v66, 0
v_mov_b32 v67, 0
v_mov_b32 v68, 0
v_mov_b32 v69, 0
v_mov_b32 v70, 0
v_mov_b32 v71, 0
v_mov_b32 v72, 0
v_mov_b32 v73, 0
v_mov_b32 v74, 0
v_mov_b32 v75, 0
v_mov_b32 v76, 0
v_mov_b32 v77, 0
v_mov_b32 v78, 0
v_mov_b32 v79, 0
v_mov_b32 v80, 0
v_mov_b32 v81, 0
v_mov_b32 v82, 0
v_mov_b32 v83, 0
v_mov_b32 v84, 0
v_mov_b32 v85, 0
v_mov_b32 v86, 0
v_mov_b32 v87, 0
v_mov_b32 v88, 0
v_mov_b32 v89, 0
v_mov_b32 v90, 0
v_mov_b32 v91, 0
v_mov_b32 v92, 0
v_mov_b32 v93, 0
v_mov_b32 v94, 0
v_mov_b32 v95, 0
v_mov_b32 v96, 0
v_mov_b32 v97, 0
v_mov_b32 v98, 0
v_mov_b32 v99, 0
v_mov_b32 v100, 0
v_mov_b32 v101, 0
v_mov_b32 v102, 0
v_mov_b32 v103, 0
v_mov_b32 v104, 0
v_mov_b32 v105, 0
v_mov_b32 v106, 0
v_mov_b32 v107, 0
v_mov_b32 v108, 0
v_mov_b32 v109, 0
v_mov_b32 v110, 0
v_mov_b32 v111, 0
s_branch Lrs28
.section .rodata,"a"
.p2align 6
.amdhsa_kernel parallel_sum__sliding_block__dense_activation_relu__prompt_kernel
  .amdhsa_next_free_vgpr 512
  .amdhsa_next_free_sgpr 102
  .amdhsa_accum_offset 256
  .amdhsa_group_segment_fixed_size 0
  .amdhsa_kernarg_size 72
  .amdhsa_user_sgpr_count 2
  .amdhsa_user_sgpr_kernarg_segment_ptr 1
  .amdhsa_system_sgpr_workgroup_id_x 1
.end_amdhsa_kernel
```
